```python
import torch

def _softmax(x, axis=-1):
    return torch.softmax(x, dim=axis)

def _gelu(x):
    return torch.nn.functional.gelu(x, approximate='tanh')

def _silu(x):
    return torch.nn.functional.silu(x)

def _sigmoid(x):
    return torch.sigmoid(x)

def _layernorm(x, axis=-1, eps=1e-05):
    m = x.mean(dim=axis, keepdim=True)
    v = x.var(dim=axis, keepdim=True, unbiased=False)
    return (x - m) / torch.sqrt(v + eps)

def _scatter_add(tgt, idx, src, axis=0):
    return tgt.clone().index_add_(axis, idx, src)

def _segment_sum(src, seg, n):
    out = torch.zeros((n,) + src.shape[1:], dtype=src.dtype)
    return out.index_add_(0, seg, src)

def _pad(x, pw):
    flat = tuple((v for pair in reversed(pw) for v in pair))
    return torch.nn.functional.pad(x, flat)
kernel_name = 'adaLN_cond__sliding_local_dilated__geglu_ffn__prompt'

def setup_inputs():

    _w = lambda a: (lambda t: t.to(torch.bfloat16) if t.is_floating_point() else t)(torch.as_tensor(a))

    def _A_setup():
        B, S, D = (1, 2048, 640)
        return {'x': _w((lambda *s: torch.randn(*s, dtype=torch.bfloat16) * 0.05)(B, S, D)), 'wqkv': _w((lambda *s: torch.randn(*s, dtype=torch.bfloat16) * 0.05)(D, 3 * D)), 'wo': _w((lambda *s: torch.randn(*s, dtype=torch.bfloat16) * 0.05)(D, D))}
    _A_in = _A_setup()

    def _B_setup():
        B, S, D, F = (1, 2048, 640, 1536)
        return {'x': _w((lambda *s: torch.randn(*s, dtype=torch.bfloat16) * 0.05)(B, S, D)), 'w_gate': _w((lambda *s: torch.randn(*s, dtype=torch.bfloat16) * 0.05)(D, F)), 'w_up': _w((lambda *s: torch.randn(*s, dtype=torch.bfloat16) * 0.05)(D, F)), 'w_down': _w((lambda *s: torch.randn(*s, dtype=torch.bfloat16) * 0.05)(F, D))}
    _B_in = _B_setup()
    return {'A_x': _A_in['x'], 'A_wqkv': _A_in['wqkv'], 'A_wo': _A_in['wo'], 'B_x': _B_in['x'], 'B_w_gate': _B_in['w_gate'], 'B_w_up': _B_in['w_up'], 'B_w_down': _B_in['w_down'], 'c': _w((lambda *s: torch.randn(*s, dtype=torch.bfloat16) * 0.1)(1, 640) * 8.0), 'w_mod': _w((lambda *s: torch.randn(*s, dtype=torch.bfloat16) * 0.1)(640, 6 * 640) * 640 ** (-0.5) * 8.0)}

def reference(A_x, A_wqkv, A_wo, B_x, B_w_gate, B_w_up, B_w_down, c, w_mod):

    def _A_ref(x, wqkv, wo):
        B, S, D = x.shape
        H = 32
        Dh = D // H
        W, dil = (8, 2)
        qkv = (lambda x, *d: x.permute(*d))((x @ wqkv).reshape(B, S, 3, H, Dh), 2, 0, 3, 1, 4)
        q, k, v = (qkv[0], qkv[1], qkv[2])
        scale = Dh ** (-0.5)
        pos = torch.arange(S)
        off = torch.arange(W) * dil
        idx = pos[:, None] - off[None, :]
        mask = idx >= 0
        idx_c = torch.where(mask, idx, 0).reshape(-1)
        kg = k[:, :, idx_c, :].reshape(B, H, S, W, Dh)
        vg = v[:, :, idx_c, :].reshape(B, H, S, W, Dh)
        logits = torch.einsum('bhsd,bhswd->bhsw', q, kg) * scale
        logits = torch.where(mask[None, None, :, :], logits, -1000000000.0)
        attn = _softmax(logits, axis=-1)
        o = torch.einsum('bhsw,bhswd->bhsd', attn, vg)
        return (lambda x, *d: x.permute(*d))(o, 0, 2, 1, 3).reshape(B, S, D) @ wo

    def _B_ref(x, w_gate, w_up, w_down):
        return _gelu(x @ w_gate) * (x @ w_up) @ w_down
    x = A_x
    mod = (_silu(c) @ w_mod).reshape(c.shape[0], 6, 1, -1)
    sa, ca, ga, sb, cb, gb = (mod[:, 0].clone(), mod[:, 1].clone(), mod[:, 2].clone(), mod[:, 3].clone(), mod[:, 4].clone(), mod[:, 5].clone())
    h = _layernorm(x, axis=-1) * (1 + ca) + sa
    x = x + ga * _A_ref(h, A_wqkv, A_wo)
    h = _layernorm(x, axis=-1) * (1 + cb) + sb
    x = x + gb * _B_ref(h, B_w_gate, B_w_up, B_w_down)
    return x
```

```asm
; @launch grid=(256,1,1) block=(256,1,1) lds=163840
.amdgcn_target "amdgcn-amd-amdhsa--gfx950"
.text
.globl adaLN_cond__sliding_local_dilated__geglu_ffn__prompt_kernel
.p2align 8
.type adaLN_cond__sliding_local_dilated__geglu_ffn__prompt_kernel,@function
adaLN_cond__sliding_local_dilated__geglu_ffn__prompt_kernel:
s_cmp_ge_u32 s2, 256
s_cbranch_scc1 L_exit
s_load_dwordx16 s[16:31], s[0:1], 0
s_load_dwordx8 s[32:39], s[0:1], 64
s_getpc_b64 s[14:15]
L_pc:
s_lshr_b32 s11, s2, 3
s_and_b32 s11, s11, 7
s_lshl_b32 s11, s11, 13
v_lshrrev_b32 v3, 6, v0
v_lshlrev_b32 v3, 4, v3
v_and_b32 v2, 15, v0
v_add_u32 v3, v3, v2
v_lshl_add_u32 v3, v3, 7, s11
v_min_u32 v3, (L_code_end-L_pc-4), v3
global_load_dword v254, v3, s[14:15]
v_lshrrev_b32 v1, 6, v0
v_and_b32 v0, 63, v0
v_readfirstlane_b32 s3, v1
v_and_b32 v252, 15, v0
v_lshl_add_u32 v252, v1, 4, v252
v_lshlrev_b32 v252, 7, v252
s_and_b32 s6, s2, 7
s_lshr_b32 s7, s2, 3
s_lshr_b32 s4, s6, 1
s_lshl_b32 s4, s4, 2
s_lshr_b32 s11, s7, 3
s_add_u32 s4, s4, s11
s_and_b32 s5, s7, 3
s_and_b32 s11, s6, 1
s_lshl_b32 s11, s11, 2
s_add_u32 s5, s5, s11
s_and_b32 s11, s7, 4
s_lshl_b32 s11, s11, 1
s_add_u32 s5, s5, s11
s_lshl_b32 s9, s4, 4
s_add_u32 s9, s9, s5
s_mov_b32 s98, 0x05040100
s_mov_b32 s99, 0x07060302
s_lshl_b32 s11, s4, 4
s_add_u32 s11, s11, s5
s_lshl_b32 s11, s11, 2
s_add_u32 s11, s11, s3
s_lshl_b32 s11, s11, 7
s_add_u32 s10, s11, 8192
s_waitcnt lgkmcnt(0)
s_mov_b32 s40, s38
s_mov_b32 s41, s39
s_mov_b32 s42, 28311552
s_mov_b32 s43, 0x20000
buffer_load_dword v251, off, s[40:43], 0 sc1
s_cmp_eq_u32 s3, 1
s_cbranch_scc1 L_ld1
s_cmp_eq_u32 s3, 2
s_cbranch_scc1 L_ld2
s_cmp_eq_u32 s3, 3
s_cbranch_scc1 L_ld3
s_mov_b32 s44, s16
s_mov_b32 s45, s17
s_mov_b32 s46, 2621440
s_mov_b32 s47, 0x20000
s_lshl_b32 s11, s4, 4
s_add_u32 s11, s11, s5
s_mul_i32 s11, s11, 10240
v_and_b32 v5, 7, v0
v_lshrrev_b32 v6, 3, v0
v_mul_u32_u24 v7, 1280, v5
v_lshl_add_u32 v7, v6, 4, v7
buffer_load_dwordx4 v[8:11], v7, s[44:47], s11 offen offset:0
buffer_load_dwordx4 v[12:15], v7, s[44:47], s11 offen offset:128
buffer_load_dwordx4 v[16:19], v7, s[44:47], s11 offen offset:256
buffer_load_dwordx4 v[20:23], v7, s[44:47], s11 offen offset:384
buffer_load_dwordx4 v[24:27], v7, s[44:47], s11 offen offset:512
buffer_load_dwordx4 v[28:31], v7, s[44:47], s11 offen offset:640
buffer_load_dwordx4 v[32:35], v7, s[44:47], s11 offen offset:768
buffer_load_dwordx4 v[36:39], v7, s[44:47], s11 offen offset:896
buffer_load_dwordx4 v[40:43], v7, s[44:47], s11 offen offset:1024
buffer_load_dwordx4 v[44:47], v7, s[44:47], s11 offen offset:1152
s_branch L_role_ln
L_ld1:
s_mov_b32 s44, s20
s_mov_b32 s45, s21
s_mov_b32 s46, 819200
s_mov_b32 s47, 0x20000
s_lshr_b32 s84, s5, 3
s_mul_i32 s85, s4, 3
s_lshl_b32 s86, s4, 1
s_add_u32 s86, s86, 48
s_cmp_eq_u32 s84, 0
s_cselect_b32 s85, s85, s86
v_mul_u32_u24 v5, 6554, v0
v_lshrrev_b32 v5, 16, v5
v_mul_u32_u24 v6, 10, v5
v_sub_u32 v6, v0, v6
v_mul_u32_u24 v5, 1280, v5
v_lshl_add_u32 v5, v6, 4, v5
s_mul_i32 s11, s85, 10240
s_and_b32 s12, s5, 7
s_mul_i32 s12, s12, 160
s_add_u32 s11, s11, s12
s_mov_b32 exec_lo, 0xffffffff
s_mov_b32 exec_hi, 0xfffffff
s_mov_b32 m0, 159232
s_nop 0
buffer_load_dwordx4 v5, s[44:47], s11 offen lds
s_add_u32 s11, s11, 7680
s_mov_b32 m0, 160192
s_nop 0
buffer_load_dwordx4 v5, s[44:47], s11 offen lds
s_add_u32 s11, s11, 7680
s_mov_b32 m0, 161152
s_nop 0
buffer_load_dwordx4 v5, s[44:47], s11 offen lds
s_add_u32 s11, s11, 7680
s_mov_b32 m0, 162112
s_nop 0
buffer_load_dwordx4 v5, s[44:47], s11 offen lds
s_mov_b64 exec, -1
s_branch L_role_wo
L_ld2:
s_mul_i32 s84, s2, 1093
s_lshr_b32 s84, s84, 16
s_mul_i32 s85, s84, 60
s_sub_u32 s85, s2, s85
s_mov_b32 s44, s30
s_mov_b32 s45, s31
s_mov_b32 s46, 1280
s_mov_b32 s47, 0x20000
s_mov_b32 s48, s32
s_mov_b32 s49, s33
s_mov_b32 s50, 4915200
s_mov_b32 s51, 0x20000
s_mul_i32 s13, s84, 320
v_lshlrev_b32 v5, 3, v0
buffer_load_dwordx2 v[8:9], v5, s[44:47], s13 offen
v_lshrrev_b32 v6, 3, v0
v_and_b32 v7, 7, v0
v_mul_u32_u24 v6, 7680, v6
v_lshl_add_u32 v6, v7, 4, v6
s_mul_i32 s13, s84, 1228800
s_lshl_b32 s72, s85, 7
s_add_u32 s13, s13, s72
s_cmp_lt_u32 s2, 240
s_cselect_b32 s13, s13, 0x40000000
s_mov_b32 m0, 122880
s_nop 0
buffer_load_dwordx4 v6, s[48:51], s13 offen lds
s_add_u32 s13, s13, 61440
s_mov_b32 m0, 123904
s_nop 0
buffer_load_dwordx4 v6, s[48:51], s13 offen lds
s_add_u32 s13, s13, 61440
s_mov_b32 m0, 124928
s_nop 0
buffer_load_dwordx4 v6, s[48:51], s13 offen lds
s_add_u32 s13, s13, 61440
s_mov_b32 m0, 125952
s_nop 0
buffer_load_dwordx4 v6, s[48:51], s13 offen lds
s_add_u32 s13, s13, 61440
s_mov_b32 m0, 126976
s_nop 0
buffer_load_dwordx4 v6, s[48:51], s13 offen lds
s_add_u32 s13, s13, 61440
s_mov_b32 m0, 128000
s_nop 0
buffer_load_dwordx4 v6, s[48:51], s13 offen lds
s_add_u32 s13, s13, 61440
s_mov_b32 m0, 129024
s_nop 0
buffer_load_dwordx4 v6, s[48:51], s13 offen lds
s_add_u32 s13, s13, 61440
s_mov_b32 m0, 130048
s_nop 0
buffer_load_dwordx4 v6, s[48:51], s13 offen lds
s_add_u32 s13, s13, 61440
s_mov_b32 m0, 131072
s_nop 0
buffer_load_dwordx4 v6, s[48:51], s13 offen lds
s_add_u32 s13, s13, 61440
s_mov_b32 m0, 132096
s_nop 0
buffer_load_dwordx4 v6, s[48:51], s13 offen lds
s_add_u32 s13, s13, 61440
s_mov_b32 m0, 133120
s_nop 0
buffer_load_dwordx4 v6, s[48:51], s13 offen lds
s_add_u32 s13, s13, 61440
s_mov_b32 m0, 134144
s_nop 0
buffer_load_dwordx4 v6, s[48:51], s13 offen lds
s_add_u32 s13, s13, 61440
s_mov_b32 m0, 135168
s_nop 0
buffer_load_dwordx4 v6, s[48:51], s13 offen lds
s_add_u32 s13, s13, 61440
s_mov_b32 m0, 136192
s_nop 0
buffer_load_dwordx4 v6, s[48:51], s13 offen lds
s_add_u32 s13, s13, 61440
s_mov_b32 m0, 137216
s_nop 0
buffer_load_dwordx4 v6, s[48:51], s13 offen lds
s_add_u32 s13, s13, 61440
s_mov_b32 m0, 138240
s_nop 0
buffer_load_dwordx4 v6, s[48:51], s13 offen lds
s_add_u32 s13, s13, 61440
s_mov_b32 m0, 139264
s_nop 0
buffer_load_dwordx4 v6, s[48:51], s13 offen lds
s_add_u32 s13, s13, 61440
s_mov_b32 m0, 140288
s_nop 0
buffer_load_dwordx4 v6, s[48:51], s13 offen lds
s_add_u32 s13, s13, 61440
s_mov_b32 m0, 141312
s_nop 0
buffer_load_dwordx4 v6, s[48:51], s13 offen lds
s_add_u32 s13, s13, 61440
s_mov_b32 m0, 142336
s_nop 0
buffer_load_dwordx4 v6, s[48:51], s13 offen lds
s_branch L_role_mod
L_ld3:
s_mov_b32 s44, s18
s_mov_b32 s45, s19
s_mov_b32 s46, 2457600
s_mov_b32 s47, 0x20000
v_mul_u32_u24 v5, 4370, v0
v_lshrrev_b32 v5, 16, v5
v_mul_u32_u24 v6, 15, v5
v_sub_u32 v6, v0, v6
v_mul_u32_u24 v7, 13108, v6
v_lshrrev_b32 v7, 16, v7
v_mul_u32_u24 v5, 3840, v5
v_lshl_add_u32 v5, v6, 4, v5
v_mul_u32_u24 v7, 1200, v7
v_add_u32 v5, v5, v7
s_mul_i32 s11, s4, 153600
s_mul_i32 s12, s5, 80
s_add_u32 s11, s11, s12
s_mov_b32 exec_lo, 0xffffffff
s_mov_b32 exec_hi, 0xfffffff
s_mov_b32 m0, 143360
s_nop 0
buffer_load_dwordx4 v5, s[44:47], s11 offen lds
s_add_u32 s11, s11, 15360
s_mov_b32 m0, 144320
s_nop 0
buffer_load_dwordx4 v5, s[44:47], s11 offen lds
s_add_u32 s11, s11, 15360
s_mov_b32 m0, 145280
s_nop 0
buffer_load_dwordx4 v5, s[44:47], s11 offen lds
s_add_u32 s11, s11, 15360
s_mov_b32 m0, 146240
s_nop 0
buffer_load_dwordx4 v5, s[44:47], s11 offen lds
s_add_u32 s11, s11, 15360
s_mov_b32 m0, 147200
s_nop 0
buffer_load_dwordx4 v5, s[44:47], s11 offen lds
s_add_u32 s11, s11, 15360
s_mov_b32 m0, 148160
s_nop 0
buffer_load_dwordx4 v5, s[44:47], s11 offen lds
s_add_u32 s11, s11, 15360
s_mov_b32 m0, 149120
s_nop 0
buffer_load_dwordx4 v5, s[44:47], s11 offen lds
s_add_u32 s11, s11, 15360
s_mov_b32 m0, 150080
s_nop 0
buffer_load_dwordx4 v5, s[44:47], s11 offen lds
s_add_u32 s11, s11, 15360
s_mov_b32 m0, 151040
s_nop 0
buffer_load_dwordx4 v5, s[44:47], s11 offen lds
s_add_u32 s11, s11, 15360
s_mov_b32 m0, 152000
s_nop 0
buffer_load_dwordx4 v5, s[44:47], s11 offen lds
s_mov_b64 exec, -1
s_branch L_role_wq
L_role_ln:
s_and_b32 s12, s5, 1
s_lshl_b32 s12, s12, 3
v_add_u32 v5, s12, v5
v_lshlrev_b32 v5, 4, v5
v_lshl_add_u32 v5, v6, 8, v5
s_lshr_b32 s12, s5, 1
s_lshl_b32 s13, s4, 3
s_add_u32 s12, s12, s13
s_mul_i32 s12, s12, 20480
s_add_u32 s12, s12, 1048576
s_mov_b32 s13, 0xffff0000
s_waitcnt vmcnt(9)
v_readfirstlane_b32 s11, v251
s_nop 3
s_mul_i32 s8, s11, 0x9e3779b1
s_add_u32 s8, s8, 0x7f4a7c15
v_lshlrev_b32 v48, 16, v8
v_and_b32 v49, s13, v8
v_lshlrev_b32 v50, 16, v9
v_and_b32 v51, s13, v9
v_lshlrev_b32 v52, 16, v10
v_and_b32 v53, s13, v10
v_lshlrev_b32 v54, 16, v11
v_and_b32 v55, s13, v11
s_waitcnt vmcnt(8)
v_lshlrev_b32 v56, 16, v12
v_and_b32 v57, s13, v12
v_lshlrev_b32 v58, 16, v13
v_and_b32 v59, s13, v13
v_lshlrev_b32 v60, 16, v14
v_and_b32 v61, s13, v14
v_lshlrev_b32 v62, 16, v15
v_and_b32 v63, s13, v15
s_waitcnt vmcnt(7)
v_lshlrev_b32 v64, 16, v16
v_and_b32 v65, s13, v16
v_lshlrev_b32 v66, 16, v17
v_and_b32 v67, s13, v17
v_lshlrev_b32 v68, 16, v18
v_and_b32 v69, s13, v18
v_lshlrev_b32 v70, 16, v19
v_and_b32 v71, s13, v19
s_waitcnt vmcnt(6)
v_lshlrev_b32 v72, 16, v20
v_and_b32 v73, s13, v20
v_lshlrev_b32 v74, 16, v21
v_and_b32 v75, s13, v21
v_lshlrev_b32 v76, 16, v22
v_and_b32 v77, s13, v22
v_lshlrev_b32 v78, 16, v23
v_and_b32 v79, s13, v23
s_waitcnt vmcnt(5)
v_lshlrev_b32 v80, 16, v24
v_and_b32 v81, s13, v24
v_lshlrev_b32 v82, 16, v25
v_and_b32 v83, s13, v25
v_lshlrev_b32 v84, 16, v26
v_and_b32 v85, s13, v26
v_lshlrev_b32 v86, 16, v27
v_and_b32 v87, s13, v27
s_waitcnt vmcnt(4)
v_lshlrev_b32 v88, 16, v28
v_and_b32 v89, s13, v28
v_lshlrev_b32 v90, 16, v29
v_and_b32 v91, s13, v29
v_lshlrev_b32 v92, 16, v30
v_and_b32 v93, s13, v30
v_lshlrev_b32 v94, 16, v31
v_and_b32 v95, s13, v31
s_waitcnt vmcnt(3)
v_lshlrev_b32 v96, 16, v32
v_and_b32 v97, s13, v32
v_lshlrev_b32 v98, 16, v33
v_and_b32 v99, s13, v33
v_lshlrev_b32 v100, 16, v34
v_and_b32 v101, s13, v34
v_lshlrev_b32 v102, 16, v35
v_and_b32 v103, s13, v35
s_waitcnt vmcnt(2)
v_lshlrev_b32 v104, 16, v36
v_and_b32 v105, s13, v36
v_lshlrev_b32 v106, 16, v37
v_and_b32 v107, s13, v37
v_lshlrev_b32 v108, 16, v38
v_and_b32 v109, s13, v38
v_lshlrev_b32 v110, 16, v39
v_and_b32 v111, s13, v39
s_waitcnt vmcnt(1)
v_lshlrev_b32 v112, 16, v40
v_and_b32 v113, s13, v40
v_lshlrev_b32 v114, 16, v41
v_and_b32 v115, s13, v41
v_lshlrev_b32 v116, 16, v42
v_and_b32 v117, s13, v42
v_lshlrev_b32 v118, 16, v43
v_and_b32 v119, s13, v43
s_waitcnt vmcnt(0)
v_lshlrev_b32 v120, 16, v44
v_and_b32 v121, s13, v44
v_lshlrev_b32 v122, 16, v45
v_and_b32 v123, s13, v45
v_lshlrev_b32 v124, 16, v46
v_and_b32 v125, s13, v46
v_lshlrev_b32 v126, 16, v47
v_and_b32 v127, s13, v47
v_pk_add_f32 v[128:129], v[48:49], v[56:57]
v_pk_add_f32 v[130:131], v[50:51], v[58:59]
v_pk_add_f32 v[132:133], v[52:53], v[60:61]
v_pk_add_f32 v[134:135], v[54:55], v[62:63]
v_pk_add_f32 v[128:129], v[128:129], v[64:65]
v_pk_add_f32 v[130:131], v[130:131], v[66:67]
v_pk_add_f32 v[132:133], v[132:133], v[68:69]
v_pk_add_f32 v[134:135], v[134:135], v[70:71]
v_pk_add_f32 v[128:129], v[128:129], v[72:73]
v_pk_add_f32 v[130:131], v[130:131], v[74:75]
v_pk_add_f32 v[132:133], v[132:133], v[76:77]
v_pk_add_f32 v[134:135], v[134:135], v[78:79]
v_pk_add_f32 v[128:129], v[128:129], v[80:81]
v_pk_add_f32 v[130:131], v[130:131], v[82:83]
v_pk_add_f32 v[132:133], v[132:133], v[84:85]
v_pk_add_f32 v[134:135], v[134:135], v[86:87]
v_pk_add_f32 v[128:129], v[128:129], v[88:89]
v_pk_add_f32 v[130:131], v[130:131], v[90:91]
v_pk_add_f32 v[132:133], v[132:133], v[92:93]
v_pk_add_f32 v[134:135], v[134:135], v[94:95]
v_pk_add_f32 v[128:129], v[128:129], v[96:97]
v_pk_add_f32 v[130:131], v[130:131], v[98:99]
v_pk_add_f32 v[132:133], v[132:133], v[100:101]
v_pk_add_f32 v[134:135], v[134:135], v[102:103]
v_pk_add_f32 v[128:129], v[128:129], v[104:105]
v_pk_add_f32 v[130:131], v[130:131], v[106:107]
v_pk_add_f32 v[132:133], v[132:133], v[108:109]
v_pk_add_f32 v[134:135], v[134:135], v[110:111]
v_pk_add_f32 v[128:129], v[128:129], v[112:113]
v_pk_add_f32 v[130:131], v[130:131], v[114:115]
v_pk_add_f32 v[132:133], v[132:133], v[116:117]
v_pk_add_f32 v[134:135], v[134:135], v[118:119]
v_pk_add_f32 v[128:129], v[128:129], v[120:121]
v_pk_add_f32 v[130:131], v[130:131], v[122:123]
v_pk_add_f32 v[132:133], v[132:133], v[124:125]
v_pk_add_f32 v[134:135], v[134:135], v[126:127]
v_pk_add_f32 v[128:129], v[128:129], v[130:131]
v_pk_add_f32 v[132:133], v[132:133], v[134:135]
v_pk_add_f32 v[128:129], v[128:129], v[132:133]
v_add_f32 v136, v128, v129
s_nop 1
v_add_f32_dpp v136, v136, v136 row_ror:8 row_mask:0xf bank_mask:0xf
v_mov_b32 v138, v136
v_mov_b32 v139, v136
s_nop 1
v_permlane16_swap_b32 v138, v139
v_add_f32 v136, v138, v139
v_mov_b32 v138, v136
v_mov_b32 v139, v136
s_nop 1
v_permlane32_swap_b32 v138, v139
v_add_f32 v136, v138, v139
v_mul_f32 v136, 0xbacccccd, v136
v_mov_b32 v137, v136
v_pk_add_f32 v[48:49], v[48:49], v[136:137]
v_pk_add_f32 v[50:51], v[50:51], v[136:137]
v_pk_add_f32 v[52:53], v[52:53], v[136:137]
v_pk_add_f32 v[54:55], v[54:55], v[136:137]
v_pk_add_f32 v[56:57], v[56:57], v[136:137]
v_pk_add_f32 v[58:59], v[58:59], v[136:137]
v_pk_add_f32 v[60:61], v[60:61], v[136:137]
v_pk_add_f32 v[62:63], v[62:63], v[136:137]
v_pk_add_f32 v[64:65], v[64:65], v[136:137]
v_pk_add_f32 v[66:67], v[66:67], v[136:137]
v_pk_add_f32 v[68:69], v[68:69], v[136:137]
v_pk_add_f32 v[70:71], v[70:71], v[136:137]
v_pk_add_f32 v[72:73], v[72:73], v[136:137]
v_pk_add_f32 v[74:75], v[74:75], v[136:137]
v_pk_add_f32 v[76:77], v[76:77], v[136:137]
v_pk_add_f32 v[78:79], v[78:79], v[136:137]
v_pk_add_f32 v[80:81], v[80:81], v[136:137]
v_pk_add_f32 v[82:83], v[82:83], v[136:137]
v_pk_add_f32 v[84:85], v[84:85], v[136:137]
v_pk_add_f32 v[86:87], v[86:87], v[136:137]
v_pk_add_f32 v[88:89], v[88:89], v[136:137]
v_pk_add_f32 v[90:91], v[90:91], v[136:137]
v_pk_add_f32 v[92:93], v[92:93], v[136:137]
v_pk_add_f32 v[94:95], v[94:95], v[136:137]
v_pk_add_f32 v[96:97], v[96:97], v[136:137]
v_pk_add_f32 v[98:99], v[98:99], v[136:137]
v_pk_add_f32 v[100:101], v[100:101], v[136:137]
v_pk_add_f32 v[102:103], v[102:103], v[136:137]
v_pk_add_f32 v[104:105], v[104:105], v[136:137]
v_pk_add_f32 v[106:107], v[106:107], v[136:137]
v_pk_add_f32 v[108:109], v[108:109], v[136:137]
v_pk_add_f32 v[110:111], v[110:111], v[136:137]
v_pk_add_f32 v[112:113], v[112:113], v[136:137]
v_pk_add_f32 v[114:115], v[114:115], v[136:137]
v_pk_add_f32 v[116:117], v[116:117], v[136:137]
v_pk_add_f32 v[118:119], v[118:119], v[136:137]
v_pk_add_f32 v[120:121], v[120:121], v[136:137]
v_pk_add_f32 v[122:123], v[122:123], v[136:137]
v_pk_add_f32 v[124:125], v[124:125], v[136:137]
v_pk_add_f32 v[126:127], v[126:127], v[136:137]
v_pk_mul_f32 v[128:129], v[48:49], v[48:49]
v_pk_mul_f32 v[130:131], v[50:51], v[50:51]
v_pk_mul_f32 v[132:133], v[52:53], v[52:53]
v_pk_mul_f32 v[134:135], v[54:55], v[54:55]
v_pk_fma_f32 v[128:129], v[56:57], v[56:57], v[128:129]
v_pk_fma_f32 v[130:131], v[58:59], v[58:59], v[130:131]
v_pk_fma_f32 v[132:133], v[60:61], v[60:61], v[132:133]
v_pk_fma_f32 v[134:135], v[62:63], v[62:63], v[134:135]
v_pk_fma_f32 v[128:129], v[64:65], v[64:65], v[128:129]
v_pk_fma_f32 v[130:131], v[66:67], v[66:67], v[130:131]
v_pk_fma_f32 v[132:133], v[68:69], v[68:69], v[132:133]
v_pk_fma_f32 v[134:135], v[70:71], v[70:71], v[134:135]
v_pk_fma_f32 v[128:129], v[72:73], v[72:73], v[128:129]
v_pk_fma_f32 v[130:131], v[74:75], v[74:75], v[130:131]
v_pk_fma_f32 v[132:133], v[76:77], v[76:77], v[132:133]
v_pk_fma_f32 v[134:135], v[78:79], v[78:79], v[134:135]
v_pk_fma_f32 v[128:129], v[80:81], v[80:81], v[128:129]
v_pk_fma_f32 v[130:131], v[82:83], v[82:83], v[130:131]
v_pk_fma_f32 v[132:133], v[84:85], v[84:85], v[132:133]
v_pk_fma_f32 v[134:135], v[86:87], v[86:87], v[134:135]
v_pk_fma_f32 v[128:129], v[88:89], v[88:89], v[128:129]
v_pk_fma_f32 v[130:131], v[90:91], v[90:91], v[130:131]
v_pk_fma_f32 v[132:133], v[92:93], v[92:93], v[132:133]
v_pk_fma_f32 v[134:135], v[94:95], v[94:95], v[134:135]
v_pk_fma_f32 v[128:129], v[96:97], v[96:97], v[128:129]
v_pk_fma_f32 v[130:131], v[98:99], v[98:99], v[130:131]
v_pk_fma_f32 v[132:133], v[100:101], v[100:101], v[132:133]
v_pk_fma_f32 v[134:135], v[102:103], v[102:103], v[134:135]
v_pk_fma_f32 v[128:129], v[104:105], v[104:105], v[128:129]
v_pk_fma_f32 v[130:131], v[106:107], v[106:107], v[130:131]
v_pk_fma_f32 v[132:133], v[108:109], v[108:109], v[132:133]
v_pk_fma_f32 v[134:135], v[110:111], v[110:111], v[134:135]
v_pk_fma_f32 v[128:129], v[112:113], v[112:113], v[128:129]
v_pk_fma_f32 v[130:131], v[114:115], v[114:115], v[130:131]
v_pk_fma_f32 v[132:133], v[116:117], v[116:117], v[132:133]
v_pk_fma_f32 v[134:135], v[118:119], v[118:119], v[134:135]
v_pk_fma_f32 v[128:129], v[120:121], v[120:121], v[128:129]
v_pk_fma_f32 v[130:131], v[122:123], v[122:123], v[130:131]
v_pk_fma_f32 v[132:133], v[124:125], v[124:125], v[132:133]
v_pk_fma_f32 v[134:135], v[126:127], v[126:127], v[134:135]
v_pk_add_f32 v[128:129], v[128:129], v[130:131]
v_pk_add_f32 v[132:133], v[132:133], v[134:135]
v_pk_add_f32 v[128:129], v[128:129], v[132:133]
v_add_f32 v136, v128, v129
s_nop 1
v_add_f32_dpp v136, v136, v136 row_ror:8 row_mask:0xf bank_mask:0xf
v_mov_b32 v138, v136
v_mov_b32 v139, v136
s_nop 1
v_permlane16_swap_b32 v138, v139
v_add_f32 v136, v138, v139
v_mov_b32 v138, v136
v_mov_b32 v139, v136
s_nop 1
v_permlane32_swap_b32 v138, v139
v_add_f32 v136, v138, v139
v_mov_b32 v137, 0x3727c5ac
v_fmac_f32 v137, 0x3acccccd, v136
v_rsq_f32 v136, v137
s_nop 0
v_mov_b32 v137, v136
v_pk_mul_f32 v[48:49], v[48:49], v[136:137]
v_pk_mul_f32 v[50:51], v[50:51], v[136:137]
v_pk_mul_f32 v[52:53], v[52:53], v[136:137]
v_pk_mul_f32 v[54:55], v[54:55], v[136:137]
v_cvt_pk_f16_f32 v8, v48, v49
v_cvt_pk_f16_f32 v9, v50, v51
v_cvt_pk_f16_f32 v10, v52, v53
v_cvt_pk_f16_f32 v11, v54, v55
buffer_store_dwordx4 v[8:11], v5, s[40:43], s12 offen offset:0 sc1
v_pk_mul_f32 v[56:57], v[56:57], v[136:137]
v_pk_mul_f32 v[58:59], v[58:59], v[136:137]
v_pk_mul_f32 v[60:61], v[60:61], v[136:137]
v_pk_mul_f32 v[62:63], v[62:63], v[136:137]
v_cvt_pk_f16_f32 v12, v56, v57
v_cvt_pk_f16_f32 v13, v58, v59
v_cvt_pk_f16_f32 v14, v60, v61
v_cvt_pk_f16_f32 v15, v62, v63
buffer_store_dwordx4 v[12:15], v5, s[40:43], s12 offen offset:2048 sc1
s_add_u32 s12, s12, 4096
v_pk_mul_f32 v[64:65], v[64:65], v[136:137]
v_pk_mul_f32 v[66:67], v[66:67], v[136:137]
v_pk_mul_f32 v[68:69], v[68:69], v[136:137]
v_pk_mul_f32 v[70:71], v[70:71], v[136:137]
v_cvt_pk_f16_f32 v16, v64, v65
v_cvt_pk_f16_f32 v17, v66, v67
v_cvt_pk_f16_f32 v18, v68, v69
v_cvt_pk_f16_f32 v19, v70, v71
buffer_store_dwordx4 v[16:19], v5, s[40:43], s12 offen offset:0 sc1
v_pk_mul_f32 v[72:73], v[72:73], v[136:137]
v_pk_mul_f32 v[74:75], v[74:75], v[136:137]
v_pk_mul_f32 v[76:77], v[76:77], v[136:137]
v_pk_mul_f32 v[78:79], v[78:79], v[136:137]
v_cvt_pk_f16_f32 v20, v72, v73
v_cvt_pk_f16_f32 v21, v74, v75
v_cvt_pk_f16_f32 v22, v76, v77
v_cvt_pk_f16_f32 v23, v78, v79
buffer_store_dwordx4 v[20:23], v5, s[40:43], s12 offen offset:2048 sc1
s_add_u32 s12, s12, 4096
v_pk_mul_f32 v[80:81], v[80:81], v[136:137]
v_pk_mul_f32 v[82:83], v[82:83], v[136:137]
v_pk_mul_f32 v[84:85], v[84:85], v[136:137]
v_pk_mul_f32 v[86:87], v[86:87], v[136:137]
v_cvt_pk_f16_f32 v24, v80, v81
v_cvt_pk_f16_f32 v25, v82, v83
v_cvt_pk_f16_f32 v26, v84, v85
v_cvt_pk_f16_f32 v27, v86, v87
buffer_store_dwordx4 v[24:27], v5, s[40:43], s12 offen offset:0 sc1
v_pk_mul_f32 v[88:89], v[88:89], v[136:137]
v_pk_mul_f32 v[90:91], v[90:91], v[136:137]
v_pk_mul_f32 v[92:93], v[92:93], v[136:137]
v_pk_mul_f32 v[94:95], v[94:95], v[136:137]
v_cvt_pk_f16_f32 v28, v88, v89
v_cvt_pk_f16_f32 v29, v90, v91
v_cvt_pk_f16_f32 v30, v92, v93
v_cvt_pk_f16_f32 v31, v94, v95
buffer_store_dwordx4 v[28:31], v5, s[40:43], s12 offen offset:2048 sc1
s_add_u32 s12, s12, 4096
v_pk_mul_f32 v[96:97], v[96:97], v[136:137]
v_pk_mul_f32 v[98:99], v[98:99], v[136:137]
v_pk_mul_f32 v[100:101], v[100:101], v[136:137]
v_pk_mul_f32 v[102:103], v[102:103], v[136:137]
v_cvt_pk_f16_f32 v32, v96, v97
v_cvt_pk_f16_f32 v33, v98, v99
v_cvt_pk_f16_f32 v34, v100, v101
v_cvt_pk_f16_f32 v35, v102, v103
buffer_store_dwordx4 v[32:35], v5, s[40:43], s12 offen offset:0 sc1
v_pk_mul_f32 v[104:105], v[104:105], v[136:137]
v_pk_mul_f32 v[106:107], v[106:107], v[136:137]
v_pk_mul_f32 v[108:109], v[108:109], v[136:137]
v_pk_mul_f32 v[110:111], v[110:111], v[136:137]
v_cvt_pk_f16_f32 v36, v104, v105
v_cvt_pk_f16_f32 v37, v106, v107
v_cvt_pk_f16_f32 v38, v108, v109
v_cvt_pk_f16_f32 v39, v110, v111
buffer_store_dwordx4 v[36:39], v5, s[40:43], s12 offen offset:2048 sc1
s_add_u32 s12, s12, 4096
v_pk_mul_f32 v[112:113], v[112:113], v[136:137]
v_pk_mul_f32 v[114:115], v[114:115], v[136:137]
v_pk_mul_f32 v[116:117], v[116:117], v[136:137]
v_pk_mul_f32 v[118:119], v[118:119], v[136:137]
v_cvt_pk_f16_f32 v40, v112, v113
v_cvt_pk_f16_f32 v41, v114, v115
v_cvt_pk_f16_f32 v42, v116, v117
v_cvt_pk_f16_f32 v43, v118, v119
buffer_store_dwordx4 v[40:43], v5, s[40:43], s12 offen offset:0 sc1
v_pk_mul_f32 v[120:121], v[120:121], v[136:137]
v_pk_mul_f32 v[122:123], v[122:123], v[136:137]
v_pk_mul_f32 v[124:125], v[124:125], v[136:137]
v_pk_mul_f32 v[126:127], v[126:127], v[136:137]
v_cvt_pk_f16_f32 v44, v120, v121
v_cvt_pk_f16_f32 v45, v122, v123
v_cvt_pk_f16_f32 v46, v124, v125
v_cvt_pk_f16_f32 v47, v126, v127
buffer_store_dwordx4 v[44:47], v5, s[40:43], s12 offen offset:2048 sc1
s_waitcnt vmcnt(0)
s_add_u32 s72, s8, 1
v_mov_b32 v1, s72
s_mov_b64 exec, 1
buffer_store_dword v1, off, s[40:43], s10 sc1
s_mov_b64 exec, -1
s_lshl_b32 s11, s4, 4
v_add_u32 v7, s11, v0
s_cmp_eq_u32 s4, 0
s_cselect_b32 s12, 16, 18
v_subrev_u32 v8, s12, v7
v_cmp_gt_u32 vcc, 16, v0
s_nop 1
v_cndmask_b32 v7, v8, v7, vcc
v_lshlrev_b32 v7, 2, v7
v_subrev_u32 v8, 18, v0
v_lshl_add_u32 v8, v8, 4, s5
v_lshl_add_u32 v8, v8, 2, 3
v_cmp_gt_u32 vcc, 18, v0
s_nop 1
v_cndmask_b32 v7, v8, v7, vcc
v_lshlrev_b32 v7, 7, v7
v_add_u32 v7, 8192, v7
s_mov_b32 exec_lo, 0xffffffff
s_mov_b32 exec_hi, 0x3
s_add_u32 s72, s8, 1
s_mov_b32 s73, 200000
L_poll_1:
buffer_load_dword v8, v7, s[40:43], 0 offen sc1
s_waitcnt vmcnt(0)
v_subrev_u32 v8, s72, v8
v_cmp_lt_u32 vcc, 14, v8
s_sub_u32 s73, s73, 1
s_cmp_eq_u32 s73, 0
s_cbranch_scc1 L_polld_2
s_nop 0
s_cbranch_vccnz L_poll_1
L_polld_2:
s_mov_b64 exec, -1
v_lshlrev_b32 v8, 4, v0
s_mul_i32 s83, s5, 153600
s_add_u32 s83, s83, 24117248
s_mov_b32 m0, 30720
s_add_u32 s91, s83, 30720
buffer_load_dwordx4 v8, s[40:43], s91 offen sc1 lds
s_mov_b32 m0, 31744
s_add_u32 s91, s83, 31744
buffer_load_dwordx4 v8, s[40:43], s91 offen sc1 lds
s_mov_b32 m0, 32768
s_add_u32 s91, s83, 32768
buffer_load_dwordx4 v8, s[40:43], s91 offen sc1 lds
s_mov_b32 m0, 33792
s_add_u32 s91, s83, 33792
buffer_load_dwordx4 v8, s[40:43], s91 offen sc1 lds
s_mov_b32 m0, 34816
s_add_u32 s91, s83, 34816
buffer_load_dwordx4 v8, s[40:43], s91 offen sc1 lds
s_mov_b32 m0, 35840
s_add_u32 s91, s83, 35840
buffer_load_dwordx4 v8, s[40:43], s91 offen sc1 lds
s_mov_b32 m0, 36864
s_add_u32 s91, s83, 36864
buffer_load_dwordx4 v8, s[40:43], s91 offen sc1 lds
s_mov_b32 m0, 37888
s_add_u32 s91, s83, 37888
buffer_load_dwordx4 v8, s[40:43], s91 offen sc1 lds
s_mov_b32 m0, 38912
s_add_u32 s91, s83, 38912
buffer_load_dwordx4 v8, s[40:43], s91 offen sc1 lds
s_mov_b32 m0, 39936
s_add_u32 s91, s83, 39936
buffer_load_dwordx4 v8, s[40:43], s91 offen sc1 lds
s_mov_b32 m0, 40960
s_add_u32 s91, s83, 40960
buffer_load_dwordx4 v8, s[40:43], s91 offen sc1 lds
s_mov_b32 m0, 41984
s_add_u32 s91, s83, 41984
buffer_load_dwordx4 v8, s[40:43], s91 offen sc1 lds
s_mov_b32 m0, 43008
s_add_u32 s91, s83, 43008
buffer_load_dwordx4 v8, s[40:43], s91 offen sc1 lds
s_mov_b32 m0, 44032
s_add_u32 s91, s83, 44032
buffer_load_dwordx4 v8, s[40:43], s91 offen sc1 lds
s_mov_b32 m0, 45056
s_add_u32 s91, s83, 45056
buffer_load_dwordx4 v8, s[40:43], s91 offen sc1 lds
s_mov_b32 m0, 46080
s_add_u32 s91, s83, 46080
buffer_load_dwordx4 v8, s[40:43], s91 offen sc1 lds
s_mov_b32 m0, 47104
s_add_u32 s91, s83, 47104
buffer_load_dwordx4 v8, s[40:43], s91 offen sc1 lds
s_mov_b32 m0, 48128
s_add_u32 s91, s83, 48128
buffer_load_dwordx4 v8, s[40:43], s91 offen sc1 lds
s_mov_b32 m0, 49152
s_add_u32 s91, s83, 49152
buffer_load_dwordx4 v8, s[40:43], s91 offen sc1 lds
s_mov_b32 m0, 50176
s_add_u32 s91, s83, 50176
buffer_load_dwordx4 v8, s[40:43], s91 offen sc1 lds
s_mov_b32 m0, 51200
s_add_u32 s91, s83, 51200
buffer_load_dwordx4 v8, s[40:43], s91 offen sc1 lds
s_mov_b32 m0, 52224
s_add_u32 s91, s83, 52224
buffer_load_dwordx4 v8, s[40:43], s91 offen sc1 lds
s_mov_b32 m0, 53248
s_add_u32 s91, s83, 53248
buffer_load_dwordx4 v8, s[40:43], s91 offen sc1 lds
s_mov_b32 m0, 54272
s_add_u32 s91, s83, 54272
buffer_load_dwordx4 v8, s[40:43], s91 offen sc1 lds
s_mov_b32 m0, 55296
s_add_u32 s91, s83, 55296
buffer_load_dwordx4 v8, s[40:43], s91 offen sc1 lds
s_mov_b32 m0, 56320
s_add_u32 s91, s83, 56320
buffer_load_dwordx4 v8, s[40:43], s91 offen sc1 lds
s_mov_b32 m0, 57344
s_add_u32 s91, s83, 57344
buffer_load_dwordx4 v8, s[40:43], s91 offen sc1 lds
s_mov_b32 m0, 58368
s_add_u32 s91, s83, 58368
buffer_load_dwordx4 v8, s[40:43], s91 offen sc1 lds
s_mov_b32 m0, 59392
s_add_u32 s91, s83, 59392
buffer_load_dwordx4 v8, s[40:43], s91 offen sc1 lds
s_mov_b32 m0, 60416
s_add_u32 s91, s83, 60416
buffer_load_dwordx4 v8, s[40:43], s91 offen sc1 lds
s_branch L_p0_join
L_role_wo:
v_lshrrev_b32 v20, 4, v0
v_and_b32 v21, 15, v0
v_and_b32 v22, 3, v21
v_lshrrev_b32 v23, 2, v21
v_mul_u32_u24 v23, 160, v23
v_lshlrev_b32 v24, 5, v20
v_lshl_add_u32 v24, v22, 3, v24
v_add_u32 v24, v24, v23
v_add_u32 v24, 159232, v24
v_lshlrev_b32 v25, 3, v22
v_add_u32 v25, v25, v23
v_add_u32 v25, 159360, v25
s_and_b32 s12, s5, 7
s_mul_i32 s12, s12, 102400
s_add_u32 s12, s12, 16777216
v_mul_u32_u24 v26, 20480, v20
v_lshl_add_u32 v26, v21, 4, v26
v_add_u32 v26, s12, v26
v_lshlrev_b32 v27, 4, v21
v_add_u32 v27, 81920, v27
v_add_u32 v27, s12, v27
v_mov_b32 v28, 0x40000000
v_cmp_gt_u32 vcc, 16, v0
s_nop 1
v_cndmask_b32 v27, v28, v27, vcc
s_waitcnt vmcnt(0)
v_readfirstlane_b32 s11, v251
s_nop 3
s_mul_i32 s8, s11, 0x9e3779b1
s_add_u32 s8, s8, 0x7f4a7c15
ds_read_b64_tr_b16 v[32:33], v24 offset:0
ds_read_b64_tr_b16 v[34:35], v24 offset:640
ds_read_b64_tr_b16 v[36:37], v25 offset:0
ds_read_b64_tr_b16 v[38:39], v25 offset:640
ds_read_b64_tr_b16 v[40:41], v24 offset:1280
ds_read_b64_tr_b16 v[42:43], v24 offset:1920
ds_read_b64_tr_b16 v[44:45], v25 offset:1280
ds_read_b64_tr_b16 v[46:47], v25 offset:1920
ds_read_b64_tr_b16 v[48:49], v24 offset:2560
ds_read_b64_tr_b16 v[50:51], v24 offset:3200
ds_read_b64_tr_b16 v[52:53], v25 offset:2560
ds_read_b64_tr_b16 v[54:55], v25 offset:3200
s_add_u32 s86, s85, 0
s_and_b32 s87, s86, 3
s_lshr_b32 s86, s86, 2
s_lshl_b32 s86, s86, 10
s_lshl_b32 s87, s87, 8
s_add_u32 s86, s86, s87
s_waitcnt lgkmcnt(8)
buffer_store_dwordx4 v[32:35], v26, s[40:43], s86 offen sc1
buffer_store_dwordx4 v[36:39], v27, s[40:43], s86 offen sc1
s_add_u32 s86, s85, 1
s_and_b32 s87, s86, 3
s_lshr_b32 s86, s86, 2
s_lshl_b32 s86, s86, 10
s_lshl_b32 s87, s87, 8
s_add_u32 s86, s86, s87
s_waitcnt lgkmcnt(4)
buffer_store_dwordx4 v[40:43], v26, s[40:43], s86 offen sc1
buffer_store_dwordx4 v[44:47], v27, s[40:43], s86 offen sc1
s_add_u32 s86, s85, 2
s_and_b32 s87, s86, 3
s_lshr_b32 s86, s86, 2
s_lshl_b32 s86, s86, 10
s_lshl_b32 s87, s87, 8
s_add_u32 s86, s86, s87
s_cmp_eq_u32 s84, 0
s_cselect_b32 s86, s86, 0x40000000
s_waitcnt lgkmcnt(0)
buffer_store_dwordx4 v[48:51], v26, s[40:43], s86 offen sc1
buffer_store_dwordx4 v[52:55], v27, s[40:43], s86 offen sc1
v_mul_u32_u24 v5, 6554, v0
v_lshrrev_b32 v5, 16, v5
v_mul_u32_u24 v6, 10, v5
v_sub_u32 v6, v0, v6
v_mul_u32_u24 v5, 3840, v5
v_lshl_add_u32 v5, v6, 6, v5
v_add_u32 v5, 63, v5
v_lshlrev_b32 v5, 3, v5
v_add_u32 v5, 262148, v5
s_mov_b32 exec_lo, 0xffffffff
s_mov_b32 exec_hi, 0xff
s_mov_b32 s73, 200000
L_probe_3:
buffer_load_dword v6, v5, s[40:43], 0 offen sc1
s_waitcnt vmcnt(0)
v_cmp_ne_u32 vcc, s8, v6
s_sub_u32 s73, s73, 1
s_cmp_eq_u32 s73, 0
s_cbranch_scc1 L_probed_4
s_nop 0
s_cbranch_vccnz L_probe_3
L_probed_4:
s_mov_b64 exec, -1
s_mov_b32 s76, 0
v_lshlrev_b32 v5, 4, v0
s_lshl_b32 s11, s76, 3
s_add_u32 s11, s11, 262144
s_mov_b32 s73, 200000
L_gath_5:
s_mov_b32 s12, s11
buffer_load_dwordx4 v[8:11], v5, s[40:43], s12 offen offset:0 sc1
buffer_load_dwordx4 v[12:15], v5, s[40:43], s12 offen offset:1024 sc1
buffer_load_dwordx4 v[16:19], v5, s[40:43], s12 offen offset:2048 sc1
buffer_load_dwordx4 v[20:23], v5, s[40:43], s12 offen offset:3072 sc1
s_add_u32 s13, s12, 4096
buffer_load_dwordx4 v[24:27], v5, s[40:43], s13 offen sc1
s_add_u32 s12, s12, 30720
buffer_load_dwordx4 v[28:31], v5, s[40:43], s12 offen offset:0 sc1
buffer_load_dwordx4 v[32:35], v5, s[40:43], s12 offen offset:1024 sc1
buffer_load_dwordx4 v[36:39], v5, s[40:43], s12 offen offset:2048 sc1
buffer_load_dwordx4 v[40:43], v5, s[40:43], s12 offen offset:3072 sc1
s_add_u32 s13, s12, 4096
buffer_load_dwordx4 v[44:47], v5, s[40:43], s13 offen sc1
s_add_u32 s12, s12, 30720
buffer_load_dwordx4 v[48:51], v5, s[40:43], s12 offen offset:0 sc1
buffer_load_dwordx4 v[52:55], v5, s[40:43], s12 offen offset:1024 sc1
buffer_load_dwordx4 v[56:59], v5, s[40:43], s12 offen offset:2048 sc1
buffer_load_dwordx4 v[60:63], v5, s[40:43], s12 offen offset:3072 sc1
s_add_u32 s13, s12, 4096
buffer_load_dwordx4 v[64:67], v5, s[40:43], s13 offen sc1
s_add_u32 s12, s12, 30720
buffer_load_dwordx4 v[68:71], v5, s[40:43], s12 offen offset:0 sc1
buffer_load_dwordx4 v[72:75], v5, s[40:43], s12 offen offset:1024 sc1
buffer_load_dwordx4 v[76:79], v5, s[40:43], s12 offen offset:2048 sc1
buffer_load_dwordx4 v[80:83], v5, s[40:43], s12 offen offset:3072 sc1
s_add_u32 s13, s12, 4096
buffer_load_dwordx4 v[84:87], v5, s[40:43], s13 offen sc1
s_waitcnt vmcnt(0)
v_max_u32 v6, v9, v11
v_min_u32 v7, v9, v11
v_max3_u32 v6, v6, v13, v15
v_min3_u32 v7, v7, v13, v15
v_max3_u32 v6, v6, v17, v19
v_min3_u32 v7, v7, v17, v19
v_max3_u32 v6, v6, v21, v23
v_min3_u32 v7, v7, v21, v23
v_max3_u32 v6, v6, v25, v27
v_min3_u32 v7, v7, v25, v27
v_max3_u32 v6, v6, v29, v31
v_min3_u32 v7, v7, v29, v31
v_max3_u32 v6, v6, v33, v35
v_min3_u32 v7, v7, v33, v35
v_max3_u32 v6, v6, v37, v39
v_min3_u32 v7, v7, v37, v39
v_max3_u32 v6, v6, v41, v43
v_min3_u32 v7, v7, v41, v43
v_max3_u32 v6, v6, v45, v47
v_min3_u32 v7, v7, v45, v47
v_max3_u32 v6, v6, v49, v51
v_min3_u32 v7, v7, v49, v51
v_max3_u32 v6, v6, v53, v55
v_min3_u32 v7, v7, v53, v55
v_max3_u32 v6, v6, v57, v59
v_min3_u32 v7, v7, v57, v59
v_max3_u32 v6, v6, v61, v63
v_min3_u32 v7, v7, v61, v63
v_max3_u32 v6, v6, v65, v67
v_min3_u32 v7, v7, v65, v67
v_max3_u32 v6, v6, v69, v71
v_min3_u32 v7, v7, v69, v71
v_max3_u32 v6, v6, v73, v75
v_min3_u32 v7, v7, v73, v75
v_max3_u32 v6, v6, v77, v79
v_min3_u32 v7, v7, v77, v79
v_max3_u32 v6, v6, v81, v83
v_min3_u32 v7, v7, v81, v83
v_max3_u32 v6, v6, v85, v87
v_min3_u32 v7, v7, v85, v87
v_cmp_ne_u32 vcc, s8, v6
v_cmp_ne_u32 s[74:75], s8, v7
s_nop 3
s_or_b64 vcc, vcc, s[74:75]
s_sub_u32 s73, s73, 1
s_cmp_eq_u32 s73, 0
s_cbranch_scc1 L_gathd_6
s_cbranch_vccnz L_gath_5
L_gathd_6:
v_add_f32 v8, v8, v28
v_add_f32 v48, v48, v68
v_add_f32 v8, v8, v48
v_add_f32 v10, v10, v30
v_add_f32 v50, v50, v70
v_add_f32 v10, v10, v50
v_add_f32 v12, v12, v32
v_add_f32 v52, v52, v72
v_add_f32 v12, v12, v52
v_add_f32 v14, v14, v34
v_add_f32 v54, v54, v74
v_add_f32 v14, v14, v54
v_add_f32 v16, v16, v36
v_add_f32 v56, v56, v76
v_add_f32 v16, v16, v56
v_add_f32 v18, v18, v38
v_add_f32 v58, v58, v78
v_add_f32 v18, v18, v58
v_add_f32 v20, v20, v40
v_add_f32 v60, v60, v80
v_add_f32 v20, v20, v60
v_add_f32 v22, v22, v42
v_add_f32 v62, v62, v82
v_add_f32 v22, v22, v62
v_add_f32 v24, v24, v44
v_add_f32 v64, v64, v84
v_add_f32 v24, v24, v64
v_add_f32 v26, v26, v46
v_add_f32 v66, v66, v86
v_add_f32 v26, v26, v66
s_mov_b32 s13, 0xffff0000
v_cvt_pk_bf16_f32 v9, v8, v10
v_lshlrev_b32 v10, 16, v9
v_and_b32 v11, s13, v9
v_cvt_pk_bf16_f32 v13, v12, v14
v_lshlrev_b32 v14, 16, v13
v_and_b32 v15, s13, v13
v_cvt_pk_bf16_f32 v17, v16, v18
v_lshlrev_b32 v18, 16, v17
v_and_b32 v19, s13, v17
v_cvt_pk_bf16_f32 v21, v20, v22
v_lshlrev_b32 v22, 16, v21
v_and_b32 v23, s13, v21
v_cvt_pk_bf16_f32 v25, v24, v26
v_lshlrev_b32 v26, 16, v25
v_and_b32 v27, s13, v25
v_lshlrev_b32 v5, 3, v0
v_add_u32 v5, 156160, v5
ds_write_b64 v5, v[10:11] offset:0
ds_write_b64 v5, v[14:15] offset:512
ds_write_b64 v5, v[18:19] offset:1024
ds_write_b64 v5, v[22:23] offset:1536
ds_write_b64 v5, v[26:27] offset:2048
s_waitcnt lgkmcnt(0)
s_branch L_p0_join
L_role_mod:
s_mov_b32 s11, s84
s_mov_b32 s12, s85
s_mul_i32 s13, s11, 3840
s_lshl_b32 s72, s12, 6
s_add_u32 s13, s13, s72
s_lshl_b32 s13, s13, 3
s_add_u32 s76, s13, 262144
s_cmp_lt_u32 s2, 240
s_cselect_b32 s76, s76, 0x40000000
v_lshrrev_b32 v20, 4, v0
v_lshlrev_b32 v21, 5, v20
v_and_b32 v22, 15, v0
v_lshrrev_b32 v23, 2, v22
v_lshl_add_u32 v23, v20, 3, v23
v_lshlrev_b32 v23, 7, v23
v_and_b32 v24, 3, v22
v_lshl_add_u32 v23, v24, 3, v23
v_add_u32 v23, 122880, v23
v_lshlrev_b32 v25, 4, v20
v_add_u32 v25, 158720, v25
s_waitcnt vmcnt(20)
v_readfirstlane_b32 s11, v251
s_nop 3
s_mul_i32 s8, s11, 0x9e3779b1
s_add_u32 s8, s8, 0x7f4a7c15
s_mov_b32 s13, 0xffff0000
v_lshlrev_b32 v10, 16, v8
v_and_b32 v11, s13, v8
v_lshlrev_b32 v12, 16, v9
v_and_b32 v13, s13, v9
v_mul_f32 v14, 0xbfb8aa3b, v10
v_mul_f32 v15, 0xbfb8aa3b, v11
v_mul_f32 v16, 0xbfb8aa3b, v12
v_mul_f32 v17, 0xbfb8aa3b, v13
v_exp_f32 v14, v14
v_exp_f32 v15, v15
v_exp_f32 v16, v16
v_exp_f32 v17, v17
v_add_f32 v14, 1.0, v14
v_add_f32 v15, 1.0, v15
v_add_f32 v16, 1.0, v16
v_add_f32 v17, 1.0, v17
v_rcp_f32 v14, v14
v_rcp_f32 v15, v15
v_rcp_f32 v16, v16
v_rcp_f32 v17, v17
v_mul_f32 v10, v10, v14
v_mul_f32 v11, v11, v15
v_mul_f32 v12, v12, v16
v_mul_f32 v13, v13, v17
v_cvt_pk_bf16_f32 v10, v10, v11
v_cvt_pk_bf16_f32 v11, v12, v13
v_add_u32 v5, 158720, v5
ds_write_b64 v5, v[10:11]
s_waitcnt lgkmcnt(0)
s_waitcnt vmcnt(0)
ds_read_b128 v[64:67], v25 offset:0
ds_read_b64_tr_b16 v[48:49], v23 offset:0
ds_read_b64_tr_b16 v[50:51], v23 offset:512
ds_read_b64_tr_b16 v[52:53], v23 offset:32
ds_read_b64_tr_b16 v[54:55], v23 offset:544
ds_read_b64_tr_b16 v[56:57], v23 offset:64
ds_read_b64_tr_b16 v[58:59], v23 offset:576
ds_read_b64_tr_b16 v[60:61], v23 offset:96
ds_read_b64_tr_b16 v[62:63], v23 offset:608
s_waitcnt lgkmcnt(6)
v_mfma_f32_16x16x32_bf16 v[32:35], v[48:51], v[64:67], 0
s_waitcnt lgkmcnt(4)
v_mfma_f32_16x16x32_bf16 v[36:39], v[52:55], v[64:67], 0
s_waitcnt lgkmcnt(2)
v_mfma_f32_16x16x32_bf16 v[40:43], v[56:59], v[64:67], 0
s_waitcnt lgkmcnt(0)
v_mfma_f32_16x16x32_bf16 v[44:47], v[60:63], v[64:67], 0
ds_read_b128 v[68:71], v25 offset:64
ds_read_b64_tr_b16 v[48:49], v23 offset:4096
ds_read_b64_tr_b16 v[50:51], v23 offset:4608
ds_read_b64_tr_b16 v[52:53], v23 offset:4128
ds_read_b64_tr_b16 v[54:55], v23 offset:4640
ds_read_b64_tr_b16 v[56:57], v23 offset:4160
ds_read_b64_tr_b16 v[58:59], v23 offset:4672
ds_read_b64_tr_b16 v[60:61], v23 offset:4192
ds_read_b64_tr_b16 v[62:63], v23 offset:4704
s_waitcnt lgkmcnt(6)
v_mfma_f32_16x16x32_bf16 v[32:35], v[48:51], v[68:71], v[32:35]
s_waitcnt lgkmcnt(4)
v_mfma_f32_16x16x32_bf16 v[36:39], v[52:55], v[68:71], v[36:39]
s_waitcnt lgkmcnt(2)
v_mfma_f32_16x16x32_bf16 v[40:43], v[56:59], v[68:71], v[40:43]
s_waitcnt lgkmcnt(0)
v_mfma_f32_16x16x32_bf16 v[44:47], v[60:63], v[68:71], v[44:47]
ds_read_b128 v[64:67], v25 offset:128
ds_read_b64_tr_b16 v[48:49], v23 offset:8192
ds_read_b64_tr_b16 v[50:51], v23 offset:8704
ds_read_b64_tr_b16 v[52:53], v23 offset:8224
ds_read_b64_tr_b16 v[54:55], v23 offset:8736
ds_read_b64_tr_b16 v[56:57], v23 offset:8256
ds_read_b64_tr_b16 v[58:59], v23 offset:8768
ds_read_b64_tr_b16 v[60:61], v23 offset:8288
ds_read_b64_tr_b16 v[62:63], v23 offset:8800
s_waitcnt lgkmcnt(6)
v_mfma_f32_16x16x32_bf16 v[32:35], v[48:51], v[64:67], v[32:35]
s_waitcnt lgkmcnt(4)
v_mfma_f32_16x16x32_bf16 v[36:39], v[52:55], v[64:67], v[36:39]
s_waitcnt lgkmcnt(2)
v_mfma_f32_16x16x32_bf16 v[40:43], v[56:59], v[64:67], v[40:43]
s_waitcnt lgkmcnt(0)
v_mfma_f32_16x16x32_bf16 v[44:47], v[60:63], v[64:67], v[44:47]
ds_read_b128 v[68:71], v25 offset:192
ds_read_b64_tr_b16 v[48:49], v23 offset:12288
ds_read_b64_tr_b16 v[50:51], v23 offset:12800
ds_read_b64_tr_b16 v[52:53], v23 offset:12320
ds_read_b64_tr_b16 v[54:55], v23 offset:12832
ds_read_b64_tr_b16 v[56:57], v23 offset:12352
ds_read_b64_tr_b16 v[58:59], v23 offset:12864
ds_read_b64_tr_b16 v[60:61], v23 offset:12384
ds_read_b64_tr_b16 v[62:63], v23 offset:12896
s_waitcnt lgkmcnt(6)
v_mfma_f32_16x16x32_bf16 v[32:35], v[48:51], v[68:71], v[32:35]
s_waitcnt lgkmcnt(4)
v_mfma_f32_16x16x32_bf16 v[36:39], v[52:55], v[68:71], v[36:39]
s_waitcnt lgkmcnt(2)
v_mfma_f32_16x16x32_bf16 v[40:43], v[56:59], v[68:71], v[40:43]
s_waitcnt lgkmcnt(0)
v_mfma_f32_16x16x32_bf16 v[44:47], v[60:63], v[68:71], v[44:47]
ds_read_b128 v[64:67], v25 offset:256
ds_read_b64_tr_b16 v[48:49], v23 offset:16384
ds_read_b64_tr_b16 v[50:51], v23 offset:16896
ds_read_b64_tr_b16 v[52:53], v23 offset:16416
ds_read_b64_tr_b16 v[54:55], v23 offset:16928
ds_read_b64_tr_b16 v[56:57], v23 offset:16448
ds_read_b64_tr_b16 v[58:59], v23 offset:16960
ds_read_b64_tr_b16 v[60:61], v23 offset:16480
ds_read_b64_tr_b16 v[62:63], v23 offset:16992
s_waitcnt lgkmcnt(6)
v_mfma_f32_16x16x32_bf16 v[32:35], v[48:51], v[64:67], v[32:35]
s_waitcnt lgkmcnt(4)
v_mfma_f32_16x16x32_bf16 v[36:39], v[52:55], v[64:67], v[36:39]
s_waitcnt lgkmcnt(2)
v_mfma_f32_16x16x32_bf16 v[40:43], v[56:59], v[64:67], v[40:43]
s_waitcnt lgkmcnt(0)
v_mfma_f32_16x16x32_bf16 v[44:47], v[60:63], v[64:67], v[44:47]
v_cmp_eq_u32 vcc, 1, v22
v_lshl_add_u32 v21, v22, 4, v21
s_mov_b32 exec_lo, 0x30003
s_mov_b32 exec_hi, 0x30003
v_cndmask_b32 v72, v32, v34, vcc
v_mov_b32 v73, s8
v_cndmask_b32 v74, v33, v35, vcc
v_mov_b32 v75, s8
buffer_store_dwordx4 v[72:75], v21, s[40:43], s76 offen offset:0 sc1
v_cndmask_b32 v76, v36, v38, vcc
v_mov_b32 v77, s8
v_cndmask_b32 v78, v37, v39, vcc
v_mov_b32 v79, s8
buffer_store_dwordx4 v[76:79], v21, s[40:43], s76 offen offset:128 sc1
v_cndmask_b32 v80, v40, v42, vcc
v_mov_b32 v81, s8
v_cndmask_b32 v82, v41, v43, vcc
v_mov_b32 v83, s8
buffer_store_dwordx4 v[80:83], v21, s[40:43], s76 offen offset:256 sc1
v_cndmask_b32 v84, v44, v46, vcc
v_mov_b32 v85, s8
v_cndmask_b32 v86, v45, v47, vcc
v_mov_b32 v87, s8
buffer_store_dwordx4 v[84:87], v21, s[40:43], s76 offen offset:384 sc1
s_mov_b64 exec, -1
v_mul_u32_u24 v5, 6554, v0
v_lshrrev_b32 v5, 16, v5
v_mul_u32_u24 v6, 10, v5
v_sub_u32 v6, v0, v6
v_mul_u32_u24 v5, 3840, v5
v_lshl_add_u32 v5, v6, 6, v5
v_add_u32 v5, 703, v5
v_lshlrev_b32 v5, 3, v5
v_add_u32 v5, 262148, v5
s_mov_b32 exec_lo, 0xffffffff
s_mov_b32 exec_hi, 0xff
s_mov_b32 s73, 200000
L_probe_7:
buffer_load_dword v6, v5, s[40:43], 0 offen sc1
s_waitcnt vmcnt(0)
v_cmp_ne_u32 vcc, s8, v6
s_sub_u32 s73, s73, 1
s_cmp_eq_u32 s73, 0
s_cbranch_scc1 L_probed_8
s_nop 0
s_cbranch_vccnz L_probe_7
L_probed_8:
s_mov_b64 exec, -1
s_mov_b32 s76, 640
v_lshlrev_b32 v5, 4, v0
s_lshl_b32 s11, s76, 3
s_add_u32 s11, s11, 262144
s_mov_b32 s73, 200000
L_gath_9:
s_mov_b32 s12, s11
buffer_load_dwordx4 v[8:11], v5, s[40:43], s12 offen offset:0 sc1
buffer_load_dwordx4 v[12:15], v5, s[40:43], s12 offen offset:1024 sc1
buffer_load_dwordx4 v[16:19], v5, s[40:43], s12 offen offset:2048 sc1
buffer_load_dwordx4 v[20:23], v5, s[40:43], s12 offen offset:3072 sc1
s_add_u32 s13, s12, 4096
buffer_load_dwordx4 v[24:27], v5, s[40:43], s13 offen sc1
s_add_u32 s12, s12, 30720
buffer_load_dwordx4 v[28:31], v5, s[40:43], s12 offen offset:0 sc1
buffer_load_dwordx4 v[32:35], v5, s[40:43], s12 offen offset:1024 sc1
buffer_load_dwordx4 v[36:39], v5, s[40:43], s12 offen offset:2048 sc1
buffer_load_dwordx4 v[40:43], v5, s[40:43], s12 offen offset:3072 sc1
s_add_u32 s13, s12, 4096
buffer_load_dwordx4 v[44:47], v5, s[40:43], s13 offen sc1
s_add_u32 s12, s12, 30720
buffer_load_dwordx4 v[48:51], v5, s[40:43], s12 offen offset:0 sc1
buffer_load_dwordx4 v[52:55], v5, s[40:43], s12 offen offset:1024 sc1
buffer_load_dwordx4 v[56:59], v5, s[40:43], s12 offen offset:2048 sc1
buffer_load_dwordx4 v[60:63], v5, s[40:43], s12 offen offset:3072 sc1
s_add_u32 s13, s12, 4096
buffer_load_dwordx4 v[64:67], v5, s[40:43], s13 offen sc1
s_add_u32 s12, s12, 30720
buffer_load_dwordx4 v[68:71], v5, s[40:43], s12 offen offset:0 sc1
buffer_load_dwordx4 v[72:75], v5, s[40:43], s12 offen offset:1024 sc1
buffer_load_dwordx4 v[76:79], v5, s[40:43], s12 offen offset:2048 sc1
buffer_load_dwordx4 v[80:83], v5, s[40:43], s12 offen offset:3072 sc1
s_add_u32 s13, s12, 4096
buffer_load_dwordx4 v[84:87], v5, s[40:43], s13 offen sc1
s_waitcnt vmcnt(0)
v_max_u32 v6, v9, v11
v_min_u32 v7, v9, v11
v_max3_u32 v6, v6, v13, v15
v_min3_u32 v7, v7, v13, v15
v_max3_u32 v6, v6, v17, v19
v_min3_u32 v7, v7, v17, v19
v_max3_u32 v6, v6, v21, v23
v_min3_u32 v7, v7, v21, v23
v_max3_u32 v6, v6, v25, v27
v_min3_u32 v7, v7, v25, v27
v_max3_u32 v6, v6, v29, v31
v_min3_u32 v7, v7, v29, v31
v_max3_u32 v6, v6, v33, v35
v_min3_u32 v7, v7, v33, v35
v_max3_u32 v6, v6, v37, v39
v_min3_u32 v7, v7, v37, v39
v_max3_u32 v6, v6, v41, v43
v_min3_u32 v7, v7, v41, v43
v_max3_u32 v6, v6, v45, v47
v_min3_u32 v7, v7, v45, v47
v_max3_u32 v6, v6, v49, v51
v_min3_u32 v7, v7, v49, v51
v_max3_u32 v6, v6, v53, v55
v_min3_u32 v7, v7, v53, v55
v_max3_u32 v6, v6, v57, v59
v_min3_u32 v7, v7, v57, v59
v_max3_u32 v6, v6, v61, v63
v_min3_u32 v7, v7, v61, v63
v_max3_u32 v6, v6, v65, v67
v_min3_u32 v7, v7, v65, v67
v_max3_u32 v6, v6, v69, v71
v_min3_u32 v7, v7, v69, v71
v_max3_u32 v6, v6, v73, v75
v_min3_u32 v7, v7, v73, v75
v_max3_u32 v6, v6, v77, v79
v_min3_u32 v7, v7, v77, v79
v_max3_u32 v6, v6, v81, v83
v_min3_u32 v7, v7, v81, v83
v_max3_u32 v6, v6, v85, v87
v_min3_u32 v7, v7, v85, v87
v_cmp_ne_u32 vcc, s8, v6
v_cmp_ne_u32 s[74:75], s8, v7
s_nop 3
s_or_b64 vcc, vcc, s[74:75]
s_sub_u32 s73, s73, 1
s_cmp_eq_u32 s73, 0
s_cbranch_scc1 L_gathd_10
s_cbranch_vccnz L_gath_9
L_gathd_10:
v_add_f32 v8, v8, v28
v_add_f32 v48, v48, v68
v_add_f32 v8, v8, v48
v_add_f32 v10, v10, v30
v_add_f32 v50, v50, v70
v_add_f32 v10, v10, v50
v_add_f32 v12, v12, v32
v_add_f32 v52, v52, v72
v_add_f32 v12, v12, v52
v_add_f32 v14, v14, v34
v_add_f32 v54, v54, v74
v_add_f32 v14, v14, v54
v_add_f32 v16, v16, v36
v_add_f32 v56, v56, v76
v_add_f32 v16, v16, v56
v_add_f32 v18, v18, v38
v_add_f32 v58, v58, v78
v_add_f32 v18, v18, v58
v_add_f32 v20, v20, v40
v_add_f32 v60, v60, v80
v_add_f32 v20, v20, v60
v_add_f32 v22, v22, v42
v_add_f32 v62, v62, v82
v_add_f32 v22, v22, v62
v_add_f32 v24, v24, v44
v_add_f32 v64, v64, v84
v_add_f32 v24, v24, v64
v_add_f32 v26, v26, v46
v_add_f32 v66, v66, v86
v_add_f32 v26, v26, v66
s_mov_b32 s13, 0xffff0000
v_cvt_pk_bf16_f32 v9, v8, v10
v_lshlrev_b32 v8, 16, v9
v_and_b32 v10, s13, v9
v_add_f32 v8, 1.0, v8
v_add_f32 v10, 1.0, v10
v_cvt_pk_bf16_f32 v9, v8, v10
v_lshlrev_b32 v10, 16, v9
v_and_b32 v11, s13, v9
v_cvt_pk_bf16_f32 v13, v12, v14
v_lshlrev_b32 v12, 16, v13
v_and_b32 v14, s13, v13
v_add_f32 v12, 1.0, v12
v_add_f32 v14, 1.0, v14
v_cvt_pk_bf16_f32 v13, v12, v14
v_lshlrev_b32 v14, 16, v13
v_and_b32 v15, s13, v13
v_cvt_pk_bf16_f32 v17, v16, v18
v_lshlrev_b32 v16, 16, v17
v_and_b32 v18, s13, v17
v_add_f32 v16, 1.0, v16
v_add_f32 v18, 1.0, v18
v_cvt_pk_bf16_f32 v17, v16, v18
v_lshlrev_b32 v18, 16, v17
v_and_b32 v19, s13, v17
v_cvt_pk_bf16_f32 v21, v20, v22
v_lshlrev_b32 v20, 16, v21
v_and_b32 v22, s13, v21
v_add_f32 v20, 1.0, v20
v_add_f32 v22, 1.0, v22
v_cvt_pk_bf16_f32 v21, v20, v22
v_lshlrev_b32 v22, 16, v21
v_and_b32 v23, s13, v21
v_cvt_pk_bf16_f32 v25, v24, v26
v_lshlrev_b32 v24, 16, v25
v_and_b32 v26, s13, v25
v_add_f32 v24, 1.0, v24
v_add_f32 v26, 1.0, v26
v_cvt_pk_bf16_f32 v25, v24, v26
v_lshlrev_b32 v26, 16, v25
v_and_b32 v27, s13, v25
v_lshlrev_b32 v5, 3, v0
v_add_u32 v5, 153600, v5
ds_write_b64 v5, v[10:11] offset:0
ds_write_b64 v5, v[14:15] offset:512
ds_write_b64 v5, v[18:19] offset:1024
ds_write_b64 v5, v[22:23] offset:1536
ds_write_b64 v5, v[26:27] offset:2048
s_waitcnt lgkmcnt(0)
s_branch L_p0_join
L_role_wq:
v_lshrrev_b32 v20, 4, v0
v_and_b32 v21, 15, v0
v_and_b32 v22, 3, v21
v_lshrrev_b32 v23, 2, v21
v_mul_u32_u24 v23, 240, v23
v_mul_u32_u24 v24, 40, v20
v_lshl_add_u32 v24, v22, 3, v24
v_add_u32 v24, v24, v23
v_add_u32 v24, 143360, v24
v_mul_u32_u24 v25, 40, v20
v_add_u32 v25, 120, v25
v_lshl_add_u32 v25, v22, 3, v25
v_mul_u32_u24 v28, 40, v22
v_add_u32 v28, 32, v28
v_cmp_eq_u32 vcc, 0, v20
s_nop 1
v_cndmask_b32 v25, v25, v28, vcc
v_and_b32 v28, 1, v22
v_mul_u32_u24 v28, 40, v28
v_add_u32 v28, 192, v28
v_cmp_eq_u32 vcc, 3, v20
s_nop 1
v_cndmask_b32 v25, v25, v28, vcc
v_add_u32 v25, v25, v23
v_add_u32 v25, 143360, v25
s_mul_i32 s12, s5, 153600
s_add_u32 s12, s12, 24117248
v_lshlrev_b32 v26, 10, v20
v_lshl_add_u32 v26, v21, 4, v26
v_add_u32 v26, s12, v26
v_add_u32 v27, 4096, v26
v_mov_b32 v29, 256
v_mov_b32 v30, 128
v_cndmask_b32 v29, v29, v30, vcc
v_cmp_le_u32 s[74:75], 8, v21
s_nop 3
s_and_b64 vcc, vcc, s[74:75]
v_mov_b32 v30, 0x40000000
v_cndmask_b32 v27, v27, v30, vcc
s_mul_i32 s84, s4, 5
s_waitcnt vmcnt(0)
v_readfirstlane_b32 s11, v251
s_nop 3
s_mul_i32 s8, s11, 0x9e3779b1
s_add_u32 s8, s8, 0x7f4a7c15
ds_read_b64_tr_b16 v[32:33], v24 offset:0
ds_read_b64_tr_b16 v[34:35], v24 offset:960
ds_read_b64_tr_b16 v[36:37], v25 offset:0
ds_read_b64_tr_b16 v[38:39], v25 offset:960
ds_read_b64_tr_b16 v[40:41], v24 offset:1920
ds_read_b64_tr_b16 v[42:43], v24 offset:2880
ds_read_b64_tr_b16 v[44:45], v25 offset:1920
ds_read_b64_tr_b16 v[46:47], v25 offset:2880
ds_read_b64_tr_b16 v[48:49], v24 offset:3840
ds_read_b64_tr_b16 v[50:51], v24 offset:4800
ds_read_b64_tr_b16 v[52:53], v25 offset:3840
ds_read_b64_tr_b16 v[54:55], v25 offset:4800
ds_read_b64_tr_b16 v[56:57], v24 offset:5760
ds_read_b64_tr_b16 v[58:59], v24 offset:6720
ds_read_b64_tr_b16 v[60:61], v25 offset:5760
ds_read_b64_tr_b16 v[62:63], v25 offset:6720
ds_read_b64_tr_b16 v[64:65], v24 offset:7680
ds_read_b64_tr_b16 v[66:67], v24 offset:8640
ds_read_b64_tr_b16 v[68:69], v25 offset:7680
ds_read_b64_tr_b16 v[70:71], v25 offset:8640
s_add_u32 s85, s84, 0
s_and_b32 s87, s85, 3
s_lshr_b32 s86, s85, 2
s_mul_i32 s86, s86, 7680
s_lshl_b32 s88, s87, 8
v_add_u32 v9, s88, v26
v_mad_u32_u24 v10, s87, v29, v27
s_waitcnt lgkmcnt(15)
buffer_store_dwordx4 v[32:35], v9, s[40:43], s86 offen sc1
buffer_store_dwordx4 v[36:39], v10, s[40:43], s86 offen sc1
s_add_u32 s85, s84, 1
s_and_b32 s87, s85, 3
s_lshr_b32 s86, s85, 2
s_mul_i32 s86, s86, 7680
s_lshl_b32 s88, s87, 8
v_add_u32 v9, s88, v26
v_mad_u32_u24 v10, s87, v29, v27
s_waitcnt lgkmcnt(12)
buffer_store_dwordx4 v[40:43], v9, s[40:43], s86 offen sc1
buffer_store_dwordx4 v[44:47], v10, s[40:43], s86 offen sc1
s_add_u32 s85, s84, 2
s_and_b32 s87, s85, 3
s_lshr_b32 s86, s85, 2
s_mul_i32 s86, s86, 7680
s_lshl_b32 s88, s87, 8
v_add_u32 v9, s88, v26
v_mad_u32_u24 v10, s87, v29, v27
s_waitcnt lgkmcnt(8)
buffer_store_dwordx4 v[48:51], v9, s[40:43], s86 offen sc1
buffer_store_dwordx4 v[52:55], v10, s[40:43], s86 offen sc1
s_add_u32 s85, s84, 3
s_and_b32 s87, s85, 3
s_lshr_b32 s86, s85, 2
s_mul_i32 s86, s86, 7680
s_lshl_b32 s88, s87, 8
v_add_u32 v9, s88, v26
v_mad_u32_u24 v10, s87, v29, v27
s_waitcnt lgkmcnt(4)
buffer_store_dwordx4 v[56:59], v9, s[40:43], s86 offen sc1
buffer_store_dwordx4 v[60:63], v10, s[40:43], s86 offen sc1
s_add_u32 s85, s84, 4
s_and_b32 s87, s85, 3
s_lshr_b32 s86, s85, 2
s_mul_i32 s86, s86, 7680
s_lshl_b32 s88, s87, 8
v_add_u32 v9, s88, v26
v_mad_u32_u24 v10, s87, v29, v27
s_waitcnt lgkmcnt(0)
buffer_store_dwordx4 v[64:67], v9, s[40:43], s86 offen sc1
buffer_store_dwordx4 v[68:71], v10, s[40:43], s86 offen sc1
s_waitcnt vmcnt(0)
s_add_u32 s72, s8, 1
v_mov_b32 v1, s72
s_mov_b64 exec, 1
buffer_store_dword v1, off, s[40:43], s10 sc1
s_mov_b64 exec, -1
v_lshl_add_u32 v5, v0, 4, s5
v_lshl_add_u32 v5, v5, 2, 3
v_lshlrev_b32 v5, 7, v5
v_add_u32 v5, 8192, v5
s_mov_b32 exec_lo, 0xffff
s_mov_b32 exec_hi, 0x0
s_add_u32 s72, s8, 1
s_mov_b32 s73, 200000
L_poll_11:
buffer_load_dword v6, v5, s[40:43], 0 offen sc1
s_waitcnt vmcnt(0)
v_subrev_u32 v6, s72, v6
v_cmp_lt_u32 vcc, 14, v6
s_sub_u32 s73, s73, 1
s_cmp_eq_u32 s73, 0
s_cbranch_scc1 L_polld_12
s_nop 0
s_cbranch_vccnz L_poll_11
L_polld_12:
s_mov_b64 exec, -1
v_lshlrev_b32 v8, 4, v0
s_mul_i32 s83, s5, 153600
s_add_u32 s83, s83, 24117248
s_mov_b32 m0, 0
s_add_u32 s91, s83, 0
buffer_load_dwordx4 v8, s[40:43], s91 offen sc1 lds
s_mov_b32 m0, 1024
s_add_u32 s91, s83, 1024
buffer_load_dwordx4 v8, s[40:43], s91 offen sc1 lds
s_mov_b32 m0, 2048
s_add_u32 s91, s83, 2048
buffer_load_dwordx4 v8, s[40:43], s91 offen sc1 lds
s_mov_b32 m0, 3072
s_add_u32 s91, s83, 3072
buffer_load_dwordx4 v8, s[40:43], s91 offen sc1 lds
s_mov_b32 m0, 4096
s_add_u32 s91, s83, 4096
buffer_load_dwordx4 v8, s[40:43], s91 offen sc1 lds
s_mov_b32 m0, 5120
s_add_u32 s91, s83, 5120
buffer_load_dwordx4 v8, s[40:43], s91 offen sc1 lds
s_mov_b32 m0, 6144
s_add_u32 s91, s83, 6144
buffer_load_dwordx4 v8, s[40:43], s91 offen sc1 lds
s_mov_b32 m0, 7168
s_add_u32 s91, s83, 7168
buffer_load_dwordx4 v8, s[40:43], s91 offen sc1 lds
s_mov_b32 m0, 8192
s_add_u32 s91, s83, 8192
buffer_load_dwordx4 v8, s[40:43], s91 offen sc1 lds
s_mov_b32 m0, 9216
s_add_u32 s91, s83, 9216
buffer_load_dwordx4 v8, s[40:43], s91 offen sc1 lds
s_mov_b32 m0, 10240
s_add_u32 s91, s83, 10240
buffer_load_dwordx4 v8, s[40:43], s91 offen sc1 lds
s_mov_b32 m0, 11264
s_add_u32 s91, s83, 11264
buffer_load_dwordx4 v8, s[40:43], s91 offen sc1 lds
s_mov_b32 m0, 12288
s_add_u32 s91, s83, 12288
buffer_load_dwordx4 v8, s[40:43], s91 offen sc1 lds
s_mov_b32 m0, 13312
s_add_u32 s91, s83, 13312
buffer_load_dwordx4 v8, s[40:43], s91 offen sc1 lds
s_mov_b32 m0, 14336
s_add_u32 s91, s83, 14336
buffer_load_dwordx4 v8, s[40:43], s91 offen sc1 lds
s_mov_b32 m0, 15360
s_add_u32 s91, s83, 15360
buffer_load_dwordx4 v8, s[40:43], s91 offen sc1 lds
s_mov_b32 m0, 16384
s_add_u32 s91, s83, 16384
buffer_load_dwordx4 v8, s[40:43], s91 offen sc1 lds
s_mov_b32 m0, 17408
s_add_u32 s91, s83, 17408
buffer_load_dwordx4 v8, s[40:43], s91 offen sc1 lds
s_mov_b32 m0, 18432
s_add_u32 s91, s83, 18432
buffer_load_dwordx4 v8, s[40:43], s91 offen sc1 lds
s_mov_b32 m0, 19456
s_add_u32 s91, s83, 19456
buffer_load_dwordx4 v8, s[40:43], s91 offen sc1 lds
s_mov_b32 m0, 20480
s_add_u32 s91, s83, 20480
buffer_load_dwordx4 v8, s[40:43], s91 offen sc1 lds
s_mov_b32 m0, 21504
s_add_u32 s91, s83, 21504
buffer_load_dwordx4 v8, s[40:43], s91 offen sc1 lds
s_mov_b32 m0, 22528
s_add_u32 s91, s83, 22528
buffer_load_dwordx4 v8, s[40:43], s91 offen sc1 lds
s_mov_b32 m0, 23552
s_add_u32 s91, s83, 23552
buffer_load_dwordx4 v8, s[40:43], s91 offen sc1 lds
s_mov_b32 m0, 24576
s_add_u32 s91, s83, 24576
buffer_load_dwordx4 v8, s[40:43], s91 offen sc1 lds
s_mov_b32 m0, 25600
s_add_u32 s91, s83, 25600
buffer_load_dwordx4 v8, s[40:43], s91 offen sc1 lds
s_mov_b32 m0, 26624
s_add_u32 s91, s83, 26624
buffer_load_dwordx4 v8, s[40:43], s91 offen sc1 lds
s_mov_b32 m0, 27648
s_add_u32 s91, s83, 27648
buffer_load_dwordx4 v8, s[40:43], s91 offen sc1 lds
s_mov_b32 m0, 28672
s_add_u32 s91, s83, 28672
buffer_load_dwordx4 v8, s[40:43], s91 offen sc1 lds
s_mov_b32 m0, 29696
s_add_u32 s91, s83, 29696
buffer_load_dwordx4 v8, s[40:43], s91 offen sc1 lds
s_waitcnt vmcnt(0)
L_p0_join:
s_barrier
L_p1:
v_lshlrev_b32 v8, 4, v0
v_add_u32 v9, 20480, v8
s_lshl_b32 s11, s4, 3
s_lshl_b32 s12, s3, 1
s_add_u32 s11, s11, s12
s_mul_i32 s11, s11, 20480
s_add_u32 s78, s11, 1048576
buffer_load_dwordx4 v[84:87], v8, s[40:43], s78 offen offset:0 sc1
buffer_load_dwordx4 v[88:91], v9, s[40:43], s78 offen offset:0 sc1
buffer_load_dwordx4 v[92:95], v8, s[40:43], s78 offen offset:1024 sc1
buffer_load_dwordx4 v[96:99], v9, s[40:43], s78 offen offset:1024 sc1
v_mov_b32 v10, v8
v_lshrrev_b32 v1, 4, v0
v_and_b32 v2, 7, v0
v_lshlrev_b32 v11, 7, v1
v_lshl_add_u32 v11, v2, 4, v11
v_lshlrev_b32 v12, 5, v1
v_add_u32 v12, 153600, v12
ds_read_b128 v[168:171], v12 offset:0
ds_read_b128 v[172:175], v12 offset:16
ds_read_b128 v[176:179], v12 offset:2560
ds_read_b128 v[180:183], v12 offset:2576
ds_read_b128 v[184:187], v12 offset:128
ds_read_b128 v[188:191], v12 offset:144
ds_read_b128 v[192:195], v12 offset:2688
ds_read_b128 v[196:199], v12 offset:2704
ds_read_b128 a[88:91], v10 offset:0
ds_read_b128 a[92:95], v10 offset:1024
ds_read_b128 a[96:99], v10 offset:2048
ds_read_b128 a[100:103], v10 offset:3072
ds_read_b128 a[104:107], v10 offset:4096
ds_read_b128 a[108:111], v10 offset:5120
ds_read_b128 a[112:115], v10 offset:6144
ds_read_b128 a[116:119], v11 offset:7168
buffer_load_dwordx4 v[100:103], v8, s[40:43], s78 offen offset:2048 sc1
buffer_load_dwordx4 v[104:107], v9, s[40:43], s78 offen offset:2048 sc1
buffer_load_dwordx4 v[108:111], v8, s[40:43], s78 offen offset:3072 sc1
buffer_load_dwordx4 v[112:115], v9, s[40:43], s78 offen offset:3072 sc1
s_add_u32 s78, s78, 4096
s_mul_i32 s11, s3, 7680
v_add_u32 v13, s11, v10
v_add_u32 v14, s11, v11
s_lshl_b32 s11, s3, 7
v_add_u32 v15, s11, v12
s_lshl_b32 s11, s4, 3
s_sub_u32 s12, s11, 1
s_cmp_eq_u32 s4, 0
s_cselect_b32 s11, 0, s12
s_mul_i32 s11, s11, 20480
s_lshl_b32 s12, s3, 10
s_add_u32 s11, s11, s12
s_add_u32 s79, s11, 1048576
s_mul_i32 s83, s5, 153600
s_add_u32 s83, s83, 24117248
s_lshl_b32 s90, s3, 10
s_add_u32 s83, s83, s90
buffer_load_dwordx4 v[116:119], v8, s[40:43], s78 offen offset:0 sc1
buffer_load_dwordx4 v[120:123], v9, s[40:43], s78 offen offset:0 sc1
buffer_load_dwordx4 v[124:127], v8, s[40:43], s78 offen offset:1024 sc1
buffer_load_dwordx4 v[128:131], v9, s[40:43], s78 offen offset:1024 sc1
s_mov_b32 s44, s24
s_mov_b32 s45, s25
s_mov_b32 s46, 1966080
s_mov_b32 s47, 0x20000
s_mov_b32 s48, s26
s_mov_b32 s49, s27
s_mov_b32 s50, 1966080
s_mov_b32 s51, 0x20000
s_mov_b32 s52, s28
s_mov_b32 s53, s29
s_mov_b32 s54, 1966080
s_mov_b32 s55, 0x20000
s_cmp_eq_u32 s3, 0
s_cselect_b32 s20, s24, s26
s_cselect_b32 s21, s25, s27
s_cmp_lt_u32 s3, 2
s_cselect_b32 s20, s20, s28
s_cselect_b32 s21, s21, s29
s_mov_b32 s22, 1966080
s_mov_b32 s23, 0x20000
s_movk_i32 s32, 1280
s_cselect_b32 s32, 3072, s32
s_mul_i32 s11, s4, 5
s_add_u32 s18, s11, s3
s_mov_b32 s19, s18
s_lshl_b32 s12, s4, 1
s_lshr_b32 s13, s5, 3
s_add_u32 s12, s12, s13
s_mul_i32 s12, s12, 6
s_add_u32 s31, s12, s3
s_add_u32 s31, s31, 2
s_add_u32 s11, s11, 4
s_add_u32 s12, s12, s3
s_sub_u32 s12, s12, 2
s_cmp_lt_u32 s3, 2
s_cselect_b32 s30, s11, s12
v_mul_u32_u24 v1, 5462, v0
v_lshrrev_b32 v1, 16, v1
v_mul_u32_u24 v2, 12, v1
v_sub_u32 v2, v0, v2
v_mul_u32_u24 v1, 3072, v1
v_lshl_add_u32 v1, v2, 4, v1
s_mul_i32 s11, s5, 192
v_add_u32 v16, s11, v1
v_mul_u32_u24 v1, 6554, v0
v_lshrrev_b32 v1, 16, v1
v_mul_u32_u24 v2, 10, v1
v_sub_u32 v2, v0, v2
v_mul_u32_u24 v1, 1280, v1
v_lshl_add_u32 v1, v2, 4, v1
s_and_b32 s11, s5, 7
s_mul_i32 s11, s11, 160
v_add_u32 v17, s11, v1
v_mov_b32 v3, 0x40000000
v_cmp_gt_u32 vcc, 60, v0
s_nop 1
v_cndmask_b32 v16, v3, v16, vcc
v_cndmask_b32 v17, v3, v17, vcc
s_cmp_lt_u32 s3, 2
s_cselect_b64 s[74:75], -1, 0
v_cndmask_b32 v18, v17, v16, s[74:75]
s_and_b32 s80, s5, 7
s_lshr_b32 s81, s5, 3
s_mul_i32 s28, s9, 683
s_lshr_b32 s28, s28, 16
s_mul_i32 s11, s28, 96
s_sub_u32 s11, s9, s11
s_mul_i32 s29, s11, 2731
s_lshr_b32 s29, s29, 16
s_mul_i32 s12, s29, 24
s_sub_u32 s82, s11, s12
s_mul_i32 s11, s80, 80
s_movk_i32 s96, 3200
s_cmp_eq_u32 s3, 0
s_cselect_b32 s96, 1280, s96
s_cmp_eq_u32 s3, 1
s_cselect_b32 s96, 2560, s96
s_add_u32 s96, s96, s11
s_movk_i32 s97, 1920
s_cmp_lt_u32 s3, 2
s_cselect_b32 s97, 2560, s97
s_and_b32 s11, s3, 1
s_mul_i32 s11, s11, 80
s_add_u32 s97, s97, s11
s_mul_i32 s11, s29, 160
s_cmp_lt_u32 s9, 192
s_cselect_b32 s11, s11, 0
s_add_u32 s97, s97, s11
s_lshl_b32 s96, s96, 3
s_add_u32 s96, s96, 262144
s_lshl_b32 s97, s97, 3
s_add_u32 s97, s97, 262144
v_lshlrev_b32 v249, 4, v0
v_mov_b32 v1, 0x40000000
v_cmp_gt_u32 vcc, 40, v0
s_nop 1
v_cndmask_b32 v249, v1, v249, vcc
s_lshl_b32 s11, s4, 7
s_lshl_b32 s12, s81, 6
s_add_u32 s11, s11, s12
s_lshl_b32 s12, s3, 4
s_add_u32 s11, s11, s12
s_mul_i32 s11, s11, 1280
s_mul_i32 s12, s80, 160
s_add_u32 s33, s11, s12
v_and_b32 v2, 15, v0
v_lshrrev_b32 v3, 4, v0
v_mul_u32_u24 v250, 1280, v2
v_lshl_add_u32 v250, v3, 3, v250
buffer_load_dwordx4 v[132:135], v8, s[40:43], s78 offen offset:2048 sc1
buffer_load_dwordx4 v[136:139], v9, s[40:43], s78 offen offset:2048 sc1
buffer_load_dwordx4 v[140:143], v8, s[40:43], s78 offen offset:3072 sc1
buffer_load_dwordx4 v[144:147], v9, s[40:43], s78 offen offset:3072 sc1
s_add_u32 s78, s78, 4096
v_and_b32 v2, 15, v0
v_lshrrev_b32 v3, 4, v0
v_lshlrev_b32 v4, 2, v3
v_sub_u32 v4, v2, v4
v_subrev_u32 v5, 0, v4
v_and_b32 v6, 0xfffffff1, v5
v_cmp_eq_u32 s[56:57], 0, v6
v_add_u32 v5, 16, v5
v_and_b32 v6, 0xfffffff1, v5
v_cmp_eq_u32 s[64:65], 0, v6
v_subrev_u32 v5, 1, v4
v_and_b32 v6, 0xfffffff1, v5
v_cmp_eq_u32 s[58:59], 0, v6
v_add_u32 v5, 16, v5
v_and_b32 v6, 0xfffffff1, v5
v_cmp_eq_u32 s[66:67], 0, v6
v_subrev_u32 v5, 2, v4
v_and_b32 v6, 0xfffffff1, v5
v_cmp_eq_u32 s[60:61], 0, v6
v_add_u32 v5, 16, v5
v_and_b32 v6, 0xfffffff1, v5
v_cmp_eq_u32 s[68:69], 0, v6
v_subrev_u32 v5, 3, v4
v_and_b32 v6, 0xfffffff1, v5
v_cmp_eq_u32 s[62:63], 0, v6
v_add_u32 v5, 16, v5
v_and_b32 v6, 0xfffffff1, v5
v_cmp_eq_u32 s[70:71], 0, v6
v_cmp_eq_u32 s[92:93], 0, v3
v_cmp_eq_u32 s[94:95], 1, v3
v_lshlrev_b32 v2, 4, v2
v_lshrrev_b32 v4, 1, v3
v_lshl_add_u32 v4, v4, 8, v2
v_and_b32 v5, 1, v3
v_lshl_add_u32 v245, v5, 3, v4
v_add_u32 v5, 5, v3
v_lshrrev_b32 v6, 1, v5
v_lshl_add_u32 v6, v6, 8, v2
v_and_b32 v5, 1, v5
v_lshl_add_u32 v246, v5, 3, v6
v_mul_u32_u24 v7, 520, v3
v_add_u32 v7, 512, v7
v_add_u32 v247, v7, v2
v_bfe_u32 v1, v0, 1, 4
v_lshlrev_b32 v1, 4, v1
v_and_b32 v2, 1, v0
v_lshl_add_u32 v1, v2, 3, v1
s_and_b32 s11, s5, 7
v_add_u32 v1, s11, v1
v_lshl_add_u32 v1, v1, 2, 1
v_lshlrev_b32 v1, 7, v1
v_add_u32 v244, 8192, v1
s_waitcnt vmcnt(14)
s_waitcnt lgkmcnt(12)
v_fma_mix_f32 v200, v84, v168, v176 op_sel_hi:[1,0,0]
v_fma_mix_f32 v201, v84, v169, v177 op_sel:[1,0,0] op_sel_hi:[1,0,0]
v_fma_mix_f32 v202, v85, v170, v178 op_sel_hi:[1,0,0]
v_fma_mix_f32 v203, v85, v171, v179 op_sel:[1,0,0] op_sel_hi:[1,0,0]
v_cvt_pk_bf16_f32 v148, v200, v201
v_fma_mix_f32 v204, v86, v172, v180 op_sel_hi:[1,0,0]
v_fma_mix_f32 v205, v86, v173, v181 op_sel:[1,0,0] op_sel_hi:[1,0,0]
v_cvt_pk_bf16_f32 v149, v202, v203
v_fma_mix_f32 v206, v87, v174, v182 op_sel_hi:[1,0,0]
v_fma_mix_f32 v207, v87, v175, v183 op_sel:[1,0,0] op_sel_hi:[1,0,0]
v_cvt_pk_bf16_f32 v150, v204, v205
v_cvt_pk_bf16_f32 v151, v206, v207
v_fma_mix_f32 v200, v88, v168, v176 op_sel_hi:[1,0,0]
v_fma_mix_f32 v201, v88, v169, v177 op_sel:[1,0,0] op_sel_hi:[1,0,0]
v_fma_mix_f32 v202, v89, v170, v178 op_sel_hi:[1,0,0]
v_fma_mix_f32 v203, v89, v171, v179 op_sel:[1,0,0] op_sel_hi:[1,0,0]
v_cvt_pk_bf16_f32 v152, v200, v201
v_fma_mix_f32 v204, v90, v172, v180 op_sel_hi:[1,0,0]
v_fma_mix_f32 v205, v90, v173, v181 op_sel:[1,0,0] op_sel_hi:[1,0,0]
v_cvt_pk_bf16_f32 v153, v202, v203
v_fma_mix_f32 v206, v91, v174, v182 op_sel_hi:[1,0,0]
v_fma_mix_f32 v207, v91, v175, v183 op_sel:[1,0,0] op_sel_hi:[1,0,0]
v_cvt_pk_bf16_f32 v154, v204, v205
v_cvt_pk_bf16_f32 v155, v206, v207
buffer_load_dwordx4 v[84:87], v8, s[40:43], s78 offen offset:0 sc1
buffer_load_dwordx4 v[88:91], v9, s[40:43], s78 offen offset:0 sc1
s_waitcnt lgkmcnt(7)
v_mfma_f32_16x16x32_bf16 v[20:23], a[88:91], v[148:151], 0
ds_read_b128 v[168:171], v12 offset:256
s_waitcnt vmcnt(14)
v_fma_mix_f32 v200, v92, v184, v192 op_sel_hi:[1,0,0]
v_fma_mix_f32 v201, v92, v185, v193 op_sel:[1,0,0] op_sel_hi:[1,0,0]
v_mfma_f32_16x16x32_bf16 v[52:55], a[88:91], v[152:155], 0
ds_read_b128 a[218:221], v10 offset:7680
v_fma_mix_f32 v202, v93, v186, v194 op_sel_hi:[1,0,0]
s_add_u32 m0, s90, 61440
s_add_u32 s91, s83, 61440
buffer_load_dwordx4 v8, s[40:43], s91 offen sc1 lds
s_waitcnt lgkmcnt(8)
v_mfma_f32_16x16x32_bf16 v[24:27], a[92:95], v[148:151], 0
ds_read_b128 v[172:175], v12 offset:272
v_fma_mix_f32 v203, v93, v187, v195 op_sel:[1,0,0] op_sel_hi:[1,0,0]
v_cvt_pk_bf16_f32 v156, v200, v201
v_mfma_f32_16x16x32_bf16 v[56:59], a[92:95], v[152:155], 0
ds_read_b128 a[222:225], v10 offset:8704
v_fma_mix_f32 v204, v94, v188, v196 op_sel_hi:[1,0,0]
s_waitcnt lgkmcnt(9)
v_mfma_f32_16x16x32_bf16 v[28:31], a[96:99], v[148:151], 0
ds_read_b128 v[176:179], v12 offset:2816
v_fma_mix_f32 v205, v94, v189, v197 op_sel:[1,0,0] op_sel_hi:[1,0,0]
v_cvt_pk_bf16_f32 v157, v202, v203
v_mfma_f32_16x16x32_bf16 v[60:63], a[96:99], v[152:155], 0
ds_read_b128 a[226:229], v10 offset:9728
v_fma_mix_f32 v206, v95, v190, v198 op_sel_hi:[1,0,0]
s_waitcnt lgkmcnt(10)
v_mfma_f32_16x16x32_bf16 v[32:35], a[100:103], v[148:151], 0
ds_read_b128 v[180:183], v12 offset:2832
v_fma_mix_f32 v207, v95, v191, v199 op_sel:[1,0,0] op_sel_hi:[1,0,0]
v_cvt_pk_bf16_f32 v158, v204, v205
v_mfma_f32_16x16x32_bf16 v[64:67], a[100:103], v[152:155], 0
ds_read_b128 a[230:233], v10 offset:10752
v_cvt_pk_bf16_f32 v159, v206, v207
s_waitcnt lgkmcnt(11)
v_mfma_f32_16x16x32_bf16 v[36:39], a[104:107], v[148:151], 0
v_fma_mix_f32 v200, v96, v184, v192 op_sel_hi:[1,0,0]
v_fma_mix_f32 v201, v96, v185, v193 op_sel:[1,0,0] op_sel_hi:[1,0,0]
s_add_u32 m0, s90, 65536
s_add_u32 s91, s83, 65536
buffer_load_dwordx4 v8, s[40:43], s91 offen sc1 lds
v_mfma_f32_16x16x32_bf16 v[68:71], a[104:107], v[152:155], 0
ds_read_b128 a[234:237], v10 offset:11776
v_fma_mix_f32 v202, v97, v186, v194 op_sel_hi:[1,0,0]
s_waitcnt lgkmcnt(11)
v_mfma_f32_16x16x32_bf16 v[40:43], v[148:151], a[108:111], 0
v_fma_mix_f32 v203, v97, v187, v195 op_sel:[1,0,0] op_sel_hi:[1,0,0]
v_cvt_pk_bf16_f32 v160, v200, v201
v_mfma_f32_16x16x32_bf16 v[72:75], v[152:155], a[108:111], 0
ds_read_b128 a[238:241], v10 offset:12800
v_fma_mix_f32 v204, v98, v188, v196 op_sel_hi:[1,0,0]
s_waitcnt lgkmcnt(11)
v_mfma_f32_16x16x32_bf16 v[44:47], v[148:151], a[112:115], 0
v_fma_mix_f32 v205, v98, v189, v197 op_sel:[1,0,0] op_sel_hi:[1,0,0]
v_cvt_pk_bf16_f32 v161, v202, v203
v_mfma_f32_16x16x32_bf16 v[76:79], v[152:155], a[112:115], 0
ds_read_b128 a[242:245], v10 offset:13824
v_fma_mix_f32 v206, v99, v190, v198 op_sel_hi:[1,0,0]
s_waitcnt lgkmcnt(11)
v_mfma_f32_16x16x32_bf16 v[48:51], v[148:151], a[116:119], 0
v_fma_mix_f32 v207, v99, v191, v199 op_sel:[1,0,0] op_sel_hi:[1,0,0]
v_cvt_pk_bf16_f32 v162, v204, v205
v_mfma_f32_16x16x32_bf16 v[80:83], v[152:155], a[116:119], 0
ds_read_b128 a[246:249], v11 offset:14848
v_cvt_pk_bf16_f32 v163, v206, v207
buffer_load_dwordx4 v[92:95], v8, s[40:43], s78 offen offset:1024 sc1
buffer_load_dwordx4 v[96:99], v9, s[40:43], s78 offen offset:1024 sc1
s_waitcnt lgkmcnt(10)
v_mfma_f32_16x16x32_bf16 v[20:23], a[218:221], v[156:159], v[20:23]
ds_read_b128 v[184:187], v12 offset:384
s_waitcnt vmcnt(16)
s_waitcnt lgkmcnt(6)
v_fma_mix_f32 v200, v100, v168, v176 op_sel_hi:[1,0,0]
v_fma_mix_f32 v201, v100, v169, v177 op_sel:[1,0,0] op_sel_hi:[1,0,0]
v_mfma_f32_16x16x32_bf16 v[52:55], a[218:221], v[160:163], v[52:55]
ds_read_b128 a[88:91], v10 offset:15360
v_fma_mix_f32 v202, v101, v170, v178 op_sel_hi:[1,0,0]
s_add_u32 m0, s90, 69632
s_add_u32 s91, s83, 69632
buffer_load_dwordx4 v8, s[40:43], s91 offen sc1 lds
v_mfma_f32_16x16x32_bf16 v[24:27], a[222:225], v[156:159], v[24:27]
ds_read_b128 v[188:191], v12 offset:400
v_fma_mix_f32 v203, v101, v171, v179 op_sel:[1,0,0] op_sel_hi:[1,0,0]
v_cvt_pk_bf16_f32 v148, v200, v201
v_mfma_f32_16x16x32_bf16 v[56:59], a[222:225], v[160:163], v[56:59]
ds_read_b128 a[92:95], v10 offset:16384
v_fma_mix_f32 v204, v102, v172, v180 op_sel_hi:[1,0,0]
v_mfma_f32_16x16x32_bf16 v[28:31], a[226:229], v[156:159], v[28:31]
ds_read_b128 v[192:195], v12 offset:2944
v_fma_mix_f32 v205, v102, v173, v181 op_sel:[1,0,0] op_sel_hi:[1,0,0]
v_cvt_pk_bf16_f32 v149, v202, v203
v_mfma_f32_16x16x32_bf16 v[60:63], a[226:229], v[160:163], v[60:63]
ds_read_b128 a[96:99], v10 offset:17408
v_fma_mix_f32 v206, v103, v174, v182 op_sel_hi:[1,0,0]
s_waitcnt lgkmcnt(10)
v_mfma_f32_16x16x32_bf16 v[32:35], a[230:233], v[156:159], v[32:35]
ds_read_b128 v[196:199], v12 offset:2960
v_fma_mix_f32 v207, v103, v175, v183 op_sel:[1,0,0] op_sel_hi:[1,0,0]
v_cvt_pk_bf16_f32 v150, v204, v205
s_add_u32 m0, s90, 73728
s_add_u32 s91, s83, 73728
buffer_load_dwordx4 v8, s[40:43], s91 offen sc1 lds
v_mfma_f32_16x16x32_bf16 v[64:67], a[230:233], v[160:163], v[64:67]
ds_read_b128 a[100:103], v10 offset:18432
v_cvt_pk_bf16_f32 v151, v206, v207
s_waitcnt lgkmcnt(11)
v_mfma_f32_16x16x32_bf16 v[36:39], a[234:237], v[156:159], v[36:39]
v_fma_mix_f32 v200, v104, v168, v176 op_sel_hi:[1,0,0]
v_fma_mix_f32 v201, v104, v169, v177 op_sel:[1,0,0] op_sel_hi:[1,0,0]
v_mfma_f32_16x16x32_bf16 v[68:71], a[234:237], v[160:163], v[68:71]
ds_read_b128 a[104:107], v10 offset:19456
v_fma_mix_f32 v202, v105, v170, v178 op_sel_hi:[1,0,0]
s_waitcnt lgkmcnt(11)
v_mfma_f32_16x16x32_bf16 v[40:43], v[156:159], a[238:241], v[40:43]
v_fma_mix_f32 v203, v105, v171, v179 op_sel:[1,0,0] op_sel_hi:[1,0,0]
v_cvt_pk_bf16_f32 v152, v200, v201
v_mfma_f32_16x16x32_bf16 v[72:75], v[160:163], a[238:241], v[72:75]
ds_read_b128 a[108:111], v10 offset:20480
v_fma_mix_f32 v204, v106, v172, v180 op_sel_hi:[1,0,0]
s_add_u32 s72, s8, 2
v_mov_b32 v1, s72
s_mov_b64 exec, 1
buffer_store_dword v1, off, s[40:43], s10 sc1
s_mov_b64 exec, -1
s_waitcnt lgkmcnt(11)
v_mfma_f32_16x16x32_bf16 v[44:47], v[156:159], a[242:245], v[44:47]
v_fma_mix_f32 v205, v106, v173, v181 op_sel:[1,0,0] op_sel_hi:[1,0,0]
v_cvt_pk_bf16_f32 v153, v202, v203
v_mfma_f32_16x16x32_bf16 v[76:79], v[160:163], a[242:245], v[76:79]
ds_read_b128 a[112:115], v10 offset:21504
v_fma_mix_f32 v206, v107, v174, v182 op_sel_hi:[1,0,0]
s_waitcnt lgkmcnt(11)
v_mfma_f32_16x16x32_bf16 v[48:51], v[156:159], a[246:249], v[48:51]
v_fma_mix_f32 v207, v107, v175, v183 op_sel:[1,0,0] op_sel_hi:[1,0,0]
v_cvt_pk_bf16_f32 v154, v204, v205
v_mfma_f32_16x16x32_bf16 v[80:83], v[160:163], a[246:249], v[80:83]
ds_read_b128 a[116:119], v11 offset:22528
v_cvt_pk_bf16_f32 v155, v206, v207
buffer_load_dwordx4 v[100:103], v8, s[40:43], s78 offen offset:2048 sc1
buffer_load_dwordx4 v[104:107], v9, s[40:43], s78 offen offset:2048 sc1
s_waitcnt lgkmcnt(10)
v_mfma_f32_16x16x32_bf16 v[20:23], a[88:91], v[148:151], v[20:23]
ds_read_b128 v[168:171], v12 offset:512
s_waitcnt vmcnt(18)
s_waitcnt lgkmcnt(6)
v_fma_mix_f32 v200, v108, v184, v192 op_sel_hi:[1,0,0]
v_fma_mix_f32 v201, v108, v185, v193 op_sel:[1,0,0] op_sel_hi:[1,0,0]
v_mfma_f32_16x16x32_bf16 v[52:55], a[88:91], v[152:155], v[52:55]
ds_read_b128 a[218:221], v10 offset:23040
v_fma_mix_f32 v202, v109, v186, v194 op_sel_hi:[1,0,0]
s_add_u32 m0, s90, 77824
s_add_u32 s91, s83, 77824
buffer_load_dwordx4 v8, s[40:43], s91 offen sc1 lds
v_mfma_f32_16x16x32_bf16 v[24:27], a[92:95], v[148:151], v[24:27]
ds_read_b128 v[172:175], v12 offset:528
v_fma_mix_f32 v203, v109, v187, v195 op_sel:[1,0,0] op_sel_hi:[1,0,0]
v_cvt_pk_bf16_f32 v156, v200, v201
v_mfma_f32_16x16x32_bf16 v[56:59], a[92:95], v[152:155], v[56:59]
ds_read_b128 a[222:225], v10 offset:24064
v_fma_mix_f32 v204, v110, v188, v196 op_sel_hi:[1,0,0]
v_mfma_f32_16x16x32_bf16 v[28:31], a[96:99], v[148:151], v[28:31]
ds_read_b128 v[176:179], v12 offset:3072
v_fma_mix_f32 v205, v110, v189, v197 op_sel:[1,0,0] op_sel_hi:[1,0,0]
v_cvt_pk_bf16_f32 v157, v202, v203
v_mfma_f32_16x16x32_bf16 v[60:63], a[96:99], v[152:155], v[60:63]
ds_read_b128 a[226:229], v10 offset:25088
v_fma_mix_f32 v206, v111, v190, v198 op_sel_hi:[1,0,0]
s_waitcnt lgkmcnt(10)
v_mfma_f32_16x16x32_bf16 v[32:35], a[100:103], v[148:151], v[32:35]
ds_read_b128 v[180:183], v12 offset:3088
v_fma_mix_f32 v207, v111, v191, v199 op_sel:[1,0,0] op_sel_hi:[1,0,0]
v_cvt_pk_bf16_f32 v158, v204, v205
v_mfma_f32_16x16x32_bf16 v[64:67], a[100:103], v[152:155], v[64:67]
ds_read_b128 a[230:233], v10 offset:26112
v_cvt_pk_bf16_f32 v159, v206, v207
s_waitcnt lgkmcnt(11)
v_mfma_f32_16x16x32_bf16 v[36:39], a[104:107], v[148:151], v[36:39]
v_fma_mix_f32 v200, v112, v184, v192 op_sel_hi:[1,0,0]
v_fma_mix_f32 v201, v112, v185, v193 op_sel:[1,0,0] op_sel_hi:[1,0,0]
s_add_u32 m0, s90, 81920
s_add_u32 s91, s83, 81920
buffer_load_dwordx4 v8, s[40:43], s91 offen sc1 lds
v_mfma_f32_16x16x32_bf16 v[68:71], a[104:107], v[152:155], v[68:71]
ds_read_b128 a[234:237], v10 offset:27136
v_fma_mix_f32 v202, v113, v186, v194 op_sel_hi:[1,0,0]
s_waitcnt lgkmcnt(11)
v_mfma_f32_16x16x32_bf16 v[40:43], v[148:151], a[108:111], v[40:43]
v_fma_mix_f32 v203, v113, v187, v195 op_sel:[1,0,0] op_sel_hi:[1,0,0]
v_cvt_pk_bf16_f32 v160, v200, v201
v_mfma_f32_16x16x32_bf16 v[72:75], v[152:155], a[108:111], v[72:75]
ds_read_b128 a[238:241], v10 offset:28160
v_fma_mix_f32 v204, v114, v188, v196 op_sel_hi:[1,0,0]
s_waitcnt lgkmcnt(11)
v_mfma_f32_16x16x32_bf16 v[44:47], v[148:151], a[112:115], v[44:47]
v_fma_mix_f32 v205, v114, v189, v197 op_sel:[1,0,0] op_sel_hi:[1,0,0]
v_cvt_pk_bf16_f32 v161, v202, v203
v_mfma_f32_16x16x32_bf16 v[76:79], v[152:155], a[112:115], v[76:79]
ds_read_b128 a[242:245], v10 offset:29184
v_fma_mix_f32 v206, v115, v190, v198 op_sel_hi:[1,0,0]
s_waitcnt lgkmcnt(11)
v_mfma_f32_16x16x32_bf16 v[48:51], v[148:151], a[116:119], v[48:51]
v_fma_mix_f32 v207, v115, v191, v199 op_sel:[1,0,0] op_sel_hi:[1,0,0]
v_cvt_pk_bf16_f32 v162, v204, v205
v_mfma_f32_16x16x32_bf16 v[80:83], v[152:155], a[116:119], v[80:83]
ds_read_b128 a[246:249], v11 offset:30208
v_cvt_pk_bf16_f32 v163, v206, v207
buffer_load_dwordx4 v[108:111], v8, s[40:43], s78 offen offset:3072 sc1
buffer_load_dwordx4 v[112:115], v9, s[40:43], s78 offen offset:3072 sc1
s_add_u32 s78, s78, 4096
s_barrier
s_waitcnt lgkmcnt(10)
v_mfma_f32_16x16x32_bf16 v[20:23], a[218:221], v[156:159], v[20:23]
ds_read_b128 v[184:187], v12 offset:640
s_waitcnt vmcnt(20)
s_waitcnt lgkmcnt(6)
v_fma_mix_f32 v200, v116, v168, v176 op_sel_hi:[1,0,0]
v_fma_mix_f32 v201, v116, v169, v177 op_sel:[1,0,0] op_sel_hi:[1,0,0]
v_mfma_f32_16x16x32_bf16 v[52:55], a[218:221], v[160:163], v[52:55]
ds_read_b128 a[88:91], v10 offset:30720
v_fma_mix_f32 v202, v117, v170, v178 op_sel_hi:[1,0,0]
s_add_u32 m0, s90, 86016
s_add_u32 s91, s83, 86016
buffer_load_dwordx4 v8, s[40:43], s91 offen sc1 lds
v_mfma_f32_16x16x32_bf16 v[24:27], a[222:225], v[156:159], v[24:27]
ds_read_b128 v[188:191], v12 offset:656
v_fma_mix_f32 v203, v117, v171, v179 op_sel:[1,0,0] op_sel_hi:[1,0,0]
v_cvt_pk_bf16_f32 v148, v200, v201
v_mfma_f32_16x16x32_bf16 v[56:59], a[222:225], v[160:163], v[56:59]
ds_read_b128 a[92:95], v10 offset:31744
v_fma_mix_f32 v204, v118, v172, v180 op_sel_hi:[1,0,0]
v_mfma_f32_16x16x32_bf16 v[28:31], a[226:229], v[156:159], v[28:31]
ds_read_b128 v[192:195], v12 offset:3200
v_fma_mix_f32 v205, v118, v173, v181 op_sel:[1,0,0] op_sel_hi:[1,0,0]
v_cvt_pk_bf16_f32 v149, v202, v203
v_mfma_f32_16x16x32_bf16 v[60:63], a[226:229], v[160:163], v[60:63]
ds_read_b128 a[96:99], v10 offset:32768
v_fma_mix_f32 v206, v119, v174, v182 op_sel_hi:[1,0,0]
s_waitcnt lgkmcnt(10)
v_mfma_f32_16x16x32_bf16 v[32:35], a[230:233], v[156:159], v[32:35]
ds_read_b128 v[196:199], v12 offset:3216
v_fma_mix_f32 v207, v119, v175, v183 op_sel:[1,0,0] op_sel_hi:[1,0,0]
v_cvt_pk_bf16_f32 v150, v204, v205
v_mfma_f32_16x16x32_bf16 v[64:67], a[230:233], v[160:163], v[64:67]
ds_read_b128 a[100:103], v10 offset:33792
v_cvt_pk_bf16_f32 v151, v206, v207
s_waitcnt lgkmcnt(11)
v_mfma_f32_16x16x32_bf16 v[36:39], a[234:237], v[156:159], v[36:39]
v_fma_mix_f32 v200, v120, v168, v176 op_sel_hi:[1,0,0]
v_fma_mix_f32 v201, v120, v169, v177 op_sel:[1,0,0] op_sel_hi:[1,0,0]
s_and_b32 s91, s90, 1024
s_add_u32 m0, s91, 90112
s_sub_u32 s91, s91, s90
s_add_u32 s91, s91, s83
s_add_u32 s91, s91, 90112
buffer_load_dwordx4 v8, s[40:43], s91 offen sc1 lds
v_mfma_f32_16x16x32_bf16 v[68:71], a[234:237], v[160:163], v[68:71]
ds_read_b128 a[104:107], v10 offset:34816
v_fma_mix_f32 v202, v121, v170, v178 op_sel_hi:[1,0,0]
s_waitcnt lgkmcnt(11)
v_mfma_f32_16x16x32_bf16 v[40:43], v[156:159], a[238:241], v[40:43]
v_fma_mix_f32 v203, v121, v171, v179 op_sel:[1,0,0] op_sel_hi:[1,0,0]
v_cvt_pk_bf16_f32 v152, v200, v201
v_mfma_f32_16x16x32_bf16 v[72:75], v[160:163], a[238:241], v[72:75]
ds_read_b128 a[108:111], v10 offset:35840
v_fma_mix_f32 v204, v122, v172, v180 op_sel_hi:[1,0,0]
s_waitcnt lgkmcnt(11)
v_mfma_f32_16x16x32_bf16 v[44:47], v[156:159], a[242:245], v[44:47]
v_fma_mix_f32 v205, v122, v173, v181 op_sel:[1,0,0] op_sel_hi:[1,0,0]
v_cvt_pk_bf16_f32 v153, v202, v203
v_mfma_f32_16x16x32_bf16 v[76:79], v[160:163], a[242:245], v[76:79]
ds_read_b128 a[112:115], v10 offset:36864
v_fma_mix_f32 v206, v123, v174, v182 op_sel_hi:[1,0,0]
s_waitcnt lgkmcnt(11)
v_mfma_f32_16x16x32_bf16 v[48:51], v[156:159], a[246:249], v[48:51]
v_fma_mix_f32 v207, v123, v175, v183 op_sel:[1,0,0] op_sel_hi:[1,0,0]
v_cvt_pk_bf16_f32 v154, v204, v205
v_mfma_f32_16x16x32_bf16 v[80:83], v[160:163], a[246:249], v[80:83]
ds_read_b128 a[116:119], v11 offset:37888
v_cvt_pk_bf16_f32 v155, v206, v207
buffer_load_dwordx4 v[116:119], v8, s[40:43], s78 offen offset:0 sc1
buffer_load_dwordx4 v[120:123], v9, s[40:43], s78 offen offset:0 sc1
s_waitcnt lgkmcnt(10)
v_mfma_f32_16x16x32_bf16 v[20:23], a[88:91], v[148:151], v[20:23]
ds_read_b128 v[168:171], v12 offset:768
s_waitcnt vmcnt(22)
s_waitcnt lgkmcnt(6)
v_fma_mix_f32 v200, v124, v184, v192 op_sel_hi:[1,0,0]
v_fma_mix_f32 v201, v124, v185, v193 op_sel:[1,0,0] op_sel_hi:[1,0,0]
v_mfma_f32_16x16x32_bf16 v[52:55], a[88:91], v[152:155], v[52:55]
ds_read_b128 a[218:221], v10 offset:38400
v_fma_mix_f32 v202, v125, v186, v194 op_sel_hi:[1,0,0]
s_add_u32 m0, s90, 92160
s_add_u32 s91, s83, 92160
buffer_load_dwordx4 v8, s[40:43], s91 offen sc1 lds
v_mfma_f32_16x16x32_bf16 v[24:27], a[92:95], v[148:151], v[24:27]
ds_read_b128 v[172:175], v12 offset:784
v_fma_mix_f32 v203, v125, v187, v195 op_sel:[1,0,0] op_sel_hi:[1,0,0]
v_cvt_pk_bf16_f32 v156, v200, v201
v_mfma_f32_16x16x32_bf16 v[56:59], a[92:95], v[152:155], v[56:59]
ds_read_b128 a[222:225], v10 offset:39424
v_fma_mix_f32 v204, v126, v188, v196 op_sel_hi:[1,0,0]
v_mfma_f32_16x16x32_bf16 v[28:31], a[96:99], v[148:151], v[28:31]
ds_read_b128 v[176:179], v12 offset:3328
v_fma_mix_f32 v205, v126, v189, v197 op_sel:[1,0,0] op_sel_hi:[1,0,0]
v_cvt_pk_bf16_f32 v157, v202, v203
v_mfma_f32_16x16x32_bf16 v[60:63], a[96:99], v[152:155], v[60:63]
ds_read_b128 a[226:229], v10 offset:40448
v_fma_mix_f32 v206, v127, v190, v198 op_sel_hi:[1,0,0]
s_waitcnt lgkmcnt(10)
v_mfma_f32_16x16x32_bf16 v[32:35], a[100:103], v[148:151], v[32:35]
ds_read_b128 v[180:183], v12 offset:3344
v_fma_mix_f32 v207, v127, v191, v199 op_sel:[1,0,0] op_sel_hi:[1,0,0]
v_cvt_pk_bf16_f32 v158, v204, v205
s_add_u32 m0, s90, 96256
s_add_u32 s91, s83, 96256
buffer_load_dwordx4 v8, s[40:43], s91 offen sc1 lds
v_mfma_f32_16x16x32_bf16 v[64:67], a[100:103], v[152:155], v[64:67]
ds_read_b128 a[230:233], v10 offset:41472
v_cvt_pk_bf16_f32 v159, v206, v207
s_waitcnt lgkmcnt(11)
v_mfma_f32_16x16x32_bf16 v[36:39], a[104:107], v[148:151], v[36:39]
v_fma_mix_f32 v200, v128, v184, v192 op_sel_hi:[1,0,0]
v_fma_mix_f32 v201, v128, v185, v193 op_sel:[1,0,0] op_sel_hi:[1,0,0]
v_mfma_f32_16x16x32_bf16 v[68:71], a[104:107], v[152:155], v[68:71]
ds_read_b128 a[234:237], v10 offset:42496
v_fma_mix_f32 v202, v129, v186, v194 op_sel_hi:[1,0,0]
s_waitcnt lgkmcnt(11)
v_mfma_f32_16x16x32_bf16 v[40:43], v[148:151], a[108:111], v[40:43]
v_fma_mix_f32 v203, v129, v187, v195 op_sel:[1,0,0] op_sel_hi:[1,0,0]
v_cvt_pk_bf16_f32 v160, v200, v201
v_mfma_f32_16x16x32_bf16 v[72:75], v[152:155], a[108:111], v[72:75]
ds_read_b128 a[238:241], v10 offset:43520
v_fma_mix_f32 v204, v130, v188, v196 op_sel_hi:[1,0,0]
buffer_load_dwordx4 v[208:211], v8, s[40:43], s79 offen sc1
s_add_u32 s79, s79, 4096
s_waitcnt lgkmcnt(11)
v_mfma_f32_16x16x32_bf16 v[44:47], v[148:151], a[112:115], v[44:47]
v_fma_mix_f32 v205, v130, v189, v197 op_sel:[1,0,0] op_sel_hi:[1,0,0]
v_cvt_pk_bf16_f32 v161, v202, v203
v_mfma_f32_16x16x32_bf16 v[76:79], v[152:155], a[112:115], v[76:79]
ds_read_b128 a[242:245], v10 offset:44544
v_fma_mix_f32 v206, v131, v190, v198 op_sel_hi:[1,0,0]
s_waitcnt lgkmcnt(11)
v_mfma_f32_16x16x32_bf16 v[48:51], v[148:151], a[116:119], v[48:51]
v_fma_mix_f32 v207, v131, v191, v199 op_sel:[1,0,0] op_sel_hi:[1,0,0]
v_cvt_pk_bf16_f32 v162, v204, v205
v_mfma_f32_16x16x32_bf16 v[80:83], v[152:155], a[116:119], v[80:83]
ds_read_b128 a[246:249], v11 offset:45568
v_cvt_pk_bf16_f32 v163, v206, v207
buffer_load_dwordx4 v[124:127], v8, s[40:43], s78 offen offset:1024 sc1
buffer_load_dwordx4 v[128:131], v9, s[40:43], s78 offen offset:1024 sc1
s_waitcnt lgkmcnt(10)
v_mfma_f32_16x16x32_bf16 v[20:23], a[218:221], v[156:159], v[20:23]
ds_read_b128 v[184:187], v12 offset:896
s_waitcnt vmcnt(25)
s_waitcnt lgkmcnt(6)
v_fma_mix_f32 v200, v132, v168, v176 op_sel_hi:[1,0,0]
v_fma_mix_f32 v201, v132, v169, v177 op_sel:[1,0,0] op_sel_hi:[1,0,0]
v_mfma_f32_16x16x32_bf16 v[52:55], a[218:221], v[160:163], v[52:55]
ds_read_b128 a[88:91], v10 offset:46080
v_fma_mix_f32 v202, v133, v170, v178 op_sel_hi:[1,0,0]
s_add_u32 m0, s90, 100352
s_add_u32 s91, s83, 100352
buffer_load_dwordx4 v8, s[40:43], s91 offen sc1 lds
v_mfma_f32_16x16x32_bf16 v[24:27], a[222:225], v[156:159], v[24:27]
ds_read_b128 v[188:191], v12 offset:912
v_fma_mix_f32 v203, v133, v171, v179 op_sel:[1,0,0] op_sel_hi:[1,0,0]
v_cvt_pk_bf16_f32 v148, v200, v201
v_mfma_f32_16x16x32_bf16 v[56:59], a[222:225], v[160:163], v[56:59]
ds_read_b128 a[92:95], v10 offset:47104
v_fma_mix_f32 v204, v134, v172, v180 op_sel_hi:[1,0,0]
v_mfma_f32_16x16x32_bf16 v[28:31], a[226:229], v[156:159], v[28:31]
ds_read_b128 v[192:195], v12 offset:3456
v_fma_mix_f32 v205, v134, v173, v181 op_sel:[1,0,0] op_sel_hi:[1,0,0]
v_cvt_pk_bf16_f32 v149, v202, v203
v_mfma_f32_16x16x32_bf16 v[60:63], a[226:229], v[160:163], v[60:63]
ds_read_b128 a[96:99], v10 offset:48128
v_fma_mix_f32 v206, v135, v174, v182 op_sel_hi:[1,0,0]
s_waitcnt lgkmcnt(10)
v_mfma_f32_16x16x32_bf16 v[32:35], a[230:233], v[156:159], v[32:35]
ds_read_b128 v[196:199], v12 offset:3472
v_fma_mix_f32 v207, v135, v175, v183 op_sel:[1,0,0] op_sel_hi:[1,0,0]
v_cvt_pk_bf16_f32 v150, v204, v205
s_add_u32 m0, s90, 104448
s_add_u32 s91, s83, 104448
buffer_load_dwordx4 v8, s[40:43], s91 offen sc1 lds
v_mfma_f32_16x16x32_bf16 v[64:67], a[230:233], v[160:163], v[64:67]
ds_read_b128 a[100:103], v10 offset:49152
v_cvt_pk_bf16_f32 v151, v206, v207
s_waitcnt lgkmcnt(11)
v_mfma_f32_16x16x32_bf16 v[36:39], a[234:237], v[156:159], v[36:39]
v_fma_mix_f32 v200, v136, v168, v176 op_sel_hi:[1,0,0]
v_fma_mix_f32 v201, v136, v169, v177 op_sel:[1,0,0] op_sel_hi:[1,0,0]
v_mfma_f32_16x16x32_bf16 v[68:71], a[234:237], v[160:163], v[68:71]
ds_read_b128 a[104:107], v10 offset:50176
v_fma_mix_f32 v202, v137, v170, v178 op_sel_hi:[1,0,0]
s_waitcnt lgkmcnt(11)
v_mfma_f32_16x16x32_bf16 v[40:43], v[156:159], a[238:241], v[40:43]
v_fma_mix_f32 v203, v137, v171, v179 op_sel:[1,0,0] op_sel_hi:[1,0,0]
v_cvt_pk_bf16_f32 v152, v200, v201
v_mfma_f32_16x16x32_bf16 v[72:75], v[160:163], a[238:241], v[72:75]
ds_read_b128 a[108:111], v10 offset:51200
v_fma_mix_f32 v204, v138, v172, v180 op_sel_hi:[1,0,0]
buffer_load_dwordx4 v[212:215], v8, s[40:43], s79 offen sc1
s_add_u32 s79, s79, 4096
s_waitcnt lgkmcnt(11)
v_mfma_f32_16x16x32_bf16 v[44:47], v[156:159], a[242:245], v[44:47]
v_fma_mix_f32 v205, v138, v173, v181 op_sel:[1,0,0] op_sel_hi:[1,0,0]
v_cvt_pk_bf16_f32 v153, v202, v203
v_mfma_f32_16x16x32_bf16 v[76:79], v[160:163], a[242:245], v[76:79]
ds_read_b128 a[112:115], v10 offset:52224
v_fma_mix_f32 v206, v139, v174, v182 op_sel_hi:[1,0,0]
s_waitcnt lgkmcnt(11)
v_mfma_f32_16x16x32_bf16 v[48:51], v[156:159], a[246:249], v[48:51]
v_fma_mix_f32 v207, v139, v175, v183 op_sel:[1,0,0] op_sel_hi:[1,0,0]
v_cvt_pk_bf16_f32 v154, v204, v205
v_mfma_f32_16x16x32_bf16 v[80:83], v[160:163], a[246:249], v[80:83]
ds_read_b128 a[116:119], v11 offset:53248
v_cvt_pk_bf16_f32 v155, v206, v207
buffer_load_dwordx4 v[132:135], v8, s[40:43], s78 offen offset:2048 sc1
buffer_load_dwordx4 v[136:139], v9, s[40:43], s78 offen offset:2048 sc1
s_waitcnt lgkmcnt(10)
v_mfma_f32_16x16x32_bf16 v[20:23], a[88:91], v[148:151], v[20:23]
ds_read_b128 v[168:171], v12 offset:1024
s_waitcnt vmcnt(28)
s_waitcnt lgkmcnt(6)
v_fma_mix_f32 v200, v140, v184, v192 op_sel_hi:[1,0,0]
v_fma_mix_f32 v201, v140, v185, v193 op_sel:[1,0,0] op_sel_hi:[1,0,0]
v_mfma_f32_16x16x32_bf16 v[52:55], a[88:91], v[152:155], v[52:55]
ds_read_b128 a[218:221], v10 offset:53760
v_fma_mix_f32 v202, v141, v186, v194 op_sel_hi:[1,0,0]
s_add_u32 m0, s90, 108544
s_add_u32 s91, s83, 108544
buffer_load_dwordx4 v8, s[40:43], s91 offen sc1 lds
v_mfma_f32_16x16x32_bf16 v[24:27], a[92:95], v[148:151], v[24:27]
ds_read_b128 v[172:175], v12 offset:1040
v_fma_mix_f32 v203, v141, v187, v195 op_sel:[1,0,0] op_sel_hi:[1,0,0]
v_cvt_pk_bf16_f32 v156, v200, v201
v_mfma_f32_16x16x32_bf16 v[56:59], a[92:95], v[152:155], v[56:59]
ds_read_b128 a[222:225], v10 offset:54784
v_fma_mix_f32 v204, v142, v188, v196 op_sel_hi:[1,0,0]
v_mfma_f32_16x16x32_bf16 v[28:31], a[96:99], v[148:151], v[28:31]
ds_read_b128 v[176:179], v12 offset:3584
v_fma_mix_f32 v205, v142, v189, v197 op_sel:[1,0,0] op_sel_hi:[1,0,0]
v_cvt_pk_bf16_f32 v157, v202, v203
v_mfma_f32_16x16x32_bf16 v[60:63], a[96:99], v[152:155], v[60:63]
ds_read_b128 a[226:229], v10 offset:55808
v_fma_mix_f32 v206, v143, v190, v198 op_sel_hi:[1,0,0]
s_waitcnt lgkmcnt(10)
v_mfma_f32_16x16x32_bf16 v[32:35], a[100:103], v[148:151], v[32:35]
ds_read_b128 v[180:183], v12 offset:3600
v_fma_mix_f32 v207, v143, v191, v199 op_sel:[1,0,0] op_sel_hi:[1,0,0]
v_cvt_pk_bf16_f32 v158, v204, v205
s_add_u32 m0, s90, 112640
s_add_u32 s91, s83, 112640
buffer_load_dwordx4 v8, s[40:43], s91 offen sc1 lds
v_mfma_f32_16x16x32_bf16 v[64:67], a[100:103], v[152:155], v[64:67]
ds_read_b128 a[230:233], v10 offset:56832
v_cvt_pk_bf16_f32 v159, v206, v207
s_waitcnt lgkmcnt(11)
v_mfma_f32_16x16x32_bf16 v[36:39], a[104:107], v[148:151], v[36:39]
v_fma_mix_f32 v200, v144, v184, v192 op_sel_hi:[1,0,0]
v_fma_mix_f32 v201, v144, v185, v193 op_sel:[1,0,0] op_sel_hi:[1,0,0]
v_mfma_f32_16x16x32_bf16 v[68:71], a[104:107], v[152:155], v[68:71]
ds_read_b128 a[234:237], v10 offset:57856
v_fma_mix_f32 v202, v145, v186, v194 op_sel_hi:[1,0,0]
s_waitcnt lgkmcnt(11)
v_mfma_f32_16x16x32_bf16 v[40:43], v[148:151], a[108:111], v[40:43]
v_fma_mix_f32 v203, v145, v187, v195 op_sel:[1,0,0] op_sel_hi:[1,0,0]
v_cvt_pk_bf16_f32 v160, v200, v201
v_mfma_f32_16x16x32_bf16 v[72:75], v[152:155], a[108:111], v[72:75]
ds_read_b128 a[238:241], v10 offset:58880
v_fma_mix_f32 v204, v146, v188, v196 op_sel_hi:[1,0,0]
buffer_load_dwordx4 v[216:219], v8, s[40:43], s79 offen sc1
s_add_u32 s79, s79, 4096
s_waitcnt lgkmcnt(11)
v_mfma_f32_16x16x32_bf16 v[44:47], v[148:151], a[112:115], v[44:47]
v_fma_mix_f32 v205, v146, v189, v197 op_sel:[1,0,0] op_sel_hi:[1,0,0]
v_cvt_pk_bf16_f32 v161, v202, v203
v_mfma_f32_16x16x32_bf16 v[76:79], v[152:155], a[112:115], v[76:79]
ds_read_b128 a[242:245], v10 offset:59904
v_fma_mix_f32 v206, v147, v190, v198 op_sel_hi:[1,0,0]
s_waitcnt lgkmcnt(11)
v_mfma_f32_16x16x32_bf16 v[48:51], v[148:151], a[116:119], v[48:51]
v_fma_mix_f32 v207, v147, v191, v199 op_sel:[1,0,0] op_sel_hi:[1,0,0]
v_cvt_pk_bf16_f32 v162, v204, v205
v_mfma_f32_16x16x32_bf16 v[80:83], v[152:155], a[116:119], v[80:83]
ds_read_b128 a[246:249], v11 offset:60928
v_cvt_pk_bf16_f32 v163, v206, v207
buffer_load_dwordx4 v[140:143], v8, s[40:43], s78 offen offset:3072 sc1
buffer_load_dwordx4 v[144:147], v9, s[40:43], s78 offen offset:3072 sc1
s_add_u32 s78, s78, 4096
s_waitcnt vmcnt(17)
s_barrier
s_waitcnt lgkmcnt(10)
v_mfma_f32_16x16x32_bf16 v[20:23], a[218:221], v[156:159], v[20:23]
v_add_u32 v10, 61440, v10
v_add_u32 v11, 61440, v11
ds_read_b128 v[184:187], v12 offset:1152
s_waitcnt lgkmcnt(6)
v_fma_mix_f32 v200, v84, v168, v176 op_sel_hi:[1,0,0]
v_fma_mix_f32 v201, v84, v169, v177 op_sel:[1,0,0] op_sel_hi:[1,0,0]
v_mfma_f32_16x16x32_bf16 v[52:55], a[218:221], v[160:163], v[52:55]
ds_read_b128 a[88:91], v10 offset:0
v_fma_mix_f32 v202, v85, v170, v178 op_sel_hi:[1,0,0]
s_add_u32 m0, s90, 116736
s_add_u32 s91, s83, 116736
buffer_load_dwordx4 v8, s[40:43], s91 offen sc1 lds
v_mfma_f32_16x16x32_bf16 v[24:27], a[222:225], v[156:159], v[24:27]
ds_read_b128 v[188:191], v12 offset:1168
v_fma_mix_f32 v203, v85, v171, v179 op_sel:[1,0,0] op_sel_hi:[1,0,0]
v_cvt_pk_bf16_f32 v148, v200, v201
v_mfma_f32_16x16x32_bf16 v[56:59], a[222:225], v[160:163], v[56:59]
ds_read_b128 a[92:95], v10 offset:1024
v_fma_mix_f32 v204, v86, v172, v180 op_sel_hi:[1,0,0]
v_mfma_f32_16x16x32_bf16 v[28:31], a[226:229], v[156:159], v[28:31]
ds_read_b128 v[192:195], v12 offset:3712
v_fma_mix_f32 v205, v86, v173, v181 op_sel:[1,0,0] op_sel_hi:[1,0,0]
v_cvt_pk_bf16_f32 v149, v202, v203
v_mfma_f32_16x16x32_bf16 v[60:63], a[226:229], v[160:163], v[60:63]
ds_read_b128 a[96:99], v10 offset:2048
v_fma_mix_f32 v206, v87, v174, v182 op_sel_hi:[1,0,0]
s_waitcnt lgkmcnt(10)
v_mfma_f32_16x16x32_bf16 v[32:35], a[230:233], v[156:159], v[32:35]
ds_read_b128 v[196:199], v12 offset:3728
v_fma_mix_f32 v207, v87, v175, v183 op_sel:[1,0,0] op_sel_hi:[1,0,0]
v_cvt_pk_bf16_f32 v150, v204, v205
s_and_b32 s91, s90, 1024
s_add_u32 m0, s91, 120832
s_sub_u32 s91, s91, s90
s_add_u32 s91, s91, s83
s_add_u32 s91, s91, 120832
buffer_load_dwordx4 v8, s[40:43], s91 offen sc1 lds
v_mfma_f32_16x16x32_bf16 v[64:67], a[230:233], v[160:163], v[64:67]
ds_read_b128 a[100:103], v10 offset:3072
v_cvt_pk_bf16_f32 v151, v206, v207
s_waitcnt lgkmcnt(11)
v_mfma_f32_16x16x32_bf16 v[36:39], a[234:237], v[156:159], v[36:39]
v_fma_mix_f32 v200, v88, v168, v176 op_sel_hi:[1,0,0]
v_fma_mix_f32 v201, v88, v169, v177 op_sel:[1,0,0] op_sel_hi:[1,0,0]
v_mfma_f32_16x16x32_bf16 v[68:71], a[234:237], v[160:163], v[68:71]
ds_read_b128 a[104:107], v10 offset:4096
v_fma_mix_f32 v202, v89, v170, v178 op_sel_hi:[1,0,0]
s_waitcnt lgkmcnt(11)
v_mfma_f32_16x16x32_bf16 v[40:43], v[156:159], a[238:241], v[40:43]
v_fma_mix_f32 v203, v89, v171, v179 op_sel:[1,0,0] op_sel_hi:[1,0,0]
v_cvt_pk_bf16_f32 v152, v200, v201
v_mfma_f32_16x16x32_bf16 v[72:75], v[160:163], a[238:241], v[72:75]
ds_read_b128 a[108:111], v10 offset:5120
v_fma_mix_f32 v204, v90, v172, v180 op_sel_hi:[1,0,0]
buffer_load_dwordx4 v[220:223], v8, s[40:43], s79 offen sc1
s_add_u32 s79, s79, 4096
s_waitcnt lgkmcnt(11)
v_mfma_f32_16x16x32_bf16 v[44:47], v[156:159], a[242:245], v[44:47]
v_fma_mix_f32 v205, v90, v173, v181 op_sel:[1,0,0] op_sel_hi:[1,0,0]
v_cvt_pk_bf16_f32 v153, v202, v203
v_mfma_f32_16x16x32_bf16 v[76:79], v[160:163], a[242:245], v[76:79]
ds_read_b128 a[112:115], v10 offset:6144
v_fma_mix_f32 v206, v91, v174, v182 op_sel_hi:[1,0,0]
s_waitcnt lgkmcnt(11)
v_mfma_f32_16x16x32_bf16 v[48:51], v[156:159], a[246:249], v[48:51]
v_fma_mix_f32 v207, v91, v175, v183 op_sel:[1,0,0] op_sel_hi:[1,0,0]
v_cvt_pk_bf16_f32 v154, v204, v205
v_mfma_f32_16x16x32_bf16 v[80:83], v[160:163], a[246:249], v[80:83]
ds_read_b128 a[116:119], v11 offset:7168
v_cvt_pk_bf16_f32 v155, v206, v207
buffer_load_dwordx4 v[84:87], v8, s[40:43], s78 offen offset:0 sc1
buffer_load_dwordx4 v[88:91], v9, s[40:43], s78 offen offset:0 sc1
s_waitcnt lgkmcnt(10)
v_mfma_f32_16x16x32_bf16 v[20:23], a[88:91], v[148:151], v[20:23]
ds_read_b128 v[168:171], v12 offset:1280
s_waitcnt lgkmcnt(6)
v_fma_mix_f32 v200, v92, v184, v192 op_sel_hi:[1,0,0]
v_fma_mix_f32 v201, v92, v185, v193 op_sel:[1,0,0] op_sel_hi:[1,0,0]
v_mfma_f32_16x16x32_bf16 v[52:55], a[88:91], v[152:155], v[52:55]
ds_read_b128 a[218:221], v10 offset:7680
v_fma_mix_f32 v202, v93, v186, v194 op_sel_hi:[1,0,0]
s_add_u32 m0, s90, 122880
s_add_u32 s91, s83, 122880
buffer_load_dwordx4 v8, s[40:43], s91 offen sc1 lds
v_mfma_f32_16x16x32_bf16 v[24:27], a[92:95], v[148:151], v[24:27]
ds_read_b128 v[172:175], v12 offset:1296
v_fma_mix_f32 v203, v93, v187, v195 op_sel:[1,0,0] op_sel_hi:[1,0,0]
v_cvt_pk_bf16_f32 v156, v200, v201
v_mfma_f32_16x16x32_bf16 v[56:59], a[92:95], v[152:155], v[56:59]
ds_read_b128 a[222:225], v10 offset:8704
v_fma_mix_f32 v204, v94, v188, v196 op_sel_hi:[1,0,0]
v_mfma_f32_16x16x32_bf16 v[28:31], a[96:99], v[148:151], v[28:31]
ds_read_b128 v[176:179], v12 offset:3840
v_fma_mix_f32 v205, v94, v189, v197 op_sel:[1,0,0] op_sel_hi:[1,0,0]
v_cvt_pk_bf16_f32 v157, v202, v203
v_mfma_f32_16x16x32_bf16 v[60:63], a[96:99], v[152:155], v[60:63]
ds_read_b128 a[226:229], v10 offset:9728
v_fma_mix_f32 v206, v95, v190, v198 op_sel_hi:[1,0,0]
s_waitcnt lgkmcnt(10)
v_mfma_f32_16x16x32_bf16 v[32:35], a[100:103], v[148:151], v[32:35]
ds_read_b128 v[180:183], v12 offset:3856
v_fma_mix_f32 v207, v95, v191, v199 op_sel:[1,0,0] op_sel_hi:[1,0,0]
v_cvt_pk_bf16_f32 v158, v204, v205
s_add_u32 m0, s90, 126976
s_add_u32 s91, s83, 126976
buffer_load_dwordx4 v8, s[40:43], s91 offen sc1 lds
v_mfma_f32_16x16x32_bf16 v[64:67], a[100:103], v[152:155], v[64:67]
ds_read_b128 a[230:233], v10 offset:10752
v_cvt_pk_bf16_f32 v159, v206, v207
s_waitcnt lgkmcnt(11)
v_mfma_f32_16x16x32_bf16 v[36:39], a[104:107], v[148:151], v[36:39]
v_fma_mix_f32 v200, v96, v184, v192 op_sel_hi:[1,0,0]
v_fma_mix_f32 v201, v96, v185, v193 op_sel:[1,0,0] op_sel_hi:[1,0,0]
v_mfma_f32_16x16x32_bf16 v[68:71], a[104:107], v[152:155], v[68:71]
ds_read_b128 a[234:237], v10 offset:11776
v_fma_mix_f32 v202, v97, v186, v194 op_sel_hi:[1,0,0]
s_waitcnt lgkmcnt(11)
v_mfma_f32_16x16x32_bf16 v[40:43], v[148:151], a[108:111], v[40:43]
v_fma_mix_f32 v203, v97, v187, v195 op_sel:[1,0,0] op_sel_hi:[1,0,0]
v_cvt_pk_bf16_f32 v160, v200, v201
v_mfma_f32_16x16x32_bf16 v[72:75], v[152:155], a[108:111], v[72:75]
ds_read_b128 a[238:241], v10 offset:12800
v_fma_mix_f32 v204, v98, v188, v196 op_sel_hi:[1,0,0]
buffer_load_dwordx4 v[224:227], v8, s[40:43], s79 offen sc1
s_waitcnt lgkmcnt(11)
v_mfma_f32_16x16x32_bf16 v[44:47], v[148:151], a[112:115], v[44:47]
v_fma_mix_f32 v205, v98, v189, v197 op_sel:[1,0,0] op_sel_hi:[1,0,0]
v_cvt_pk_bf16_f32 v161, v202, v203
v_mfma_f32_16x16x32_bf16 v[76:79], v[152:155], a[112:115], v[76:79]
ds_read_b128 a[242:245], v10 offset:13824
v_fma_mix_f32 v206, v99, v190, v198 op_sel_hi:[1,0,0]
s_waitcnt lgkmcnt(11)
v_mfma_f32_16x16x32_bf16 v[48:51], v[148:151], a[116:119], v[48:51]
v_fma_mix_f32 v207, v99, v191, v199 op_sel:[1,0,0] op_sel_hi:[1,0,0]
v_cvt_pk_bf16_f32 v162, v204, v205
v_mfma_f32_16x16x32_bf16 v[80:83], v[152:155], a[116:119], v[80:83]
ds_read_b128 a[246:249], v11 offset:14848
v_cvt_pk_bf16_f32 v163, v206, v207
buffer_load_dwordx4 v[92:95], v8, s[40:43], s78 offen offset:1024 sc1
buffer_load_dwordx4 v[96:99], v9, s[40:43], s78 offen offset:1024 sc1
s_waitcnt lgkmcnt(10)
v_mfma_f32_16x16x32_bf16 v[20:23], a[218:221], v[156:159], v[20:23]
ds_read_b128 v[184:187], v12 offset:1408
s_waitcnt lgkmcnt(6)
v_fma_mix_f32 v200, v100, v168, v176 op_sel_hi:[1,0,0]
v_fma_mix_f32 v201, v100, v169, v177 op_sel:[1,0,0] op_sel_hi:[1,0,0]
v_mfma_f32_16x16x32_bf16 v[52:55], a[218:221], v[160:163], v[52:55]
ds_read_b128 a[88:91], v10 offset:15360
v_fma_mix_f32 v202, v101, v170, v178 op_sel_hi:[1,0,0]
s_add_u32 m0, s90, 131072
s_add_u32 s91, s83, 131072
buffer_load_dwordx4 v8, s[40:43], s91 offen sc1 lds
v_mfma_f32_16x16x32_bf16 v[24:27], a[222:225], v[156:159], v[24:27]
ds_read_b128 v[188:191], v12 offset:1424
v_fma_mix_f32 v203, v101, v171, v179 op_sel:[1,0,0] op_sel_hi:[1,0,0]
v_cvt_pk_bf16_f32 v148, v200, v201
v_mfma_f32_16x16x32_bf16 v[56:59], a[222:225], v[160:163], v[56:59]
ds_read_b128 a[92:95], v10 offset:16384
v_fma_mix_f32 v204, v102, v172, v180 op_sel_hi:[1,0,0]
v_mfma_f32_16x16x32_bf16 v[28:31], a[226:229], v[156:159], v[28:31]
ds_read_b128 v[192:195], v12 offset:3968
v_fma_mix_f32 v205, v102, v173, v181 op_sel:[1,0,0] op_sel_hi:[1,0,0]
v_cvt_pk_bf16_f32 v149, v202, v203
v_mfma_f32_16x16x32_bf16 v[60:63], a[226:229], v[160:163], v[60:63]
ds_read_b128 a[96:99], v10 offset:17408
v_fma_mix_f32 v206, v103, v174, v182 op_sel_hi:[1,0,0]
s_waitcnt lgkmcnt(10)
v_mfma_f32_16x16x32_bf16 v[32:35], a[230:233], v[156:159], v[32:35]
ds_read_b128 v[196:199], v12 offset:3984
v_fma_mix_f32 v207, v103, v175, v183 op_sel:[1,0,0] op_sel_hi:[1,0,0]
v_cvt_pk_bf16_f32 v150, v204, v205
s_add_u32 m0, s90, 135168
s_add_u32 s91, s83, 135168
buffer_load_dwordx4 v8, s[40:43], s91 offen sc1 lds
v_mfma_f32_16x16x32_bf16 v[64:67], a[230:233], v[160:163], v[64:67]
ds_read_b128 a[100:103], v10 offset:18432
v_cvt_pk_bf16_f32 v151, v206, v207
s_waitcnt lgkmcnt(11)
v_mfma_f32_16x16x32_bf16 v[36:39], a[234:237], v[156:159], v[36:39]
v_fma_mix_f32 v200, v104, v168, v176 op_sel_hi:[1,0,0]
v_fma_mix_f32 v201, v104, v169, v177 op_sel:[1,0,0] op_sel_hi:[1,0,0]
v_mfma_f32_16x16x32_bf16 v[68:71], a[234:237], v[160:163], v[68:71]
ds_read_b128 a[104:107], v10 offset:19456
v_fma_mix_f32 v202, v105, v170, v178 op_sel_hi:[1,0,0]
s_waitcnt lgkmcnt(11)
v_mfma_f32_16x16x32_bf16 v[40:43], v[156:159], a[238:241], v[40:43]
v_fma_mix_f32 v203, v105, v171, v179 op_sel:[1,0,0] op_sel_hi:[1,0,0]
v_cvt_pk_bf16_f32 v152, v200, v201
v_mfma_f32_16x16x32_bf16 v[72:75], v[160:163], a[238:241], v[72:75]
ds_read_b128 a[108:111], v10 offset:20480
v_fma_mix_f32 v204, v106, v172, v180 op_sel_hi:[1,0,0]
s_waitcnt lgkmcnt(11)
v_mfma_f32_16x16x32_bf16 v[44:47], v[156:159], a[242:245], v[44:47]
v_fma_mix_f32 v205, v106, v173, v181 op_sel:[1,0,0] op_sel_hi:[1,0,0]
v_cvt_pk_bf16_f32 v153, v202, v203
v_mfma_f32_16x16x32_bf16 v[76:79], v[160:163], a[242:245], v[76:79]
ds_read_b128 a[112:115], v10 offset:21504
v_fma_mix_f32 v206, v107, v174, v182 op_sel_hi:[1,0,0]
s_waitcnt lgkmcnt(11)
v_mfma_f32_16x16x32_bf16 v[48:51], v[156:159], a[246:249], v[48:51]
v_fma_mix_f32 v207, v107, v175, v183 op_sel:[1,0,0] op_sel_hi:[1,0,0]
v_cvt_pk_bf16_f32 v154, v204, v205
v_mfma_f32_16x16x32_bf16 v[80:83], v[160:163], a[246:249], v[80:83]
ds_read_b128 a[116:119], v11 offset:22528
v_cvt_pk_bf16_f32 v155, v206, v207
ds_read_b128 v[228:231], v15 offset:0
ds_read_b128 v[232:235], v15 offset:16
ds_read_b128 v[236:239], v15 offset:2560
ds_read_b128 v[240:243], v15 offset:2576
ds_read_b128 a[120:123], v13 offset:2048
ds_read_b128 a[124:127], v13 offset:3072
ds_read_b128 a[128:131], v13 offset:4096
ds_read_b128 a[132:135], v13 offset:5120
ds_read_b128 a[136:139], v13 offset:6144
ds_read_b128 a[140:143], v14 offset:7168
buffer_load_dwordx4 v[100:103], v8, s[40:43], s78 offen offset:2048 sc1
buffer_load_dwordx4 v[104:107], v9, s[40:43], s78 offen offset:2048 sc1
s_waitcnt lgkmcnt(15)
v_mfma_f32_16x16x32_bf16 v[20:23], a[88:91], v[148:151], v[20:23]
ds_read_b128 v[168:171], v12 offset:1536
s_waitcnt vmcnt(26)
s_waitcnt lgkmcnt(7)
v_fma_mix_f32 v200, v208, v228, v236 op_sel_hi:[1,0,0]
v_fma_mix_f32 v201, v208, v229, v237 op_sel:[1,0,0] op_sel_hi:[1,0,0]
v_mfma_f32_16x16x32_bf16 v[52:55], a[88:91], v[152:155], v[52:55]
ds_read_b128 a[218:221], v10 offset:23040
v_fma_mix_f32 v202, v209, v230, v238 op_sel_hi:[1,0,0]
v_fma_mix_f32 v203, v209, v231, v239 op_sel:[1,0,0] op_sel_hi:[1,0,0]
s_add_u32 m0, s90, 139264
s_add_u32 s91, s83, 139264
buffer_load_dwordx4 v8, s[40:43], s91 offen sc1 lds
v_mfma_f32_16x16x32_bf16 v[24:27], a[92:95], v[148:151], v[24:27]
ds_read_b128 v[172:175], v12 offset:1552
v_cvt_pk_bf16_f32 v164, v200, v201
v_mfma_f32_16x16x32_bf16 v[56:59], a[92:95], v[152:155], v[56:59]
ds_read_b128 a[222:225], v10 offset:24064
v_fma_mix_f32 v204, v210, v232, v240 op_sel_hi:[1,0,0]
v_fma_mix_f32 v205, v210, v233, v241 op_sel:[1,0,0] op_sel_hi:[1,0,0]
v_mfma_f32_16x16x32_bf16 v[28:31], a[96:99], v[148:151], v[28:31]
ds_read_b128 v[176:179], v12 offset:4096
v_cvt_pk_bf16_f32 v165, v202, v203
v_fma_mix_f32 v206, v211, v234, v242 op_sel_hi:[1,0,0]
v_mfma_f32_16x16x32_bf16 v[60:63], a[96:99], v[152:155], v[60:63]
ds_read_b128 a[226:229], v10 offset:25088
v_fma_mix_f32 v207, v211, v235, v243 op_sel:[1,0,0] op_sel_hi:[1,0,0]
v_mfma_f32_16x16x32_bf16 v[32:35], a[100:103], v[148:151], v[32:35]
ds_read_b128 v[180:183], v12 offset:4112
v_cvt_pk_bf16_f32 v166, v204, v205
v_cvt_pk_bf16_f32 v167, v206, v207
v_mfma_f32_16x16x32_bf16 v[64:67], a[100:103], v[152:155], v[64:67]
ds_read_b128 a[230:233], v10 offset:26112
v_fma_mix_f32 v200, v108, v184, v192 op_sel_hi:[1,0,0]
v_fma_mix_f32 v201, v108, v185, v193 op_sel:[1,0,0] op_sel_hi:[1,0,0]
v_mfma_f32_16x16x32_bf16 v[36:39], a[104:107], v[148:151], v[36:39]
v_fma_mix_f32 v202, v109, v186, v194 op_sel_hi:[1,0,0]
s_add_u32 m0, s90, 143360
s_add_u32 s91, s83, 143360
buffer_load_dwordx4 v8, s[40:43], s91 offen sc1 lds
v_mfma_f32_16x16x32_bf16 v[68:71], a[104:107], v[152:155], v[68:71]
ds_read_b128 a[234:237], v10 offset:27136
v_fma_mix_f32 v203, v109, v187, v195 op_sel:[1,0,0] op_sel_hi:[1,0,0]
v_cvt_pk_bf16_f32 v156, v200, v201
v_mfma_f32_16x16x32_bf16 v[40:43], v[148:151], a[108:111], v[40:43]
v_fma_mix_f32 v204, v110, v188, v196 op_sel_hi:[1,0,0]
v_mfma_f32_16x16x32_bf16 v[72:75], v[152:155], a[108:111], v[72:75]
ds_read_b128 a[238:241], v10 offset:28160
v_fma_mix_f32 v205, v110, v189, v197 op_sel:[1,0,0] op_sel_hi:[1,0,0]
v_cvt_pk_bf16_f32 v157, v202, v203
v_mfma_f32_16x16x32_bf16 v[44:47], v[148:151], a[112:115], v[44:47]
v_fma_mix_f32 v206, v111, v190, v198 op_sel_hi:[1,0,0]
v_fma_mix_f32 v207, v111, v191, v199 op_sel:[1,0,0] op_sel_hi:[1,0,0]
v_mfma_f32_16x16x32_bf16 v[76:79], v[152:155], a[112:115], v[76:79]
ds_read_b128 a[242:245], v10 offset:29184
v_cvt_pk_bf16_f32 v158, v204, v205
v_mfma_f32_16x16x32_bf16 v[48:51], v[148:151], a[116:119], v[48:51]
v_cvt_pk_bf16_f32 v159, v206, v207
v_fma_mix_f32 v200, v112, v184, v192 op_sel_hi:[1,0,0]
v_mfma_f32_16x16x32_bf16 v[80:83], v[152:155], a[116:119], v[80:83]
ds_read_b128 a[246:249], v11 offset:30208
v_fma_mix_f32 v201, v112, v185, v193 op_sel:[1,0,0] op_sel_hi:[1,0,0]
v_fma_mix_f32 v202, v113, v186, v194 op_sel_hi:[1,0,0]
buffer_load_dword v19, v244, s[40:43], 0 offen sc1
s_waitcnt lgkmcnt(15)
v_mfma_f32_16x16x32_bf16 a[64:67], a[120:123], v[164:167], 0
ds_read_b128 a[176:179], v13 offset:32768
v_fma_mix_f32 v203, v113, v187, v195 op_sel:[1,0,0] op_sel_hi:[1,0,0]
v_mfma_f32_16x16x32_bf16 a[68:71], a[124:127], v[164:167], 0
ds_read_b128 a[180:183], v13 offset:33792
v_cvt_pk_bf16_f32 v160, v200, v201
v_fma_mix_f32 v204, v114, v188, v196 op_sel_hi:[1,0,0]
v_mfma_f32_16x16x32_bf16 a[72:75], a[128:131], v[164:167], 0
ds_read_b128 a[184:187], v13 offset:34816
v_fma_mix_f32 v205, v114, v189, v197 op_sel:[1,0,0] op_sel_hi:[1,0,0]
v_cvt_pk_bf16_f32 v161, v202, v203
s_waitcnt lgkmcnt(15)
v_mfma_f32_16x16x32_bf16 a[76:79], v[164:167], a[132:135], 0
ds_read_b128 a[188:191], v13 offset:35840
v_fma_mix_f32 v206, v115, v190, v198 op_sel_hi:[1,0,0]
v_mfma_f32_16x16x32_bf16 a[80:83], v[164:167], a[136:139], 0
ds_read_b128 a[192:195], v13 offset:36864
v_fma_mix_f32 v207, v115, v191, v199 op_sel:[1,0,0] op_sel_hi:[1,0,0]
v_cvt_pk_bf16_f32 v162, v204, v205
v_mfma_f32_16x16x32_bf16 a[84:87], v[164:167], a[140:143], 0
ds_read_b128 a[196:199], v14 offset:37888
v_cvt_pk_bf16_f32 v163, v206, v207
ds_read_b128 v[228:231], v15 offset:512
ds_read_b128 v[232:235], v15 offset:528
ds_read_b128 v[236:239], v15 offset:3072
ds_read_b128 v[240:243], v15 offset:3088
buffer_load_dwordx4 v[108:111], v8, s[40:43], s78 offen offset:3072 sc1
buffer_load_dwordx4 v[112:115], v9, s[40:43], s78 offen offset:3072 sc1
s_add_u32 s78, s78, 4096
s_waitcnt vmcnt(17)
s_barrier
s_waitcnt lgkmcnt(15)
v_mfma_f32_16x16x32_bf16 v[20:23], a[218:221], v[156:159], v[20:23]
ds_read_b128 v[184:187], v12 offset:1664
s_waitcnt lgkmcnt(1)
v_fma_mix_f32 v200, v212, v228, v236 op_sel_hi:[1,0,0]
v_fma_mix_f32 v201, v212, v229, v237 op_sel:[1,0,0] op_sel_hi:[1,0,0]
v_mfma_f32_16x16x32_bf16 v[52:55], a[218:221], v[160:163], v[52:55]
ds_read_b128 a[88:91], v10 offset:30720
v_fma_mix_f32 v202, v213, v230, v238 op_sel_hi:[1,0,0]
v_fma_mix_f32 v203, v213, v231, v239 op_sel:[1,0,0] op_sel_hi:[1,0,0]
s_add_u32 m0, s90, 147456
s_add_u32 s91, s83, 147456
buffer_load_dwordx4 v8, s[40:43], s91 offen sc1 lds
v_mfma_f32_16x16x32_bf16 v[24:27], a[222:225], v[156:159], v[24:27]
ds_read_b128 v[188:191], v12 offset:1680
v_cvt_pk_bf16_f32 v164, v200, v201
v_mfma_f32_16x16x32_bf16 v[56:59], a[222:225], v[160:163], v[56:59]
ds_read_b128 a[92:95], v10 offset:31744
v_fma_mix_f32 v204, v214, v232, v240 op_sel_hi:[1,0,0]
v_fma_mix_f32 v205, v214, v233, v241 op_sel:[1,0,0] op_sel_hi:[1,0,0]
v_mfma_f32_16x16x32_bf16 v[28:31], a[226:229], v[156:159], v[28:31]
ds_read_b128 v[192:195], v12 offset:4224
v_cvt_pk_bf16_f32 v165, v202, v203
v_fma_mix_f32 v206, v215, v234, v242 op_sel_hi:[1,0,0]
s_and_b32 s91, s90, 1024
s_add_u32 m0, s91, 151552
s_sub_u32 s91, s91, s90
s_add_u32 s91, s91, s83
s_add_u32 s91, s91, 151552
buffer_load_dwordx4 v8, s[40:43], s91 offen sc1 lds
v_mfma_f32_16x16x32_bf16 v[60:63], a[226:229], v[160:163], v[60:63]
ds_read_b128 a[96:99], v10 offset:32768
v_fma_mix_f32 v207, v215, v235, v243 op_sel:[1,0,0] op_sel_hi:[1,0,0]
v_mfma_f32_16x16x32_bf16 v[32:35], a[230:233], v[156:159], v[32:35]
ds_read_b128 v[196:199], v12 offset:4240
v_cvt_pk_bf16_f32 v166, v204, v205
v_cvt_pk_bf16_f32 v167, v206, v207
v_mfma_f32_16x16x32_bf16 v[64:67], a[230:233], v[160:163], v[64:67]
ds_read_b128 a[100:103], v10 offset:33792
v_fma_mix_f32 v200, v116, v168, v176 op_sel_hi:[1,0,0]
v_fma_mix_f32 v201, v116, v169, v177 op_sel:[1,0,0] op_sel_hi:[1,0,0]
v_mfma_f32_16x16x32_bf16 v[36:39], a[234:237], v[156:159], v[36:39]
v_fma_mix_f32 v202, v117, v170, v178 op_sel_hi:[1,0,0]
buffer_load_dwordx4 a[0:3], v249, s[40:43], s96 offen sc1
s_add_u32 s96, s96, 30720
v_mfma_f32_16x16x32_bf16 v[68:71], a[234:237], v[160:163], v[68:71]
ds_read_b128 a[104:107], v10 offset:34816
v_fma_mix_f32 v203, v117, v171, v179 op_sel:[1,0,0] op_sel_hi:[1,0,0]
v_cvt_pk_bf16_f32 v148, v200, v201
v_mfma_f32_16x16x32_bf16 v[40:43], v[156:159], a[238:241], v[40:43]
v_fma_mix_f32 v204, v118, v172, v180 op_sel_hi:[1,0,0]
v_mfma_f32_16x16x32_bf16 v[72:75], v[160:163], a[238:241], v[72:75]
ds_read_b128 a[108:111], v10 offset:35840
v_fma_mix_f32 v205, v118, v173, v181 op_sel:[1,0,0] op_sel_hi:[1,0,0]
v_cvt_pk_bf16_f32 v149, v202, v203
buffer_load_dwordx4 a[4:7], v249, s[40:43], s96 offen sc1
s_add_u32 s96, s96, 30720
v_mfma_f32_16x16x32_bf16 v[44:47], v[156:159], a[242:245], v[44:47]
v_fma_mix_f32 v206, v119, v174, v182 op_sel_hi:[1,0,0]
v_fma_mix_f32 v207, v119, v175, v183 op_sel:[1,0,0] op_sel_hi:[1,0,0]
v_mfma_f32_16x16x32_bf16 v[76:79], v[160:163], a[242:245], v[76:79]
ds_read_b128 a[112:115], v10 offset:36864
v_cvt_pk_bf16_f32 v150, v204, v205
v_mfma_f32_16x16x32_bf16 v[48:51], v[156:159], a[246:249], v[48:51]
v_cvt_pk_bf16_f32 v151, v206, v207
v_fma_mix_f32 v200, v120, v168, v176 op_sel_hi:[1,0,0]
v_mfma_f32_16x16x32_bf16 v[80:83], v[160:163], a[246:249], v[80:83]
ds_read_b128 a[116:119], v11 offset:37888
v_fma_mix_f32 v201, v120, v169, v177 op_sel:[1,0,0] op_sel_hi:[1,0,0]
v_fma_mix_f32 v202, v121, v170, v178 op_sel_hi:[1,0,0]
s_mul_i32 s86, s18, 24576
buffer_load_dwordx4 a[144:147], v16, s[44:47], s86 offen
v_mfma_f32_16x16x32_bf16 a[64:67], a[176:179], v[164:167], a[64:67]
v_add_u32 v13, 61440, v13
v_add_u32 v14, 61440, v14
ds_read_b128 a[120:123], v13 offset:2048
v_fma_mix_f32 v203, v121, v171, v179 op_sel:[1,0,0] op_sel_hi:[1,0,0]
v_mfma_f32_16x16x32_bf16 a[68:71], a[180:183], v[164:167], a[68:71]
ds_read_b128 a[124:127], v13 offset:3072
v_cvt_pk_bf16_f32 v152, v200, v201
v_fma_mix_f32 v204, v122, v172, v180 op_sel_hi:[1,0,0]
v_mfma_f32_16x16x32_bf16 a[72:75], a[184:187], v[164:167], a[72:75]
ds_read_b128 a[128:131], v13 offset:4096
v_fma_mix_f32 v205, v122, v173, v181 op_sel:[1,0,0] op_sel_hi:[1,0,0]
v_cvt_pk_bf16_f32 v153, v202, v203
s_add_u32 s86, s86, 15360
buffer_load_dwordx4 a[148:151], v16, s[44:47], s86 offen
v_mfma_f32_16x16x32_bf16 a[76:79], v[164:167], a[188:191], a[76:79]
ds_read_b128 a[132:135], v13 offset:5120
v_fma_mix_f32 v206, v123, v174, v182 op_sel_hi:[1,0,0]
v_mfma_f32_16x16x32_bf16 a[80:83], v[164:167], a[192:195], a[80:83]
ds_read_b128 a[136:139], v13 offset:6144
v_fma_mix_f32 v207, v123, v175, v183 op_sel:[1,0,0] op_sel_hi:[1,0,0]
v_cvt_pk_bf16_f32 v154, v204, v205
v_mfma_f32_16x16x32_bf16 a[84:87], v[164:167], a[196:199], a[84:87]
ds_read_b128 a[140:143], v14 offset:7168
v_cvt_pk_bf16_f32 v155, v206, v207
ds_read_b128 v[228:231], v15 offset:1024
ds_read_b128 v[232:235], v15 offset:1040
ds_read_b128 v[236:239], v15 offset:3584
ds_read_b128 v[240:243], v15 offset:3600
s_waitcnt lgkmcnt(15)
v_mfma_f32_16x16x32_bf16 v[20:23], a[88:91], v[148:151], v[20:23]
ds_read_b128 v[168:171], v12 offset:1792
s_waitcnt lgkmcnt(1)
v_fma_mix_f32 v200, v216, v228, v236 op_sel_hi:[1,0,0]
v_fma_mix_f32 v201, v216, v229, v237 op_sel:[1,0,0] op_sel_hi:[1,0,0]
v_mfma_f32_16x16x32_bf16 v[52:55], a[88:91], v[152:155], v[52:55]
ds_read_b128 a[218:221], v10 offset:38400
v_fma_mix_f32 v202, v217, v230, v238 op_sel_hi:[1,0,0]
v_fma_mix_f32 v203, v217, v231, v239 op_sel:[1,0,0] op_sel_hi:[1,0,0]
buffer_load_dwordx4 a[8:11], v249, s[40:43], s96 offen sc1
s_add_u32 s96, s96, 30720
v_mfma_f32_16x16x32_bf16 v[24:27], a[92:95], v[148:151], v[24:27]
ds_read_b128 v[172:175], v12 offset:1808
v_cvt_pk_bf16_f32 v164, v200, v201
v_mfma_f32_16x16x32_bf16 v[56:59], a[92:95], v[152:155], v[56:59]
ds_read_b128 a[222:225], v10 offset:39424
v_fma_mix_f32 v204, v218, v232, v240 op_sel_hi:[1,0,0]
v_fma_mix_f32 v205, v218, v233, v241 op_sel:[1,0,0] op_sel_hi:[1,0,0]
v_mfma_f32_16x16x32_bf16 v[28:31], a[96:99], v[148:151], v[28:31]
ds_read_b128 v[176:179], v12 offset:4352
v_cvt_pk_bf16_f32 v165, v202, v203
v_fma_mix_f32 v206, v219, v234, v242 op_sel_hi:[1,0,0]
v_mfma_f32_16x16x32_bf16 v[60:63], a[96:99], v[152:155], v[60:63]
ds_read_b128 a[226:229], v10 offset:40448
v_fma_mix_f32 v207, v219, v235, v243 op_sel:[1,0,0] op_sel_hi:[1,0,0]
v_mfma_f32_16x16x32_bf16 v[32:35], a[100:103], v[148:151], v[32:35]
ds_read_b128 v[180:183], v12 offset:4368
v_cvt_pk_bf16_f32 v166, v204, v205
v_cvt_pk_bf16_f32 v167, v206, v207
buffer_load_dwordx4 a[12:15], v249, s[40:43], s96 offen sc1
v_mfma_f32_16x16x32_bf16 v[64:67], a[100:103], v[152:155], v[64:67]
ds_read_b128 a[230:233], v10 offset:41472
v_fma_mix_f32 v200, v124, v184, v192 op_sel_hi:[1,0,0]
v_fma_mix_f32 v201, v124, v185, v193 op_sel:[1,0,0] op_sel_hi:[1,0,0]
v_mfma_f32_16x16x32_bf16 v[36:39], a[104:107], v[148:151], v[36:39]
v_fma_mix_f32 v202, v125, v186, v194 op_sel_hi:[1,0,0]
v_mfma_f32_16x16x32_bf16 v[68:71], a[104:107], v[152:155], v[68:71]
ds_read_b128 a[234:237], v10 offset:42496
v_fma_mix_f32 v203, v125, v187, v195 op_sel:[1,0,0] op_sel_hi:[1,0,0]
v_cvt_pk_bf16_f32 v156, v200, v201
v_mfma_f32_16x16x32_bf16 v[40:43], v[148:151], a[108:111], v[40:43]
v_fma_mix_f32 v204, v126, v188, v196 op_sel_hi:[1,0,0]
v_mfma_f32_16x16x32_bf16 v[72:75], v[152:155], a[108:111], v[72:75]
ds_read_b128 a[238:241], v10 offset:43520
v_fma_mix_f32 v205, v126, v189, v197 op_sel:[1,0,0] op_sel_hi:[1,0,0]
v_cvt_pk_bf16_f32 v157, v202, v203
s_mul_i32 s86, s19, 24576
buffer_load_dwordx4 a[152:155], v16, s[48:51], s86 offen
v_mfma_f32_16x16x32_bf16 v[44:47], v[148:151], a[112:115], v[44:47]
v_fma_mix_f32 v206, v127, v190, v198 op_sel_hi:[1,0,0]
v_fma_mix_f32 v207, v127, v191, v199 op_sel:[1,0,0] op_sel_hi:[1,0,0]
v_mfma_f32_16x16x32_bf16 v[76:79], v[152:155], a[112:115], v[76:79]
ds_read_b128 a[242:245], v10 offset:44544
v_cvt_pk_bf16_f32 v158, v204, v205
v_mfma_f32_16x16x32_bf16 v[48:51], v[148:151], a[116:119], v[48:51]
v_cvt_pk_bf16_f32 v159, v206, v207
v_fma_mix_f32 v200, v128, v184, v192 op_sel_hi:[1,0,0]
v_mfma_f32_16x16x32_bf16 v[80:83], v[152:155], a[116:119], v[80:83]
ds_read_b128 a[246:249], v11 offset:45568
v_fma_mix_f32 v201, v128, v185, v193 op_sel:[1,0,0] op_sel_hi:[1,0,0]
v_fma_mix_f32 v202, v129, v186, v194 op_sel_hi:[1,0,0]
v_mfma_f32_16x16x32_bf16 a[64:67], a[120:123], v[164:167], a[64:67]
ds_read_b128 a[176:179], v13 offset:32768
v_fma_mix_f32 v203, v129, v187, v195 op_sel:[1,0,0] op_sel_hi:[1,0,0]
s_add_u32 s86, s86, 15360
buffer_load_dwordx4 a[156:159], v16, s[48:51], s86 offen
v_mfma_f32_16x16x32_bf16 a[68:71], a[124:127], v[164:167], a[68:71]
ds_read_b128 a[180:183], v13 offset:33792
v_cvt_pk_bf16_f32 v160, v200, v201
v_fma_mix_f32 v204, v130, v188, v196 op_sel_hi:[1,0,0]
v_mfma_f32_16x16x32_bf16 a[72:75], a[128:131], v[164:167], a[72:75]
ds_read_b128 a[184:187], v13 offset:34816
v_fma_mix_f32 v205, v130, v189, v197 op_sel:[1,0,0] op_sel_hi:[1,0,0]
v_cvt_pk_bf16_f32 v161, v202, v203
v_mfma_f32_16x16x32_bf16 a[76:79], v[164:167], a[132:135], a[76:79]
ds_read_b128 a[188:191], v13 offset:35840
v_fma_mix_f32 v206, v131, v190, v198 op_sel_hi:[1,0,0]
v_mfma_f32_16x16x32_bf16 a[80:83], v[164:167], a[136:139], a[80:83]
ds_read_b128 a[192:195], v13 offset:36864
v_fma_mix_f32 v207, v131, v191, v199 op_sel:[1,0,0] op_sel_hi:[1,0,0]
v_cvt_pk_bf16_f32 v162, v204, v205
v_mfma_f32_16x16x32_bf16 a[84:87], v[164:167], a[140:143], a[84:87]
ds_read_b128 a[196:199], v14 offset:37888
v_cvt_pk_bf16_f32 v163, v206, v207
ds_read_b128 v[228:231], v15 offset:1536
ds_read_b128 v[232:235], v15 offset:1552
ds_read_b128 v[236:239], v15 offset:4096
ds_read_b128 v[240:243], v15 offset:4112
s_waitcnt vmcnt(8)
s_barrier
s_waitcnt lgkmcnt(15)
v_mfma_f32_16x16x32_bf16 v[20:23], a[218:221], v[156:159], v[20:23]
ds_read_b128 v[184:187], v12 offset:1920
s_waitcnt lgkmcnt(1)
v_fma_mix_f32 v200, v220, v228, v236 op_sel_hi:[1,0,0]
v_fma_mix_f32 v201, v220, v229, v237 op_sel:[1,0,0] op_sel_hi:[1,0,0]
v_mfma_f32_16x16x32_bf16 v[52:55], a[218:221], v[160:163], v[52:55]
ds_read_b128 a[88:91], v10 offset:46080
v_fma_mix_f32 v202, v221, v230, v238 op_sel_hi:[1,0,0]
v_fma_mix_f32 v203, v221, v231, v239 op_sel:[1,0,0] op_sel_hi:[1,0,0]
buffer_load_dwordx4 a[16:19], v249, s[40:43], s97 offen sc1
s_add_u32 s97, s97, 30720
v_mfma_f32_16x16x32_bf16 v[24:27], a[222:225], v[156:159], v[24:27]
ds_read_b128 v[188:191], v12 offset:1936
v_cvt_pk_bf16_f32 v164, v200, v201
v_mfma_f32_16x16x32_bf16 v[56:59], a[222:225], v[160:163], v[56:59]
ds_read_b128 a[92:95], v10 offset:47104
v_fma_mix_f32 v204, v222, v232, v240 op_sel_hi:[1,0,0]
v_fma_mix_f32 v205, v222, v233, v241 op_sel:[1,0,0] op_sel_hi:[1,0,0]
v_mfma_f32_16x16x32_bf16 v[28:31], a[226:229], v[156:159], v[28:31]
ds_read_b128 v[192:195], v12 offset:4480
v_cvt_pk_bf16_f32 v165, v202, v203
v_fma_mix_f32 v206, v223, v234, v242 op_sel_hi:[1,0,0]
v_mfma_f32_16x16x32_bf16 v[60:63], a[226:229], v[160:163], v[60:63]
ds_read_b128 a[96:99], v10 offset:48128
v_fma_mix_f32 v207, v223, v235, v243 op_sel:[1,0,0] op_sel_hi:[1,0,0]
v_mfma_f32_16x16x32_bf16 v[32:35], a[230:233], v[156:159], v[32:35]
ds_read_b128 v[196:199], v12 offset:4496
v_cvt_pk_bf16_f32 v166, v204, v205
v_cvt_pk_bf16_f32 v167, v206, v207
buffer_load_dwordx4 a[20:23], v249, s[40:43], s97 offen sc1
s_add_u32 s97, s97, 30720
v_mfma_f32_16x16x32_bf16 v[64:67], a[230:233], v[160:163], v[64:67]
ds_read_b128 a[100:103], v10 offset:49152
v_fma_mix_f32 v200, v132, v168, v176 op_sel_hi:[1,0,0]
v_fma_mix_f32 v201, v132, v169, v177 op_sel:[1,0,0] op_sel_hi:[1,0,0]
v_mfma_f32_16x16x32_bf16 v[36:39], a[234:237], v[156:159], v[36:39]
v_fma_mix_f32 v202, v133, v170, v178 op_sel_hi:[1,0,0]
v_mfma_f32_16x16x32_bf16 v[68:71], a[234:237], v[160:163], v[68:71]
ds_read_b128 a[104:107], v10 offset:50176
v_fma_mix_f32 v203, v133, v171, v179 op_sel:[1,0,0] op_sel_hi:[1,0,0]
v_cvt_pk_bf16_f32 v148, v200, v201
v_mfma_f32_16x16x32_bf16 v[40:43], v[156:159], a[238:241], v[40:43]
v_fma_mix_f32 v204, v134, v172, v180 op_sel_hi:[1,0,0]
v_mfma_f32_16x16x32_bf16 v[72:75], v[160:163], a[238:241], v[72:75]
ds_read_b128 a[108:111], v10 offset:51200
v_fma_mix_f32 v205, v134, v173, v181 op_sel:[1,0,0] op_sel_hi:[1,0,0]
v_cvt_pk_bf16_f32 v149, v202, v203
s_mul_i32 s86, s30, s32
s_lshl_b32 s86, s86, 3
buffer_load_dwordx4 a[160:163], v18, s[20:23], s86 offen
v_mfma_f32_16x16x32_bf16 v[44:47], v[156:159], a[242:245], v[44:47]
v_fma_mix_f32 v206, v135, v174, v182 op_sel_hi:[1,0,0]
v_fma_mix_f32 v207, v135, v175, v183 op_sel:[1,0,0] op_sel_hi:[1,0,0]
v_mfma_f32_16x16x32_bf16 v[76:79], v[160:163], a[242:245], v[76:79]
ds_read_b128 a[112:115], v10 offset:52224
v_cvt_pk_bf16_f32 v150, v204, v205
v_mfma_f32_16x16x32_bf16 v[48:51], v[156:159], a[246:249], v[48:51]
v_cvt_pk_bf16_f32 v151, v206, v207
v_fma_mix_f32 v200, v136, v168, v176 op_sel_hi:[1,0,0]
v_mfma_f32_16x16x32_bf16 v[80:83], v[160:163], a[246:249], v[80:83]
ds_read_b128 a[116:119], v11 offset:53248
v_fma_mix_f32 v201, v136, v169, v177 op_sel:[1,0,0] op_sel_hi:[1,0,0]
v_fma_mix_f32 v202, v137, v170, v178 op_sel_hi:[1,0,0]
v_mfma_f32_16x16x32_bf16 a[64:67], a[176:179], v[164:167], a[64:67]
v_add_u32 v13, 61440, v13
v_add_u32 v14, 61440, v14
ds_read_b128 a[120:123], v13 offset:2048
v_fma_mix_f32 v203, v137, v171, v179 op_sel:[1,0,0] op_sel_hi:[1,0,0]
s_movk_i32 s87, 7680
s_cmp_lt_u32 s3, 2
s_cselect_b32 s87, 15360, s87
s_add_u32 s86, s86, s87
buffer_load_dwordx4 a[164:167], v18, s[20:23], s86 offen
v_mfma_f32_16x16x32_bf16 a[68:71], a[180:183], v[164:167], a[68:71]
ds_read_b128 a[124:127], v13 offset:3072
v_cvt_pk_bf16_f32 v152, v200, v201
v_fma_mix_f32 v204, v138, v172, v180 op_sel_hi:[1,0,0]
v_mfma_f32_16x16x32_bf16 a[72:75], a[184:187], v[164:167], a[72:75]
ds_read_b128 a[128:131], v13 offset:4096
v_fma_mix_f32 v205, v138, v173, v181 op_sel:[1,0,0] op_sel_hi:[1,0,0]
v_cvt_pk_bf16_f32 v153, v202, v203
v_mfma_f32_16x16x32_bf16 a[76:79], v[164:167], a[188:191], a[76:79]
ds_read_b128 a[132:135], v13 offset:5120
v_fma_mix_f32 v206, v139, v174, v182 op_sel_hi:[1,0,0]
v_mfma_f32_16x16x32_bf16 a[80:83], v[164:167], a[192:195], a[80:83]
ds_read_b128 a[136:139], v13 offset:6144
v_fma_mix_f32 v207, v139, v175, v183 op_sel:[1,0,0] op_sel_hi:[1,0,0]
v_cvt_pk_bf16_f32 v154, v204, v205
v_mfma_f32_16x16x32_bf16 a[84:87], v[164:167], a[196:199], a[84:87]
ds_read_b128 a[140:143], v14 offset:7168
v_cvt_pk_bf16_f32 v155, v206, v207
ds_read_b128 v[228:231], v15 offset:2048
ds_read_b128 v[232:235], v15 offset:2064
ds_read_b128 v[236:239], v15 offset:4608
ds_read_b128 v[240:243], v15 offset:4624
s_waitcnt lgkmcnt(15)
v_mfma_f32_16x16x32_bf16 v[20:23], a[88:91], v[148:151], v[20:23]
ds_read_b128 v[168:171], v12 offset:2048
s_waitcnt lgkmcnt(1)
v_fma_mix_f32 v200, v224, v228, v236 op_sel_hi:[1,0,0]
v_fma_mix_f32 v201, v224, v229, v237 op_sel:[1,0,0] op_sel_hi:[1,0,0]
v_mfma_f32_16x16x32_bf16 v[52:55], a[88:91], v[152:155], v[52:55]
ds_read_b128 a[218:221], v10 offset:53760
v_fma_mix_f32 v202, v225, v230, v238 op_sel_hi:[1,0,0]
v_fma_mix_f32 v203, v225, v231, v239 op_sel:[1,0,0] op_sel_hi:[1,0,0]
buffer_load_dwordx4 a[24:27], v249, s[40:43], s97 offen sc1
s_add_u32 s97, s97, 30720
v_mfma_f32_16x16x32_bf16 v[24:27], a[92:95], v[148:151], v[24:27]
ds_read_b128 v[172:175], v12 offset:2064
v_cvt_pk_bf16_f32 v164, v200, v201
v_mfma_f32_16x16x32_bf16 v[56:59], a[92:95], v[152:155], v[56:59]
ds_read_b128 a[222:225], v10 offset:54784
v_fma_mix_f32 v204, v226, v232, v240 op_sel_hi:[1,0,0]
v_fma_mix_f32 v205, v226, v233, v241 op_sel:[1,0,0] op_sel_hi:[1,0,0]
v_mfma_f32_16x16x32_bf16 v[28:31], a[96:99], v[148:151], v[28:31]
ds_read_b128 v[176:179], v12 offset:4608
v_cvt_pk_bf16_f32 v165, v202, v203
v_fma_mix_f32 v206, v227, v234, v242 op_sel_hi:[1,0,0]
v_mfma_f32_16x16x32_bf16 v[60:63], a[96:99], v[152:155], v[60:63]
ds_read_b128 a[226:229], v10 offset:55808
v_fma_mix_f32 v207, v227, v235, v243 op_sel:[1,0,0] op_sel_hi:[1,0,0]
v_mfma_f32_16x16x32_bf16 v[32:35], a[100:103], v[148:151], v[32:35]
ds_read_b128 v[180:183], v12 offset:4624
v_cvt_pk_bf16_f32 v166, v204, v205
v_cvt_pk_bf16_f32 v167, v206, v207
buffer_load_dwordx4 a[28:31], v249, s[40:43], s97 offen sc1
v_mfma_f32_16x16x32_bf16 v[64:67], a[100:103], v[152:155], v[64:67]
ds_read_b128 a[230:233], v10 offset:56832
v_fma_mix_f32 v200, v140, v184, v192 op_sel_hi:[1,0,0]
v_fma_mix_f32 v201, v140, v185, v193 op_sel:[1,0,0] op_sel_hi:[1,0,0]
v_mfma_f32_16x16x32_bf16 v[36:39], a[104:107], v[148:151], v[36:39]
v_fma_mix_f32 v202, v141, v186, v194 op_sel_hi:[1,0,0]
v_mfma_f32_16x16x32_bf16 v[68:71], a[104:107], v[152:155], v[68:71]
ds_read_b128 a[234:237], v10 offset:57856
v_fma_mix_f32 v203, v141, v187, v195 op_sel:[1,0,0] op_sel_hi:[1,0,0]
v_cvt_pk_bf16_f32 v156, v200, v201
v_mfma_f32_16x16x32_bf16 v[40:43], v[148:151], a[108:111], v[40:43]
v_fma_mix_f32 v204, v142, v188, v196 op_sel_hi:[1,0,0]
v_mfma_f32_16x16x32_bf16 v[72:75], v[152:155], a[108:111], v[72:75]
ds_read_b128 a[238:241], v10 offset:58880
v_fma_mix_f32 v205, v142, v189, v197 op_sel:[1,0,0] op_sel_hi:[1,0,0]
v_cvt_pk_bf16_f32 v157, v202, v203
s_mul_i32 s86, s31, 10240
buffer_load_dwordx4 a[168:171], v17, s[52:55], s86 offen
v_mfma_f32_16x16x32_bf16 v[44:47], v[148:151], a[112:115], v[44:47]
v_fma_mix_f32 v206, v143, v190, v198 op_sel_hi:[1,0,0]
v_fma_mix_f32 v207, v143, v191, v199 op_sel:[1,0,0] op_sel_hi:[1,0,0]
v_mfma_f32_16x16x32_bf16 v[76:79], v[152:155], a[112:115], v[76:79]
ds_read_b128 a[242:245], v10 offset:59904
v_cvt_pk_bf16_f32 v158, v204, v205
v_mfma_f32_16x16x32_bf16 v[48:51], v[148:151], a[116:119], v[48:51]
v_cvt_pk_bf16_f32 v159, v206, v207
v_fma_mix_f32 v200, v144, v184, v192 op_sel_hi:[1,0,0]
v_mfma_f32_16x16x32_bf16 v[80:83], v[152:155], a[116:119], v[80:83]
ds_read_b128 a[246:249], v11 offset:60928
v_fma_mix_f32 v201, v144, v185, v193 op_sel:[1,0,0] op_sel_hi:[1,0,0]
v_fma_mix_f32 v202, v145, v186, v194 op_sel_hi:[1,0,0]
v_mfma_f32_16x16x32_bf16 a[64:67], a[120:123], v[164:167], a[64:67]
v_fma_mix_f32 v203, v145, v187, v195 op_sel:[1,0,0] op_sel_hi:[1,0,0]
s_add_u32 s86, s86, 7680
buffer_load_dwordx4 a[172:175], v17, s[52:55], s86 offen
v_mfma_f32_16x16x32_bf16 a[68:71], a[124:127], v[164:167], a[68:71]
v_cvt_pk_bf16_f32 v160, v200, v201
v_fma_mix_f32 v204, v146, v188, v196 op_sel_hi:[1,0,0]
v_mfma_f32_16x16x32_bf16 a[72:75], a[128:131], v[164:167], a[72:75]
v_fma_mix_f32 v205, v146, v189, v197 op_sel:[1,0,0] op_sel_hi:[1,0,0]
v_cvt_pk_bf16_f32 v161, v202, v203
v_mfma_f32_16x16x32_bf16 a[76:79], v[164:167], a[132:135], a[76:79]
v_fma_mix_f32 v206, v147, v190, v198 op_sel_hi:[1,0,0]
v_mfma_f32_16x16x32_bf16 a[80:83], v[164:167], a[136:139], a[80:83]
v_fma_mix_f32 v207, v147, v191, v199 op_sel:[1,0,0] op_sel_hi:[1,0,0]
v_cvt_pk_bf16_f32 v162, v204, v205
v_mfma_f32_16x16x32_bf16 a[84:87], v[164:167], a[140:143], a[84:87]
v_cvt_pk_bf16_f32 v163, v206, v207
s_add_u32 s72, s8, 2
v_subrev_u32 v19, s72, v19
v_cmp_lt_u32 vcc, 13, v19
s_nop 3
s_cbranch_vccnz L_slow_13
L_back_14:
s_barrier
s_and_b32 s11, s5, 7
s_mul_i32 s84, s11, 102400
s_mul_i32 s85, s3, 25600
s_add_u32 s84, s84, s85
s_add_u32 s84, s84, 16777216
s_waitcnt lgkmcnt(10)
v_mfma_f32_16x16x32_bf16 v[20:23], a[218:221], v[156:159], v[20:23]
v_add_u32 v10, 61440, v10
v_add_u32 v11, 61440, v11
ds_read_b128 v[184:187], v12 offset:2176
s_waitcnt lgkmcnt(6)
v_fma_mix_f32 v200, v84, v168, v176 op_sel_hi:[1,0,0]
v_fma_mix_f32 v201, v84, v169, v177 op_sel:[1,0,0] op_sel_hi:[1,0,0]
v_mfma_f32_16x16x32_bf16 v[52:55], a[218:221], v[160:163], v[52:55]
ds_read_b128 a[88:91], v10 offset:0
v_fma_mix_f32 v202, v85, v170, v178 op_sel_hi:[1,0,0]
s_add_u32 m0, s85, 0
s_nop 0
buffer_load_dwordx4 v8, s[40:43], s84 offen offset:0 sc1 lds
v_mfma_f32_16x16x32_bf16 v[24:27], a[222:225], v[156:159], v[24:27]
ds_read_b128 v[188:191], v12 offset:2192
v_fma_mix_f32 v203, v85, v171, v179 op_sel:[1,0,0] op_sel_hi:[1,0,0]
v_cvt_pk_bf16_f32 v148, v200, v201
buffer_load_dwordx4 v8, s[40:43], s84 offen offset:1024 sc1 lds
v_mfma_f32_16x16x32_bf16 v[56:59], a[222:225], v[160:163], v[56:59]
ds_read_b128 a[92:95], v10 offset:1024
v_fma_mix_f32 v204, v86, v172, v180 op_sel_hi:[1,0,0]
v_mfma_f32_16x16x32_bf16 v[28:31], a[226:229], v[156:159], v[28:31]
ds_read_b128 v[192:195], v12 offset:4736
v_fma_mix_f32 v205, v86, v173, v181 op_sel:[1,0,0] op_sel_hi:[1,0,0]
v_cvt_pk_bf16_f32 v149, v202, v203
buffer_load_dwordx4 v8, s[40:43], s84 offen offset:2048 sc1 lds
v_mfma_f32_16x16x32_bf16 v[60:63], a[226:229], v[160:163], v[60:63]
ds_read_b128 a[96:99], v10 offset:2048
v_fma_mix_f32 v206, v87, v174, v182 op_sel_hi:[1,0,0]
s_waitcnt lgkmcnt(10)
v_mfma_f32_16x16x32_bf16 v[32:35], a[230:233], v[156:159], v[32:35]
ds_read_b128 v[196:199], v12 offset:4752
v_fma_mix_f32 v207, v87, v175, v183 op_sel:[1,0,0] op_sel_hi:[1,0,0]
v_cvt_pk_bf16_f32 v150, v204, v205
buffer_load_dwordx4 v8, s[40:43], s84 offen offset:3072 sc1 lds
s_add_u32 s84, s84, 4096
v_mfma_f32_16x16x32_bf16 v[64:67], a[230:233], v[160:163], v[64:67]
ds_read_b128 a[100:103], v10 offset:3072
v_cvt_pk_bf16_f32 v151, v206, v207
s_waitcnt lgkmcnt(11)
v_mfma_f32_16x16x32_bf16 v[36:39], a[234:237], v[156:159], v[36:39]
v_fma_mix_f32 v200, v88, v168, v176 op_sel_hi:[1,0,0]
v_fma_mix_f32 v201, v88, v169, v177 op_sel:[1,0,0] op_sel_hi:[1,0,0]
s_add_u32 m0, s85, 4096
s_nop 0
buffer_load_dwordx4 v8, s[40:43], s84 offen offset:0 sc1 lds
v_mfma_f32_16x16x32_bf16 v[68:71], a[234:237], v[160:163], v[68:71]
ds_read_b128 a[104:107], v10 offset:4096
v_fma_mix_f32 v202, v89, v170, v178 op_sel_hi:[1,0,0]
s_waitcnt lgkmcnt(11)
v_mfma_f32_16x16x32_bf16 v[40:43], v[156:159], a[238:241], v[40:43]
v_fma_mix_f32 v203, v89, v171, v179 op_sel:[1,0,0] op_sel_hi:[1,0,0]
v_cvt_pk_bf16_f32 v152, v200, v201
s_mov_b32 s48, s16
s_mov_b32 s49, s17
s_mov_b32 s50, 2621440
s_mov_b32 s51, 0x20000
buffer_load_dwordx2 a[32:33], v250, s[48:51], s33 offen offset:0
v_mfma_f32_16x16x32_bf16 v[72:75], v[160:163], a[238:241], v[72:75]
ds_read_b128 a[108:111], v10 offset:5120
v_fma_mix_f32 v204, v90, v172, v180 op_sel_hi:[1,0,0]
s_waitcnt lgkmcnt(11)
v_mfma_f32_16x16x32_bf16 v[44:47], v[156:159], a[242:245], v[44:47]
v_fma_mix_f32 v205, v90, v173, v181 op_sel:[1,0,0] op_sel_hi:[1,0,0]
v_cvt_pk_bf16_f32 v153, v202, v203
buffer_load_dwordx2 a[34:35], v250, s[48:51], s33 offen offset:32
v_mfma_f32_16x16x32_bf16 v[76:79], v[160:163], a[242:245], v[76:79]
ds_read_b128 a[112:115], v10 offset:6144
v_fma_mix_f32 v206, v91, v174, v182 op_sel_hi:[1,0,0]
s_waitcnt lgkmcnt(11)
v_mfma_f32_16x16x32_bf16 v[48:51], v[156:159], a[246:249], v[48:51]
v_fma_mix_f32 v207, v91, v175, v183 op_sel:[1,0,0] op_sel_hi:[1,0,0]
v_cvt_pk_bf16_f32 v154, v204, v205
buffer_load_dwordx2 a[36:37], v250, s[48:51], s33 offen offset:64
v_mfma_f32_16x16x32_bf16 v[80:83], v[160:163], a[246:249], v[80:83]
ds_read_b128 a[116:119], v11 offset:7168
v_cvt_pk_bf16_f32 v155, v206, v207
s_waitcnt lgkmcnt(10)
v_mfma_f32_16x16x32_bf16 v[20:23], a[88:91], v[148:151], v[20:23]
ds_read_b128 v[168:171], v12 offset:2304
s_waitcnt lgkmcnt(6)
v_fma_mix_f32 v200, v92, v184, v192 op_sel_hi:[1,0,0]
v_fma_mix_f32 v201, v92, v185, v193 op_sel:[1,0,0] op_sel_hi:[1,0,0]
v_mfma_f32_16x16x32_bf16 v[52:55], a[88:91], v[152:155], v[52:55]
ds_read_b128 a[218:221], v10 offset:7680
v_fma_mix_f32 v202, v93, v186, v194 op_sel_hi:[1,0,0]
buffer_load_dwordx4 v8, s[40:43], s84 offen offset:1024 sc1 lds
v_mfma_f32_16x16x32_bf16 v[24:27], a[92:95], v[148:151], v[24:27]
ds_read_b128 v[172:175], v12 offset:2320
v_fma_mix_f32 v203, v93, v187, v195 op_sel:[1,0,0] op_sel_hi:[1,0,0]
v_cvt_pk_bf16_f32 v156, v200, v201
buffer_load_dwordx4 v8, s[40:43], s84 offen offset:2048 sc1 lds
v_mfma_f32_16x16x32_bf16 v[56:59], a[92:95], v[152:155], v[56:59]
ds_read_b128 a[222:225], v10 offset:8704
v_fma_mix_f32 v204, v94, v188, v196 op_sel_hi:[1,0,0]
v_mfma_f32_16x16x32_bf16 v[28:31], a[96:99], v[148:151], v[28:31]
ds_read_b128 v[176:179], v12 offset:4864
v_fma_mix_f32 v205, v94, v189, v197 op_sel:[1,0,0] op_sel_hi:[1,0,0]
v_cvt_pk_bf16_f32 v157, v202, v203
buffer_load_dwordx4 v8, s[40:43], s84 offen offset:3072 sc1 lds
s_add_u32 s84, s84, 4096
v_mfma_f32_16x16x32_bf16 v[60:63], a[96:99], v[152:155], v[60:63]
ds_read_b128 a[226:229], v10 offset:9728
v_fma_mix_f32 v206, v95, v190, v198 op_sel_hi:[1,0,0]
s_waitcnt lgkmcnt(10)
v_mfma_f32_16x16x32_bf16 v[32:35], a[100:103], v[148:151], v[32:35]
ds_read_b128 v[180:183], v12 offset:4880
v_fma_mix_f32 v207, v95, v191, v199 op_sel:[1,0,0] op_sel_hi:[1,0,0]
v_cvt_pk_bf16_f32 v158, v204, v205
s_add_u32 m0, s85, 8192
s_nop 0
buffer_load_dwordx4 v8, s[40:43], s84 offen offset:0 sc1 lds
v_mfma_f32_16x16x32_bf16 v[64:67], a[100:103], v[152:155], v[64:67]
ds_read_b128 a[230:233], v10 offset:10752
v_cvt_pk_bf16_f32 v159, v206, v207
s_waitcnt lgkmcnt(11)
v_mfma_f32_16x16x32_bf16 v[36:39], a[104:107], v[148:151], v[36:39]
v_fma_mix_f32 v200, v96, v184, v192 op_sel_hi:[1,0,0]
v_fma_mix_f32 v201, v96, v185, v193 op_sel:[1,0,0] op_sel_hi:[1,0,0]
buffer_load_dwordx4 v8, s[40:43], s84 offen offset:1024 sc1 lds
v_mfma_f32_16x16x32_bf16 v[68:71], a[104:107], v[152:155], v[68:71]
ds_read_b128 a[234:237], v10 offset:11776
v_fma_mix_f32 v202, v97, v186, v194 op_sel_hi:[1,0,0]
s_waitcnt lgkmcnt(11)
v_mfma_f32_16x16x32_bf16 v[40:43], v[148:151], a[108:111], v[40:43]
v_fma_mix_f32 v203, v97, v187, v195 op_sel:[1,0,0] op_sel_hi:[1,0,0]
v_cvt_pk_bf16_f32 v160, v200, v201
buffer_load_dwordx2 a[38:39], v250, s[48:51], s33 offen offset:96
v_mfma_f32_16x16x32_bf16 v[72:75], v[152:155], a[108:111], v[72:75]
ds_read_b128 a[238:241], v10 offset:12800
v_fma_mix_f32 v204, v98, v188, v196 op_sel_hi:[1,0,0]
s_waitcnt lgkmcnt(11)
v_mfma_f32_16x16x32_bf16 v[44:47], v[148:151], a[112:115], v[44:47]
v_fma_mix_f32 v205, v98, v189, v197 op_sel:[1,0,0] op_sel_hi:[1,0,0]
v_cvt_pk_bf16_f32 v161, v202, v203
buffer_load_dwordx2 a[40:41], v250, s[48:51], s33 offen offset:128
v_mfma_f32_16x16x32_bf16 v[76:79], v[152:155], a[112:115], v[76:79]
ds_read_b128 a[242:245], v10 offset:13824
v_fma_mix_f32 v206, v99, v190, v198 op_sel_hi:[1,0,0]
s_waitcnt lgkmcnt(11)
v_mfma_f32_16x16x32_bf16 v[48:51], v[148:151], a[116:119], v[48:51]
v_fma_mix_f32 v207, v99, v191, v199 op_sel:[1,0,0] op_sel_hi:[1,0,0]
v_cvt_pk_bf16_f32 v162, v204, v205
v_mfma_f32_16x16x32_bf16 v[80:83], v[152:155], a[116:119], v[80:83]
ds_read_b128 a[246:249], v11 offset:14848
v_cvt_pk_bf16_f32 v163, v206, v207
s_waitcnt lgkmcnt(10)
v_mfma_f32_16x16x32_bf16 v[20:23], a[218:221], v[156:159], v[20:23]
ds_read_b128 v[184:187], v12 offset:2432
s_waitcnt lgkmcnt(6)
v_fma_mix_f32 v200, v100, v168, v176 op_sel_hi:[1,0,0]
v_fma_mix_f32 v201, v100, v169, v177 op_sel:[1,0,0] op_sel_hi:[1,0,0]
v_mfma_f32_16x16x32_bf16 v[52:55], a[218:221], v[160:163], v[52:55]
ds_read_b128 a[88:91], v10 offset:15360
v_fma_mix_f32 v202, v101, v170, v178 op_sel_hi:[1,0,0]
buffer_load_dwordx4 v8, s[40:43], s84 offen offset:2048 sc1 lds
v_mfma_f32_16x16x32_bf16 v[24:27], a[222:225], v[156:159], v[24:27]
ds_read_b128 v[188:191], v12 offset:2448
v_fma_mix_f32 v203, v101, v171, v179 op_sel:[1,0,0] op_sel_hi:[1,0,0]
v_cvt_pk_bf16_f32 v148, v200, v201
v_mfma_f32_16x16x32_bf16 v[56:59], a[222:225], v[160:163], v[56:59]
ds_read_b128 a[92:95], v10 offset:16384
v_fma_mix_f32 v204, v102, v172, v180 op_sel_hi:[1,0,0]
v_mfma_f32_16x16x32_bf16 v[28:31], a[226:229], v[156:159], v[28:31]
ds_read_b128 v[192:195], v12 offset:4992
v_fma_mix_f32 v205, v102, v173, v181 op_sel:[1,0,0] op_sel_hi:[1,0,0]
v_cvt_pk_bf16_f32 v149, v202, v203
buffer_load_dwordx4 v8, s[40:43], s84 offen offset:3072 sc1 lds
s_add_u32 s84, s84, 4096
v_mfma_f32_16x16x32_bf16 v[60:63], a[226:229], v[160:163], v[60:63]
ds_read_b128 a[96:99], v10 offset:17408
v_fma_mix_f32 v206, v103, v174, v182 op_sel_hi:[1,0,0]
s_waitcnt lgkmcnt(10)
v_mfma_f32_16x16x32_bf16 v[32:35], a[230:233], v[156:159], v[32:35]
ds_read_b128 v[196:199], v12 offset:5008
v_fma_mix_f32 v207, v103, v175, v183 op_sel:[1,0,0] op_sel_hi:[1,0,0]
v_cvt_pk_bf16_f32 v150, v204, v205
v_mfma_f32_16x16x32_bf16 v[64:67], a[230:233], v[160:163], v[64:67]
ds_read_b128 a[100:103], v10 offset:18432
v_cvt_pk_bf16_f32 v151, v206, v207
s_add_u32 m0, s85, 12288
s_nop 0
buffer_load_dwordx4 v8, s[40:43], s84 offen offset:0 sc1 lds
s_waitcnt lgkmcnt(11)
v_mfma_f32_16x16x32_bf16 v[36:39], a[234:237], v[156:159], v[36:39]
v_fma_mix_f32 v200, v104, v168, v176 op_sel_hi:[1,0,0]
v_fma_mix_f32 v201, v104, v169, v177 op_sel:[1,0,0] op_sel_hi:[1,0,0]
v_mfma_f32_16x16x32_bf16 v[68:71], a[234:237], v[160:163], v[68:71]
ds_read_b128 a[104:107], v10 offset:19456
v_fma_mix_f32 v202, v105, v170, v178 op_sel_hi:[1,0,0]
s_waitcnt lgkmcnt(11)
v_mfma_f32_16x16x32_bf16 v[40:43], v[156:159], a[238:241], v[40:43]
v_fma_mix_f32 v203, v105, v171, v179 op_sel:[1,0,0] op_sel_hi:[1,0,0]
v_cvt_pk_bf16_f32 v152, v200, v201
buffer_load_dwordx4 v8, s[40:43], s84 offen offset:1024 sc1 lds
v_mfma_f32_16x16x32_bf16 v[72:75], v[160:163], a[238:241], v[72:75]
ds_read_b128 a[108:111], v10 offset:20480
v_fma_mix_f32 v204, v106, v172, v180 op_sel_hi:[1,0,0]
s_waitcnt lgkmcnt(11)
v_mfma_f32_16x16x32_bf16 v[44:47], v[156:159], a[242:245], v[44:47]
v_fma_mix_f32 v205, v106, v173, v181 op_sel:[1,0,0] op_sel_hi:[1,0,0]
v_cvt_pk_bf16_f32 v153, v202, v203
v_mfma_f32_16x16x32_bf16 v[76:79], v[160:163], a[242:245], v[76:79]
ds_read_b128 a[112:115], v10 offset:21504
v_fma_mix_f32 v206, v107, v174, v182 op_sel_hi:[1,0,0]
buffer_load_dwordx4 v8, s[40:43], s84 offen offset:2048 sc1 lds
s_waitcnt lgkmcnt(11)
v_mfma_f32_16x16x32_bf16 v[48:51], v[156:159], a[246:249], v[48:51]
v_fma_mix_f32 v207, v107, v175, v183 op_sel:[1,0,0] op_sel_hi:[1,0,0]
v_cvt_pk_bf16_f32 v154, v204, v205
v_mfma_f32_16x16x32_bf16 v[80:83], v[160:163], a[246:249], v[80:83]
ds_read_b128 a[116:119], v11 offset:22528
v_cvt_pk_bf16_f32 v155, v206, v207
s_waitcnt lgkmcnt(10)
v_mfma_f32_16x16x32_bf16 v[20:23], a[88:91], v[148:151], v[20:23]
s_waitcnt lgkmcnt(5)
v_fma_mix_f32 v200, v108, v184, v192 op_sel_hi:[1,0,0]
v_fma_mix_f32 v201, v108, v185, v193 op_sel:[1,0,0] op_sel_hi:[1,0,0]
v_mfma_f32_16x16x32_bf16 v[52:55], a[88:91], v[152:155], v[52:55]
ds_read_b128 a[218:221], v10 offset:23040
v_fma_mix_f32 v202, v109, v186, v194 op_sel_hi:[1,0,0]
buffer_load_dwordx4 v8, s[40:43], s84 offen offset:3072 sc1 lds
s_add_u32 s84, s84, 4096
v_mfma_f32_16x16x32_bf16 v[24:27], a[92:95], v[148:151], v[24:27]
v_fma_mix_f32 v203, v109, v187, v195 op_sel:[1,0,0] op_sel_hi:[1,0,0]
v_cvt_pk_bf16_f32 v156, v200, v201
v_mfma_f32_16x16x32_bf16 v[56:59], a[92:95], v[152:155], v[56:59]
ds_read_b128 a[222:225], v10 offset:24064
v_fma_mix_f32 v204, v110, v188, v196 op_sel_hi:[1,0,0]
v_mfma_f32_16x16x32_bf16 v[28:31], a[96:99], v[148:151], v[28:31]
v_fma_mix_f32 v205, v110, v189, v197 op_sel:[1,0,0] op_sel_hi:[1,0,0]
v_cvt_pk_bf16_f32 v157, v202, v203
s_add_u32 m0, s85, 16384
s_nop 0
buffer_load_dwordx4 v8, s[40:43], s84 offen offset:0 sc1 lds
v_mfma_f32_16x16x32_bf16 v[60:63], a[96:99], v[152:155], v[60:63]
ds_read_b128 a[226:229], v10 offset:25088
v_fma_mix_f32 v206, v111, v190, v198 op_sel_hi:[1,0,0]
s_waitcnt lgkmcnt(7)
v_mfma_f32_16x16x32_bf16 v[32:35], a[100:103], v[148:151], v[32:35]
v_fma_mix_f32 v207, v111, v191, v199 op_sel:[1,0,0] op_sel_hi:[1,0,0]
v_cvt_pk_bf16_f32 v158, v204, v205
v_mfma_f32_16x16x32_bf16 v[64:67], a[100:103], v[152:155], v[64:67]
ds_read_b128 a[230:233], v10 offset:26112
v_cvt_pk_bf16_f32 v159, v206, v207
buffer_load_dwordx4 v8, s[40:43], s84 offen offset:1024 sc1 lds
s_waitcnt lgkmcnt(7)
v_mfma_f32_16x16x32_bf16 v[36:39], a[104:107], v[148:151], v[36:39]
v_fma_mix_f32 v200, v112, v184, v192 op_sel_hi:[1,0,0]
v_fma_mix_f32 v201, v112, v185, v193 op_sel:[1,0,0] op_sel_hi:[1,0,0]
v_mfma_f32_16x16x32_bf16 v[68:71], a[104:107], v[152:155], v[68:71]
ds_read_b128 a[234:237], v10 offset:27136
v_fma_mix_f32 v202, v113, v186, v194 op_sel_hi:[1,0,0]
s_waitcnt lgkmcnt(7)
v_mfma_f32_16x16x32_bf16 v[40:43], v[148:151], a[108:111], v[40:43]
v_fma_mix_f32 v203, v113, v187, v195 op_sel:[1,0,0] op_sel_hi:[1,0,0]
v_cvt_pk_bf16_f32 v160, v200, v201
buffer_load_dwordx4 v8, s[40:43], s84 offen offset:2048 sc1 lds
v_mfma_f32_16x16x32_bf16 v[72:75], v[152:155], a[108:111], v[72:75]
ds_read_b128 a[238:241], v10 offset:28160
v_fma_mix_f32 v204, v114, v188, v196 op_sel_hi:[1,0,0]
s_waitcnt lgkmcnt(7)
v_mfma_f32_16x16x32_bf16 v[44:47], v[148:151], a[112:115], v[44:47]
v_fma_mix_f32 v205, v114, v189, v197 op_sel:[1,0,0] op_sel_hi:[1,0,0]
v_cvt_pk_bf16_f32 v161, v202, v203
v_mfma_f32_16x16x32_bf16 v[76:79], v[152:155], a[112:115], v[76:79]
ds_read_b128 a[242:245], v10 offset:29184
v_fma_mix_f32 v206, v115, v190, v198 op_sel_hi:[1,0,0]
buffer_load_dwordx4 v8, s[40:43], s84 offen offset:3072 sc1 lds
s_add_u32 s84, s84, 4096
s_waitcnt lgkmcnt(7)
v_mfma_f32_16x16x32_bf16 v[48:51], v[148:151], a[116:119], v[48:51]
v_fma_mix_f32 v207, v115, v191, v199 op_sel:[1,0,0] op_sel_hi:[1,0,0]
v_cvt_pk_bf16_f32 v162, v204, v205
v_mfma_f32_16x16x32_bf16 v[80:83], v[152:155], a[116:119], v[80:83]
ds_read_b128 a[246:249], v11 offset:30208
v_cvt_pk_bf16_f32 v163, v206, v207
s_waitcnt lgkmcnt(7)
v_mfma_f32_16x16x32_bf16 v[20:23], a[218:221], v[156:159], v[20:23]
v_mfma_f32_16x16x32_bf16 v[52:55], a[218:221], v[160:163], v[52:55]
s_add_u32 m0, s85, 20480
s_nop 0
buffer_load_dwordx4 v8, s[40:43], s84 offen offset:0 sc1 lds
s_waitcnt lgkmcnt(6)
v_mfma_f32_16x16x32_bf16 v[24:27], a[222:225], v[156:159], v[24:27]
v_mfma_f32_16x16x32_bf16 v[56:59], a[222:225], v[160:163], v[56:59]
s_waitcnt lgkmcnt(5)
v_mfma_f32_16x16x32_bf16 v[28:31], a[226:229], v[156:159], v[28:31]
buffer_load_dwordx4 v8, s[40:43], s84 offen offset:1024 sc1 lds
v_mfma_f32_16x16x32_bf16 v[60:63], a[226:229], v[160:163], v[60:63]
s_waitcnt lgkmcnt(4)
v_mfma_f32_16x16x32_bf16 v[32:35], a[230:233], v[156:159], v[32:35]
v_mfma_f32_16x16x32_bf16 v[64:67], a[230:233], v[160:163], v[64:67]
buffer_load_dwordx4 v8, s[40:43], s84 offen offset:2048 sc1 lds
s_waitcnt lgkmcnt(3)
v_mfma_f32_16x16x32_bf16 v[36:39], a[234:237], v[156:159], v[36:39]
v_mfma_f32_16x16x32_bf16 v[68:71], a[234:237], v[160:163], v[68:71]
s_waitcnt lgkmcnt(2)
v_mfma_f32_16x16x32_bf16 v[40:43], v[156:159], a[238:241], v[40:43]
buffer_load_dwordx4 v8, s[40:43], s84 offen offset:3072 sc1 lds
s_add_u32 s84, s84, 4096
v_mfma_f32_16x16x32_bf16 v[72:75], v[160:163], a[238:241], v[72:75]
s_waitcnt lgkmcnt(1)
v_mfma_f32_16x16x32_bf16 v[44:47], v[156:159], a[242:245], v[44:47]
v_mfma_f32_16x16x32_bf16 v[76:79], v[160:163], a[242:245], v[76:79]
s_add_u32 m0, s85, 24576
s_nop 0
buffer_load_dwordx4 v8, s[40:43], s84 offen offset:0 sc1 lds
s_waitcnt lgkmcnt(0)
v_mfma_f32_16x16x32_bf16 v[48:51], v[156:159], a[246:249], v[48:51]
v_mfma_f32_16x16x32_bf16 v[80:83], v[160:163], a[246:249], v[80:83]
L_attn:
v_mov_b32 v216, 0xf149f2ca
v_mov_b32 v212, 0x3f803f80
v_mov_b32 v213, 0x3f803f80
v_mov_b32 v214, 0x3f803f80
v_mov_b32 v215, 0x3f803f80
s_or_b32 s11, s4, s3
s_cmp_eq_u32 s11, 0
s_cselect_b32 s11, 0xf149f2ca, 0
v_mov_b32 v224, s11
v_mov_b32 v225, s11
v_mov_b32 v226, s11
v_mov_b32 v227, s11
s_mul_i32 s11, s3, 6144
s_add_u32 s11, s11, 114688
v_add_u32 v1, s11, v8
s_mul_i32 s11, s3, 3584
s_add_u32 s11, s11, 102400
v_add_u32 v2, s11, v8
v_lshlrev_b32 v5, 3, v0
v_add_u32 v5, s11, v5
s_lshl_b32 s11, s4, 3
s_lshl_b32 s12, s3, 1
s_add_u32 s11, s11, s12
s_mul_i32 s11, s11, 20480
s_mul_i32 s12, s5, 1280
s_add_u32 s11, s11, s12
s_add_u32 s76, s11, 4194304
s_add_u32 s77, s76, 20480
s_mov_b32 s79, 0x3ea52b5c
s_barrier
ds_write_b128 v1, a[64:67] offset:0
ds_write_b128 v1, a[68:71] offset:1024
ds_write_b128 v1, a[72:75] offset:2048
ds_write_b128 v1, a[76:79] offset:3072
ds_write_b128 v1, a[80:83] offset:4096
ds_write_b128 v1, a[84:87] offset:5120
v_cvt_pk_bf16_f32 v116, v60, v61
v_cvt_pk_bf16_f32 v117, v62, v63
v_cvt_pk_bf16_f32 v120, v64, v65
v_cvt_pk_bf16_f32 v121, v66, v67
v_cvt_pk_bf16_f32 v217, v68, v69
v_mov_b32 v118, v217
s_nop 1
v_permlane32_swap_b32 v217, v118
v_mov_b32 v122, v118
v_cvt_pk_bf16_f32 v217, v70, v71
v_mov_b32 v119, v217
s_nop 1
v_permlane32_swap_b32 v217, v119
v_mov_b32 v123, v119
v_cvt_pk_bf16_f32 v138, v72, v73
v_cvt_pk_bf16_f32 v139, v74, v75
v_cvt_pk_bf16_f32 v142, v76, v77
v_cvt_pk_bf16_f32 v143, v78, v79
v_cvt_pk_bf16_f32 v146, v80, v81
v_cvt_pk_bf16_f32 v147, v82, v83
s_cmp_eq_u32 s3, 3
s_cbranch_scc1 L_noex_15
ds_write_b128 v2, v[116:119]
ds_write_b128 v2, v[120:123] offset:1024
ds_write_b64 v5, v[138:139] offset:2048
ds_write_b64 v5, v[142:143] offset:2560
ds_write_b64 v5, v[146:147] offset:3072
L_noex_15:
s_waitcnt vmcnt(30)
s_mul_i32 s11, s5, 245760
s_add_u32 s11, s11, 17825792
v_lshrrev_b32 v1, 5, v0
v_mul_u32_u24 v1, 81920, v1
v_and_b32 v2, 31, v0
v_lshl_add_u32 v10, v2, 4, v1
v_add_u32 v10, s11, v10
v_lshlrev_b32 v11, 4, v0
v_add_u32 v11, 163840, v11
v_add_u32 v11, s11, v11
s_and_b32 s12, s5, 7
s_mul_i32 s12, s12, 245760
s_add_u32 s12, s12, 22020096
v_lshrrev_b32 v1, 4, v0
v_lshlrev_b32 v1, 10, v1
v_and_b32 v2, 15, v0
v_lshl_add_u32 v12, v2, 4, v1
v_add_u32 v12, s12, v12
v_lshlrev_b32 v13, 4, v0
v_add_u32 v13, 4096, v13
v_add_u32 v13, s12, v13
v_mov_b32 v3, 0x40000000
v_cmp_gt_u32 vcc, 32, v0
s_nop 1
v_cndmask_b32 v11, v3, v11, vcc
v_cmp_gt_u32 vcc, 16, v0
s_nop 1
v_cndmask_b32 v13, v3, v13, vcc
s_cmp_eq_u32 s3, 1
s_cselect_b32 s13, 1024, 0
v_add_u32 v14, s13, v10
v_add_u32 v15, s13, v11
s_cmp_lt_u32 s3, 2
s_cselect_b64 s[74:75], -1, 0
v_cndmask_b32 v14, v12, v14, s[74:75]
v_cndmask_b32 v15, v13, v15, s[74:75]
s_mul_i32 s13, s3, 5120
s_add_u32 s13, s13, 139264
v_lshl_add_u32 v4, v0, 4, s13
v_lshrrev_b32 v1, 4, v0
v_and_b32 v2, 3, v0
v_bfe_u32 v3, v0, 2, 2
v_lshlrev_b32 v1, 5, v1
v_lshl_add_u32 v1, v2, 3, v1
v_add_u32 v1, s13, v1
v_mad_u32_u24 v5, v3, 64, v1
v_mad_u32_u24 v5, v3, 64, v5
v_mad_u32_u24 v5, v3, 64, v5
v_mul_u32_u24 v6, 160, v3
v_add_u32 v6, v6, v1
s_cmp_lt_u32 s3, 2
s_cselect_b64 s[74:75], -1, 0
v_cndmask_b32 v7, v6, v5, s[74:75]
ds_write_b128 v4, a[144:147] offset:0
ds_write_b128 v4, a[148:151] offset:960
ds_write_b128 v4, a[152:155] offset:2048
ds_write_b128 v4, a[156:159] offset:3008
ds_read_b64_tr_b16 v[228:229], v5 offset:0
ds_read_b64_tr_b16 v[230:231], v5 offset:768
ds_read_b64_tr_b16 v[232:233], v5 offset:128
ds_read_b64_tr_b16 v[234:235], v5 offset:896
ds_read_b64_tr_b16 v[236:237], v5 offset:2048
ds_read_b64_tr_b16 v[238:239], v5 offset:2816
ds_read_b64_tr_b16 v[240:241], v5 offset:2176
ds_read_b64_tr_b16 v[242:243], v5 offset:2944
s_and_b32 s87, s18, 1
s_lshr_b32 s86, s18, 1
s_lshl_b32 s86, s86, 11
s_lshl_b32 s87, s87, 9
s_add_u32 s86, s86, s87
s_waitcnt lgkmcnt(4)
buffer_store_dwordx4 v[228:231], v10, s[40:43], s86 offen offset:0 sc1
buffer_store_dwordx4 v[232:235], v11, s[40:43], s86 offen offset:0 sc1
s_and_b32 s87, s19, 1
s_lshr_b32 s86, s19, 1
s_lshl_b32 s86, s86, 11
s_lshl_b32 s87, s87, 9
s_add_u32 s86, s86, s87
s_waitcnt lgkmcnt(0)
buffer_store_dwordx4 v[236:239], v10, s[40:43], s86 offen offset:1024 sc1
buffer_store_dwordx4 v[240:243], v11, s[40:43], s86 offen offset:1024 sc1
ds_write_b128 v4, a[160:163] offset:0
ds_write_b128 v4, a[164:167] offset:960
ds_write_b128 v4, a[168:171] offset:2048
ds_write_b128 v4, a[172:175] offset:3008
s_movk_i32 s13, 640
s_cmp_lt_u32 s3, 2
s_cselect_b32 s13, 768, s13
v_add_u32 v3, s13, v7
ds_read_b64_tr_b16 v[228:229], v7 offset:0
ds_read_b64_tr_b16 v[230:231], v3 offset:0
ds_read_b64_tr_b16 v[232:233], v7 offset:128
ds_read_b64_tr_b16 v[234:235], v3 offset:128
ds_read_b64_tr_b16 v[236:237], v6 offset:2048
ds_read_b64_tr_b16 v[238:239], v6 offset:2688
ds_read_b64_tr_b16 v[240:241], v6 offset:2176
ds_read_b64_tr_b16 v[242:243], v6 offset:2816
s_and_b32 s87, s30, 1
s_lshr_b32 s86, s30, 1
s_lshl_b32 s86, s86, 11
s_lshl_b32 s87, s87, 9
s_add_u32 s86, s86, s87
s_lshr_b32 s88, s30, 2
s_mul_i32 s87, s88, 21846
s_lshr_b32 s87, s87, 16
s_mul_i32 s72, s87, 3
s_sub_u32 s88, s88, s72
s_lshl_b32 s88, s88, 4
s_add_u32 s88, s88, s87
s_mul_i32 s88, s88, 5120
s_and_b32 s87, s30, 3
s_lshl_b32 s87, s87, 8
s_add_u32 s88, s88, s87
s_cmp_lt_u32 s3, 2
s_cselect_b32 s86, s86, s88
s_waitcnt lgkmcnt(4)
buffer_store_dwordx4 v[228:231], v14, s[40:43], s86 offen offset:0 sc1
buffer_store_dwordx4 v[232:235], v15, s[40:43], s86 offen offset:0 sc1
s_lshr_b32 s86, s31, 2
s_mul_i32 s87, s86, 21846
s_lshr_b32 s87, s87, 16
s_mul_i32 s72, s87, 3
s_sub_u32 s86, s86, s72
s_lshl_b32 s86, s86, 4
s_add_u32 s86, s86, s87
s_mul_i32 s86, s86, 5120
s_and_b32 s87, s31, 3
s_lshl_b32 s87, s87, 8
s_add_u32 s86, s86, s87
s_waitcnt lgkmcnt(0)
buffer_store_dwordx4 v[236:239], v12, s[40:43], s86 offen offset:0 sc1
buffer_store_dwordx4 v[240:243], v13, s[40:43], s86 offen offset:0 sc1
s_mul_i32 s11, s3, 3584
s_add_u32 s11, s11, 102400
v_add_u32 v2, s11, v8
v_lshlrev_b32 v5, 3, v0
v_add_u32 v5, s11, v5
v_cvt_pk_bf16_f32 v108, v28, v29
v_cvt_pk_bf16_f32 v109, v30, v31
v_cvt_pk_bf16_f32 v112, v32, v33
v_cvt_pk_bf16_f32 v113, v34, v35
v_cvt_pk_bf16_f32 v217, v36, v37
v_mov_b32 v110, v217
s_nop 1
v_permlane32_swap_b32 v217, v110
v_mov_b32 v114, v110
v_cvt_pk_bf16_f32 v217, v38, v39
v_mov_b32 v111, v217
s_nop 1
v_permlane32_swap_b32 v217, v111
v_mov_b32 v115, v111
v_cvt_pk_bf16_f32 v92, v52, v53
v_cvt_pk_bf16_f32 v93, v54, v55
v_cvt_pk_bf16_f32 v96, v56, v57
v_cvt_pk_bf16_f32 v97, v58, v59
v_cvt_pk_bf16_f32 v217, v68, v69
v_cndmask_b32 v94, 0, v217, s[92:93]
v_cndmask_b32 v98, 0, v217, s[94:95]
v_cvt_pk_bf16_f32 v217, v70, v71
v_cndmask_b32 v95, 0, v217, s[92:93]
v_cndmask_b32 v99, 0, v217, s[94:95]
s_nop 0
v_mfma_f32_16x16x32_bf16 v[164:167], v[108:111], v[92:95], 0
v_mfma_f32_16x16x32_bf16 v[168:171], v[116:119], v[92:95], 0
v_mfma_f32_16x16x32_bf16 v[172:175], v[112:115], v[96:99], 0
v_mfma_f32_16x16x32_bf16 v[176:179], v[120:123], v[96:99], 0
v_cvt_pk_bf16_f32 v126, v40, v41
v_cvt_pk_bf16_f32 v127, v42, v43
v_cvt_pk_bf16_f32 v136, v40, v41
v_cvt_pk_bf16_f32 v137, v42, v43
v_cvt_pk_bf16_f32 v130, v44, v45
v_cvt_pk_bf16_f32 v131, v46, v47
v_cvt_pk_bf16_f32 v140, v44, v45
v_cvt_pk_bf16_f32 v141, v46, v47
v_cvt_pk_bf16_f32 v134, v48, v49
v_cvt_pk_bf16_f32 v135, v50, v51
v_cvt_pk_bf16_f32 v144, v48, v49
v_cvt_pk_bf16_f32 v145, v50, v51
v_cvt_pk_bf16_f32 v84, v20, v21
v_cvt_pk_bf16_f32 v85, v22, v23
v_cvt_pk_bf16_f32 v88, v24, v25
v_cvt_pk_bf16_f32 v89, v26, v27
v_cvt_pk_bf16_f32 v217, v36, v37
v_cndmask_b32 v86, 0, v217, s[92:93]
v_cndmask_b32 v90, 0, v217, s[94:95]
v_cvt_pk_bf16_f32 v217, v38, v39
v_cndmask_b32 v87, 0, v217, s[92:93]
v_cndmask_b32 v91, 0, v217, s[94:95]
s_waitcnt lgkmcnt(0)
s_barrier
s_cmp_eq_u32 s3, 0
s_cbranch_scc1 L_w0_16
v_subrev_u32 v2, 3584, v2
v_subrev_u32 v5, 3584, v5
ds_read_b128 v[100:103], v2
ds_read_b128 v[104:107], v2 offset:1024
ds_read_b64 v[124:125], v5 offset:2048
ds_read_b64 v[128:129], v5 offset:2560
ds_read_b64 v[132:133], v5 offset:3072
s_branch L_prevj_17
L_w0_16:
v_add_u32 v1, 114688, v8
ds_read_b128 v[228:231], v1 offset:0
ds_read_b128 v[232:235], v1 offset:1024
ds_read_b128 v[236:239], v1 offset:2048
ds_read_b128 v[240:243], v1 offset:3072
ds_read_b128 v[196:199], v1 offset:4096
ds_read_b128 v[200:203], v1 offset:5120
ds_read_b128 v[180:183], v1 offset:6144
ds_read_b128 v[184:187], v1 offset:7168
ds_read_b128 v[188:191], v1 offset:8192
ds_read_b128 v[192:195], v1 offset:9216
ds_read_b128 v[148:151], v1 offset:10240
ds_read_b128 v[152:155], v1 offset:11264
s_waitcnt lgkmcnt(0)
v_pk_add_f32 v[228:229], v[228:229], v[180:181]
v_pk_add_f32 v[230:231], v[230:231], v[182:183]
v_pk_add_f32 v[232:233], v[232:233], v[184:185]
v_pk_add_f32 v[234:235], v[234:235], v[186:187]
v_pk_add_f32 v[236:237], v[236:237], v[188:189]
v_pk_add_f32 v[238:239], v[238:239], v[190:191]
v_pk_add_f32 v[240:241], v[240:241], v[192:193]
v_pk_add_f32 v[242:243], v[242:243], v[194:195]
v_pk_add_f32 v[196:197], v[196:197], v[148:149]
v_pk_add_f32 v[198:199], v[198:199], v[150:151]
v_pk_add_f32 v[200:201], v[200:201], v[152:153]
v_pk_add_f32 v[202:203], v[202:203], v[154:155]
ds_read_b128 v[180:183], v1 offset:12288
ds_read_b128 v[184:187], v1 offset:13312
ds_read_b128 v[188:191], v1 offset:14336
ds_read_b128 v[192:195], v1 offset:15360
ds_read_b128 v[148:151], v1 offset:16384
ds_read_b128 v[152:155], v1 offset:17408
s_waitcnt lgkmcnt(0)
v_pk_add_f32 v[228:229], v[228:229], v[180:181]
v_pk_add_f32 v[230:231], v[230:231], v[182:183]
v_pk_add_f32 v[232:233], v[232:233], v[184:185]
v_pk_add_f32 v[234:235], v[234:235], v[186:187]
v_pk_add_f32 v[236:237], v[236:237], v[188:189]
v_pk_add_f32 v[238:239], v[238:239], v[190:191]
v_pk_add_f32 v[240:241], v[240:241], v[192:193]
v_pk_add_f32 v[242:243], v[242:243], v[194:195]
v_pk_add_f32 v[196:197], v[196:197], v[148:149]
v_pk_add_f32 v[198:199], v[198:199], v[150:151]
v_pk_add_f32 v[200:201], v[200:201], v[152:153]
v_pk_add_f32 v[202:203], v[202:203], v[154:155]
ds_read_b128 v[180:183], v1 offset:18432
ds_read_b128 v[184:187], v1 offset:19456
ds_read_b128 v[188:191], v1 offset:20480
ds_read_b128 v[192:195], v1 offset:21504
ds_read_b128 v[148:151], v1 offset:22528
ds_read_b128 v[152:155], v1 offset:23552
s_waitcnt lgkmcnt(0)
v_pk_add_f32 v[228:229], v[228:229], v[180:181]
v_pk_add_f32 v[230:231], v[230:231], v[182:183]
v_pk_add_f32 v[232:233], v[232:233], v[184:185]
v_pk_add_f32 v[234:235], v[234:235], v[186:187]
v_pk_add_f32 v[236:237], v[236:237], v[188:189]
v_pk_add_f32 v[238:239], v[238:239], v[190:191]
v_pk_add_f32 v[240:241], v[240:241], v[192:193]
v_pk_add_f32 v[242:243], v[242:243], v[194:195]
v_pk_add_f32 v[196:197], v[196:197], v[148:149]
v_pk_add_f32 v[198:199], v[198:199], v[150:151]
v_pk_add_f32 v[200:201], v[200:201], v[152:153]
v_pk_add_f32 v[202:203], v[202:203], v[154:155]
v_cvt_pk_bf16_f32 v100, v228, v229
v_cvt_pk_bf16_f32 v101, v230, v231
v_cvt_pk_bf16_f32 v104, v232, v233
v_cvt_pk_bf16_f32 v105, v234, v235
v_cvt_pk_bf16_f32 v217, v236, v237
v_mov_b32 v102, v217
s_nop 1
v_permlane32_swap_b32 v217, v102
v_mov_b32 v106, v102
v_cvt_pk_bf16_f32 v217, v238, v239
v_mov_b32 v103, v217
s_nop 1
v_permlane32_swap_b32 v217, v103
v_mov_b32 v107, v103
v_cvt_pk_bf16_f32 v124, v240, v241
v_cvt_pk_bf16_f32 v125, v242, v243
v_cvt_pk_bf16_f32 v128, v196, v197
v_cvt_pk_bf16_f32 v129, v198, v199
v_cvt_pk_bf16_f32 v132, v200, v201
v_cvt_pk_bf16_f32 v133, v202, v203
L_prevj_17:
s_waitcnt lgkmcnt(0)
v_mfma_f32_16x16x32_bf16 v[148:151], v[100:103], v[84:87], v[224:227]
v_mfma_f32_16x16x32_bf16 v[152:155], v[108:111], v[84:87], 0
v_mfma_f32_16x16x32_bf16 v[156:159], v[104:107], v[88:91], v[224:227]
v_mfma_f32_16x16x32_bf16 v[160:163], v[112:115], v[88:91], 0
v_cndmask_b32 v164, v216, v164, s[64:65]
v_cndmask_b32 v168, v216, v168, s[56:57]
v_cndmask_b32 v165, v216, v165, s[66:67]
v_cndmask_b32 v169, v216, v169, s[58:59]
v_cndmask_b32 v166, v216, v166, s[68:69]
v_cndmask_b32 v170, v216, v170, s[60:61]
v_cndmask_b32 v167, v216, v167, s[70:71]
v_cndmask_b32 v171, v216, v171, s[62:63]
v_cndmask_b32 v172, v216, v172, s[64:65]
v_cndmask_b32 v176, v216, v176, s[56:57]
v_cndmask_b32 v173, v216, v173, s[66:67]
v_cndmask_b32 v177, v216, v177, s[58:59]
v_cndmask_b32 v174, v216, v174, s[68:69]
v_cndmask_b32 v178, v216, v178, s[60:61]
v_cndmask_b32 v175, v216, v175, s[70:71]
v_cndmask_b32 v179, v216, v179, s[62:63]
v_cndmask_b32 v148, v216, v148, s[64:65]
v_cndmask_b32 v152, v216, v152, s[56:57]
v_cndmask_b32 v149, v216, v149, s[66:67]
v_cndmask_b32 v153, v216, v153, s[58:59]
v_cndmask_b32 v150, v216, v150, s[68:69]
v_cndmask_b32 v154, v216, v154, s[60:61]
v_cndmask_b32 v151, v216, v151, s[70:71]
v_cndmask_b32 v155, v216, v155, s[62:63]
v_cndmask_b32 v156, v216, v156, s[64:65]
v_cndmask_b32 v160, v216, v160, s[56:57]
v_cndmask_b32 v157, v216, v157, s[66:67]
v_cndmask_b32 v161, v216, v161, s[58:59]
v_cndmask_b32 v158, v216, v158, s[68:69]
v_cndmask_b32 v162, v216, v162, s[60:61]
v_cndmask_b32 v159, v216, v159, s[70:71]
v_cndmask_b32 v163, v216, v163, s[62:63]
v_max3_f32 v220, v164, v165, v166
v_max3_f32 v221, v172, v173, v174
v_max3_f32 v222, v148, v149, v150
v_max3_f32 v223, v156, v157, v158
v_max3_f32 v220, v220, v167, v168
v_max3_f32 v221, v221, v175, v176
v_max3_f32 v222, v222, v151, v152
v_max3_f32 v223, v223, v159, v160
v_max3_f32 v220, v220, v169, v170
v_max3_f32 v221, v221, v177, v178
v_max3_f32 v222, v222, v153, v154
v_max3_f32 v223, v223, v161, v162
v_max_f32 v220, v220, v171
v_max_f32 v221, v221, v179
v_max_f32 v222, v222, v155
v_max_f32 v223, v223, v163
v_mov_b32 v196, v220
v_mov_b32 v197, v220
v_mov_b32 v198, v221
v_mov_b32 v199, v221
v_mov_b32 v200, v222
v_mov_b32 v201, v222
v_mov_b32 v202, v223
v_mov_b32 v203, v223
v_permlane16_swap_b32 v196, v197
v_permlane16_swap_b32 v198, v199
v_permlane16_swap_b32 v200, v201
v_permlane16_swap_b32 v202, v203
v_max_f32 v220, v196, v197
v_max_f32 v221, v198, v199
v_max_f32 v222, v200, v201
v_max_f32 v223, v202, v203
v_mov_b32 v196, v220
v_mov_b32 v197, v220
v_mov_b32 v198, v221
v_mov_b32 v199, v221
v_mov_b32 v200, v222
v_mov_b32 v201, v222
v_mov_b32 v202, v223
v_mov_b32 v203, v223
v_permlane32_swap_b32 v196, v197
v_permlane32_swap_b32 v198, v199
v_permlane32_swap_b32 v200, v201
v_permlane32_swap_b32 v202, v203
v_max_f32 v220, v196, v197
v_max_f32 v221, v198, v199
v_max_f32 v222, v200, v201
v_max_f32 v223, v202, v203
v_mul_f32 v220, s79, v220
v_mul_f32 v221, s79, v221
v_mul_f32 v222, s79, v222
v_mul_f32 v223, s79, v223
v_fma_f32 v164, v164, s79, -v220
v_fma_f32 v165, v165, s79, -v220
v_fma_f32 v166, v166, s79, -v220
v_fma_f32 v167, v167, s79, -v220
v_fma_f32 v168, v168, s79, -v220
v_fma_f32 v169, v169, s79, -v220
v_fma_f32 v170, v170, s79, -v220
v_fma_f32 v171, v171, s79, -v220
v_fma_f32 v172, v172, s79, -v221
v_fma_f32 v173, v173, s79, -v221
v_fma_f32 v174, v174, s79, -v221
v_fma_f32 v175, v175, s79, -v221
v_fma_f32 v176, v176, s79, -v221
v_fma_f32 v177, v177, s79, -v221
v_fma_f32 v178, v178, s79, -v221
v_fma_f32 v179, v179, s79, -v221
v_fma_f32 v148, v148, s79, -v222
v_fma_f32 v149, v149, s79, -v222
v_fma_f32 v150, v150, s79, -v222
v_fma_f32 v151, v151, s79, -v222
v_fma_f32 v152, v152, s79, -v222
v_fma_f32 v153, v153, s79, -v222
v_fma_f32 v154, v154, s79, -v222
v_fma_f32 v155, v155, s79, -v222
v_fma_f32 v156, v156, s79, -v223
v_fma_f32 v157, v157, s79, -v223
v_fma_f32 v158, v158, s79, -v223
v_fma_f32 v159, v159, s79, -v223
v_fma_f32 v160, v160, s79, -v223
v_fma_f32 v161, v161, s79, -v223
v_fma_f32 v162, v162, s79, -v223
v_fma_f32 v163, v163, s79, -v223
v_exp_f32 v164, v164
v_exp_f32 v165, v165
v_exp_f32 v166, v166
v_exp_f32 v167, v167
v_exp_f32 v168, v168
v_exp_f32 v169, v169
v_exp_f32 v170, v170
v_exp_f32 v171, v171
v_exp_f32 v172, v172
v_exp_f32 v173, v173
v_exp_f32 v174, v174
v_exp_f32 v175, v175
v_exp_f32 v176, v176
v_exp_f32 v177, v177
v_exp_f32 v178, v178
v_exp_f32 v179, v179
v_exp_f32 v148, v148
v_exp_f32 v149, v149
v_exp_f32 v150, v150
v_exp_f32 v151, v151
v_exp_f32 v152, v152
v_exp_f32 v153, v153
v_exp_f32 v154, v154
v_exp_f32 v155, v155
v_exp_f32 v156, v156
v_exp_f32 v157, v157
v_exp_f32 v158, v158
v_exp_f32 v159, v159
v_exp_f32 v160, v160
v_exp_f32 v161, v161
v_exp_f32 v162, v162
v_exp_f32 v163, v163
v_cvt_pk_bf16_f32 v188, v164, v165
v_cvt_pk_bf16_f32 v189, v166, v167
v_cvt_pk_bf16_f32 v190, v168, v169
v_cvt_pk_bf16_f32 v191, v170, v171
v_cvt_pk_bf16_f32 v192, v172, v173
v_cvt_pk_bf16_f32 v193, v174, v175
v_cvt_pk_bf16_f32 v194, v176, v177
v_cvt_pk_bf16_f32 v195, v178, v179
v_cvt_pk_bf16_f32 v180, v148, v149
v_cvt_pk_bf16_f32 v181, v150, v151
v_cvt_pk_bf16_f32 v182, v152, v153
v_cvt_pk_bf16_f32 v183, v154, v155
v_cvt_pk_bf16_f32 v184, v156, v157
v_cvt_pk_bf16_f32 v185, v158, v159
v_cvt_pk_bf16_f32 v186, v160, v161
v_cvt_pk_bf16_f32 v187, v162, v163
v_mfma_f32_16x16x32_bf16 v[20:23], v[212:215], v[188:191], 0
v_mfma_f32_16x16x32_bf16 v[24:27], v[212:215], v[192:195], 0
v_mfma_f32_16x16x32_bf16 v[28:31], v[136:139], v[188:191], 0
v_mfma_f32_16x16x32_bf16 v[32:35], v[140:143], v[192:195], 0
v_mfma_f32_16x16x32_bf16 v[36:39], v[144:147], v[188:191], 0
v_mfma_f32_16x16x32_bf16 v[40:43], v[144:147], v[192:195], 0
v_mfma_f32_16x16x32_bf16 v[44:47], v[212:215], v[180:183], 0
v_mfma_f32_16x16x32_bf16 v[48:51], v[212:215], v[184:187], 0
v_mfma_f32_16x16x32_bf16 v[52:55], v[124:127], v[180:183], 0
v_mfma_f32_16x16x32_bf16 v[56:59], v[128:131], v[184:187], 0
v_mfma_f32_16x16x32_bf16 v[60:63], v[132:135], v[180:183], 0
v_mfma_f32_16x16x32_bf16 v[64:67], v[132:135], v[184:187], 0
v_rcp_f32 v20, v20
v_rcp_f32 v24, v24
v_cndmask_b32 v36, v40, v36, s[92:93]
v_cndmask_b32 v37, v41, v37, s[92:93]
v_cndmask_b32 v38, v42, v38, s[92:93]
v_cndmask_b32 v39, v43, v39, s[92:93]
v_cndmask_b32 v22, v24, v20, s[92:93]
v_pk_mul_f32 v[28:29], v[28:29], v[20:21] op_sel_hi:[1,0]
v_pk_mul_f32 v[32:33], v[32:33], v[24:25] op_sel_hi:[1,0]
v_pk_mul_f32 v[36:37], v[36:37], v[22:23] op_sel_hi:[1,0]
v_pk_mul_f32 v[30:31], v[30:31], v[20:21] op_sel_hi:[1,0]
v_pk_mul_f32 v[34:35], v[34:35], v[24:25] op_sel_hi:[1,0]
v_pk_mul_f32 v[38:39], v[38:39], v[22:23] op_sel_hi:[1,0]
v_cvt_pk_bf16_f32 v28, v28, v29
v_cvt_pk_bf16_f32 v29, v30, v31
v_cvt_pk_bf16_f32 v32, v32, v33
v_cvt_pk_bf16_f32 v33, v34, v35
v_cvt_pk_bf16_f32 v36, v36, v37
v_cvt_pk_bf16_f32 v37, v38, v39
buffer_store_dwordx2 v[28:29], v245, s[40:43], s77 offen sc1
buffer_store_dwordx2 v[32:33], v246, s[40:43], s77 offen sc1
s_mov_b32 exec_hi, 0
buffer_store_dwordx2 v[36:37], v247, s[40:43], s77 offen sc1
s_mov_b32 exec_hi, -1
v_rcp_f32 v44, v44
v_rcp_f32 v48, v48
v_cndmask_b32 v60, v64, v60, s[92:93]
v_cndmask_b32 v61, v65, v61, s[92:93]
v_cndmask_b32 v62, v66, v62, s[92:93]
v_cndmask_b32 v63, v67, v63, s[92:93]
v_cndmask_b32 v46, v48, v44, s[92:93]
v_pk_mul_f32 v[52:53], v[52:53], v[44:45] op_sel_hi:[1,0]
v_pk_mul_f32 v[56:57], v[56:57], v[48:49] op_sel_hi:[1,0]
v_pk_mul_f32 v[60:61], v[60:61], v[46:47] op_sel_hi:[1,0]
v_pk_mul_f32 v[54:55], v[54:55], v[44:45] op_sel_hi:[1,0]
v_pk_mul_f32 v[58:59], v[58:59], v[48:49] op_sel_hi:[1,0]
v_pk_mul_f32 v[62:63], v[62:63], v[46:47] op_sel_hi:[1,0]
v_cvt_pk_bf16_f32 v52, v52, v53
v_cvt_pk_bf16_f32 v53, v54, v55
v_cvt_pk_bf16_f32 v56, v56, v57
v_cvt_pk_bf16_f32 v57, v58, v59
v_cvt_pk_bf16_f32 v60, v60, v61
v_cvt_pk_bf16_f32 v61, v62, v63
buffer_store_dwordx2 v[52:53], v245, s[40:43], s76 offen sc1
buffer_store_dwordx2 v[56:57], v246, s[40:43], s76 offen sc1
s_mov_b32 exec_hi, 0
buffer_store_dwordx2 v[60:61], v247, s[40:43], s76 offen sc1
s_mov_b32 exec_hi, -1
s_cmp_eq_u32 s28, 0
s_cselect_b32 s44, s24, s26
s_cselect_b32 s45, s25, s27
s_mov_b32 s46, 1966080
s_mov_b32 s47, 0x20000
v_lshrrev_b32 v5, 3, v0
v_and_b32 v6, 7, v0
v_mul_u32_u24 v5, 3072, v5
v_lshl_add_u32 v5, v6, 4, v5
s_mul_i32 s12, s29, 160
s_mul_i32 s13, s3, 40
s_add_u32 s12, s12, s13
s_mul_i32 s12, s12, 3072
s_lshl_b32 s13, s82, 7
s_add_u32 s12, s12, s13
s_cmp_lt_u32 s9, 192
s_cselect_b32 s12, s12, 0x40000000
s_mul_i32 s13, s3, 5120
s_add_u32 m0, s13, 139264
s_nop 0
buffer_load_dwordx4 v5, s[44:47], s12 offen lds
s_add_u32 s12, s12, 24576
s_add_u32 m0, s13, 140288
s_nop 0
buffer_load_dwordx4 v5, s[44:47], s12 offen lds
s_add_u32 s12, s12, 24576
s_add_u32 m0, s13, 141312
s_nop 0
buffer_load_dwordx4 v5, s[44:47], s12 offen lds
s_add_u32 s12, s12, 24576
s_add_u32 m0, s13, 142336
s_nop 0
buffer_load_dwordx4 v5, s[44:47], s12 offen lds
s_add_u32 s12, s12, 24576
s_add_u32 m0, s13, 143360
s_nop 0
buffer_load_dwordx4 v5, s[44:47], s12 offen lds
v_lshlrev_b32 v8, 4, v0
s_lshl_b32 s11, s81, 2
s_add_u32 s11, s11, s3
s_lshl_b32 s13, s4, 3
s_add_u32 s87, s13, s11
v_and_b32 v2, 15, v0
v_lshrrev_b32 v3, 4, v0
v_and_b32 v5, 1, v3
v_lshlrev_b32 v5, 1, v5
v_lshrrev_b32 v6, 1, v3
v_add_u32 v5, v5, v6
v_lshlrev_b32 v5, 8, v5
v_lshl_add_u32 v25, v2, 4, v5
s_mul_i32 s77, s87, 20480
s_mul_i32 s13, s80, 2560
s_add_u32 s77, s77, s13
s_add_u32 s77, s77, 7340032
s_lshl_b32 s76, s4, 1
s_add_u32 s76, s76, s81
s_lshl_b32 s76, s76, 3
s_add_u32 s76, s76, s80
s_lshl_b32 s76, s76, 6
s_lshl_b32 s12, s3, 4
s_add_u32 s76, s76, s12
s_lshl_b32 s76, s76, 3
s_add_u32 s76, s76, 524288
v_lshlrev_b32 v26, 3, v0
v_lshrrev_b32 v5, 2, v0
v_lshlrev_b32 v5, 4, v5
v_add_u32 v5, s5, v5
v_and_b32 v6, 3, v0
v_lshl_add_u32 v5, v5, 2, v6
v_lshlrev_b32 v5, 7, v5
v_add_u32 v23, 8192, v5
s_mul_i32 s12, s5, 3
s_lshr_b32 s12, s12, 1
v_lshrrev_b32 v5, 2, v0
v_and_b32 v6, 1, v5
v_add_u32 v6, s12, v6
v_min_u32 v6, 23, v6
v_bfe_u32 v7, v5, 1, 2
v_mul_u32_u24 v7, 24, v7
v_add_u32 v6, v6, v7
v_lshrrev_b32 v7, 3, v5
v_mul_u32_u24 v7, 96, v7
v_add_u32 v6, v6, v7
v_and_b32 v7, 3, v0
v_lshl_add_u32 v6, v6, 2, v7
v_lshlrev_b32 v6, 7, v6
v_add_u32 v24, 8192, v6
s_lshl_b32 s90, s3, 10
s_mul_i32 s88, s5, 245760
s_add_u32 s88, s88, 17825792
s_add_u32 s88, s88, s90
s_mul_i32 s89, s80, 245760
s_add_u32 s89, s89, 22020096
s_add_u32 s89, s89, s90
s_lshr_b32 s12, s11, 1
s_lshl_b32 s13, s4, 6
s_add_u32 s12, s12, s13
v_lshl_add_u32 v5, v0, 2, s12
v_lshlrev_b32 v5, 7, v5
v_add_u32 v29, 8192, v5
s_mul_i32 s12, s87, 20480
s_add_u32 s12, s12, 4194304
v_add_u32 v9, 61440, v8
s_mov_b32 s55, s12
s_mov_b32 exec_lo, 0xffffffff
s_mov_b32 exec_hi, 0xff
v_accvgpr_read_b32 v32, a0
v_accvgpr_read_b32 v33, a1
v_accvgpr_read_b32 v34, a2
v_accvgpr_read_b32 v35, a3
v_accvgpr_read_b32 v36, a4
v_accvgpr_read_b32 v37, a5
v_accvgpr_read_b32 v38, a6
v_accvgpr_read_b32 v39, a7
v_accvgpr_read_b32 v40, a8
v_accvgpr_read_b32 v41, a9
v_accvgpr_read_b32 v42, a10
v_accvgpr_read_b32 v43, a11
v_accvgpr_read_b32 v44, a12
v_accvgpr_read_b32 v45, a13
v_accvgpr_read_b32 v46, a14
v_accvgpr_read_b32 v47, a15
v_accvgpr_read_b32 v48, a16
v_accvgpr_read_b32 v49, a17
v_accvgpr_read_b32 v50, a18
v_accvgpr_read_b32 v51, a19
v_accvgpr_read_b32 v52, a20
v_accvgpr_read_b32 v53, a21
v_accvgpr_read_b32 v54, a22
v_accvgpr_read_b32 v55, a23
v_accvgpr_read_b32 v56, a24
v_accvgpr_read_b32 v57, a25
v_accvgpr_read_b32 v58, a26
v_accvgpr_read_b32 v59, a27
v_accvgpr_read_b32 v60, a28
v_accvgpr_read_b32 v61, a29
v_accvgpr_read_b32 v62, a30
v_accvgpr_read_b32 v63, a31
s_mov_b32 s73, 200000
L_mgc_20:
v_max_u32 v6, v33, v35
v_min_u32 v7, v33, v35
v_max3_u32 v6, v6, v37, v39
v_min3_u32 v7, v7, v37, v39
v_max3_u32 v6, v6, v41, v43
v_min3_u32 v7, v7, v41, v43
v_max3_u32 v6, v6, v45, v47
v_min3_u32 v7, v7, v45, v47
v_max3_u32 v6, v6, v49, v51
v_min3_u32 v7, v7, v49, v51
v_max3_u32 v6, v6, v53, v55
v_min3_u32 v7, v7, v53, v55
v_max3_u32 v6, v6, v57, v59
v_min3_u32 v7, v7, v57, v59
v_max3_u32 v6, v6, v61, v63
v_min3_u32 v7, v7, v61, v63
v_cmp_ne_u32 vcc, s8, v6
v_cmp_ne_u32 s[74:75], s8, v7
s_nop 3
s_or_b64 vcc, vcc, s[74:75]
s_cbranch_vccz L_mgd_19
s_sub_u32 s73, s73, 1
s_cmp_eq_u32 s73, 0
s_cbranch_scc1 L_mgd_19
s_mul_i32 s11, s80, 80
s_movk_i32 s96, 3200
s_cmp_eq_u32 s3, 0
s_cselect_b32 s96, 1280, s96
s_cmp_eq_u32 s3, 1
s_cselect_b32 s96, 2560, s96
s_add_u32 s96, s96, s11
s_movk_i32 s97, 1920
s_cmp_lt_u32 s3, 2
s_cselect_b32 s97, 2560, s97
s_and_b32 s11, s3, 1
s_mul_i32 s11, s11, 80
s_add_u32 s97, s97, s11
s_mul_i32 s11, s29, 160
s_cmp_lt_u32 s9, 192
s_cselect_b32 s11, s11, 0
s_add_u32 s97, s97, s11
v_lshlrev_b32 v5, 4, v0
s_lshl_b32 s12, s96, 3
s_add_u32 s12, s12, 262144
buffer_load_dwordx4 v[32:35], v5, s[40:43], s12 offen sc1
s_add_u32 s12, s12, 30720
buffer_load_dwordx4 v[36:39], v5, s[40:43], s12 offen sc1
s_add_u32 s12, s12, 30720
buffer_load_dwordx4 v[40:43], v5, s[40:43], s12 offen sc1
s_add_u32 s12, s12, 30720
buffer_load_dwordx4 v[44:47], v5, s[40:43], s12 offen sc1
s_lshl_b32 s12, s97, 3
s_add_u32 s12, s12, 262144
buffer_load_dwordx4 v[48:51], v5, s[40:43], s12 offen sc1
s_add_u32 s12, s12, 30720
buffer_load_dwordx4 v[52:55], v5, s[40:43], s12 offen sc1
s_add_u32 s12, s12, 30720
buffer_load_dwordx4 v[56:59], v5, s[40:43], s12 offen sc1
s_add_u32 s12, s12, 30720
buffer_load_dwordx4 v[60:63], v5, s[40:43], s12 offen sc1
s_waitcnt vmcnt(0)
s_branch L_mgc_20
L_mgd_19:
v_add_f32 v32, v32, v36
v_add_f32 v40, v40, v44
v_add_f32 v32, v32, v40
v_add_f32 v34, v34, v38
v_add_f32 v42, v42, v46
v_add_f32 v34, v34, v42
v_cvt_pk_bf16_f32 v33, v32, v34
v_add_f32 v48, v48, v52
v_add_f32 v56, v56, v60
v_add_f32 v48, v48, v56
v_add_f32 v50, v50, v54
v_add_f32 v58, v58, v62
v_add_f32 v50, v50, v58
v_cvt_pk_bf16_f32 v49, v48, v50
s_cmp_eq_u32 s3, 1
s_cselect_b64 s[74:75], -1, 0
v_lshlrev_b32 v6, 16, v33
v_and_b32 v7, 0xffff0000, v33
v_add_f32 v6, 1.0, v6
v_add_f32 v7, 1.0, v7
v_cvt_pk_bf16_f32 v6, v6, v7
v_cndmask_b32 v33, v33, v6, s[74:75]
s_cmp_lt_u32 s3, 2
s_cselect_b64 s[74:75], -1, 0
v_lshlrev_b32 v6, 16, v49
v_and_b32 v7, 0xffff0000, v49
v_add_f32 v6, 1.0, v6
v_add_f32 v7, 1.0, v7
v_cvt_pk_bf16_f32 v6, v6, v7
v_cndmask_b32 v49, v49, v6, s[74:75]
v_lshlrev_b32 v34, 16, v33
v_and_b32 v35, 0xffff0000, v33
s_min_u32 s11, s3, 2
s_mul_i32 s11, s11, 320
s_add_u32 s11, s11, 159744
v_lshlrev_b32 v5, 3, v0
v_add_u32 v5, s11, v5
ds_write_b64 v5, v[34:35]
s_lshr_b32 s11, s3, 1
s_mul_i32 s11, s11, 384
s_and_b32 s12, s3, 1
s_mul_i32 s12, s12, 160
s_add_u32 s11, s11, s12
s_add_u32 s11, s11, 160768
v_lshlrev_b32 v5, 2, v0
v_add_u32 v5, s11, v5
ds_write_b32 v5, v49
s_mov_b64 exec, -1
s_waitcnt lgkmcnt(0)
s_waitcnt vmcnt(5)
s_add_u32 s72, s8, 4
v_mov_b32 v1, s72
s_mov_b64 exec, 1
buffer_store_dword v1, off, s[40:43], s10 sc1
s_mov_b64 exec, -1
L_p2:
s_waitcnt vmcnt(1)
s_barrier
ds_read_b128 v[128:131], v8 offset:0
ds_read_b128 v[132:135], v8 offset:20480
ds_read_b128 v[136:139], v8 offset:40960
ds_read_b128 v[140:143], v9 offset:0
ds_read_b128 v[144:147], v9 offset:20480
ds_read_b128 v[148:151], v8 offset:1024
ds_read_b128 v[152:155], v8 offset:21504
ds_read_b128 v[156:159], v8 offset:41984
ds_read_b128 v[160:163], v9 offset:1024
s_mov_b32 exec_lo, 0xffff
s_mov_b32 exec_hi, 0x0
s_add_u32 s72, s8, 3
s_mov_b32 s73, 200000
L_poll_21:
buffer_load_dword v6, v29, s[40:43], 0 offen sc1
s_waitcnt vmcnt(0)
v_subrev_u32 v6, s72, v6
v_cmp_lt_u32 vcc, 12, v6
s_sub_u32 s73, s73, 1
s_cmp_eq_u32 s73, 0
s_cbranch_scc1 L_polld_22
s_nop 0
s_cbranch_vccnz L_poll_21
L_polld_22:
s_mov_b64 exec, -1
s_mov_b32 s12, s55
buffer_load_dwordx4 a[64:67], v8, s[40:43], s12 offen offset:0 sc1
buffer_load_dwordx4 a[68:71], v8, s[40:43], s12 offen offset:1024 sc1
buffer_load_dwordx4 a[72:75], v8, s[40:43], s12 offen offset:2048 sc1
buffer_load_dwordx4 a[76:79], v8, s[40:43], s12 offen offset:3072 sc1
s_add_u32 s12, s12, 4096
buffer_load_dwordx4 a[80:83], v8, s[40:43], s12 offen offset:0 sc1
buffer_load_dwordx4 a[84:87], v8, s[40:43], s12 offen offset:1024 sc1
buffer_load_dwordx4 a[88:91], v8, s[40:43], s12 offen offset:2048 sc1
buffer_load_dwordx4 a[92:95], v8, s[40:43], s12 offen offset:3072 sc1
s_add_u32 s12, s12, 4096
buffer_load_dwordx4 a[96:99], v8, s[40:43], s12 offen offset:0 sc1
buffer_load_dwordx4 a[100:103], v8, s[40:43], s12 offen offset:1024 sc1
buffer_load_dwordx4 a[104:107], v8, s[40:43], s12 offen offset:2048 sc1
buffer_load_dwordx4 a[108:111], v8, s[40:43], s12 offen offset:3072 sc1
s_add_u32 s12, s12, 4096
s_mov_b32 s54, s12
v_lshrrev_b32 v3, 4, v0
v_lshlrev_b32 v4, 4, v3
v_add_u32 v4, 159744, v4
ds_read_b128 v[32:35], v4 offset:0
ds_read_b128 v[96:99], v4 offset:320
ds_read_b128 v[36:39], v4 offset:64
ds_read_b128 v[100:103], v4 offset:384
ds_read_b128 v[40:43], v4 offset:128
ds_read_b128 v[104:107], v4 offset:448
ds_read_b128 v[44:47], v4 offset:192
ds_read_b128 v[108:111], v4 offset:512
ds_read_b128 v[48:51], v4 offset:256
ds_read_b128 v[112:115], v4 offset:576
v_and_b32 v2, 15, v0
v_lshrrev_b32 v3, 4, v0
v_lshrrev_b32 v6, 2, v2
v_lshl_add_u32 v6, v3, 3, v6
v_lshlrev_b32 v6, 7, v6
v_and_b32 v7, 3, v2
v_lshl_add_u32 v6, v7, 3, v6
s_lshl_b32 s11, s3, 5
s_add_u32 s11, s11, 139264
v_add_u32 v6, s11, v6
v_lshrrev_b32 v7, 3, v2
v_mul_u32_u24 v7, 384, v7
v_lshl_add_u32 v7, v3, 4, v7
v_add_u32 v7, 160768, v7
ds_read_b128 v[188:191], v7 offset:0
ds_read_b64_tr_b16 v[208:209], v6 offset:0
ds_read_b64_tr_b16 v[210:211], v6 offset:512
ds_read_b128 v[192:195], v7 offset:64
ds_read_b64_tr_b16 v[212:213], v6 offset:4096
ds_read_b64_tr_b16 v[214:215], v6 offset:4608
ds_read_b128 v[196:199], v7 offset:128
ds_read_b64_tr_b16 v[216:217], v6 offset:8192
ds_read_b64_tr_b16 v[218:219], v6 offset:8704
ds_read_b128 v[200:203], v7 offset:192
ds_read_b64_tr_b16 v[220:221], v6 offset:12288
ds_read_b64_tr_b16 v[222:223], v6 offset:12800
ds_read_b128 v[204:207], v7 offset:256
ds_read_b64_tr_b16 v[224:225], v6 offset:16384
ds_read_b64_tr_b16 v[226:227], v6 offset:16896
s_waitcnt lgkmcnt(12)
v_mfma_f32_16x16x32_bf16 v[228:231], v[208:211], v[188:191], 0
s_waitcnt lgkmcnt(9)
v_mfma_f32_16x16x32_bf16 v[228:231], v[212:215], v[192:195], v[228:231]
s_waitcnt lgkmcnt(6)
v_mfma_f32_16x16x32_bf16 v[228:231], v[216:219], v[196:199], v[228:231]
s_waitcnt lgkmcnt(3)
v_mfma_f32_16x16x32_bf16 v[228:231], v[220:223], v[200:203], v[228:231]
s_waitcnt lgkmcnt(0)
v_mfma_f32_16x16x32_bf16 v[228:231], v[224:227], v[204:207], v[228:231]
s_lshl_b32 s11, s29, 1
s_add_u32 s11, s11, s28
s_mul_i32 s11, s11, 3072
s_lshl_b32 s12, s82, 6
s_add_u32 s11, s11, s12
s_lshl_b32 s12, s3, 4
s_add_u32 s11, s11, s12
s_lshl_b32 s11, s11, 2
s_add_u32 s11, s11, 393216
s_cmp_lt_u32 s9, 192
s_cselect_b32 s11, s11, 0x40000000
v_lshrrev_b32 v7, 3, v2
v_mul_u32_u24 v7, 6144, v7
v_lshl_add_u32 v7, v3, 4, v7
s_mov_b32 exec_lo, 0x1010101
s_mov_b32 exec_hi, 0x1010101
buffer_store_dwordx4 v[228:231], v7, s[40:43], s11 offen sc1
s_mov_b64 exec, -1
s_mov_b32 s11, 0xffff0000
v_accvgpr_read_b32 v1, a32
v_lshlrev_b32 v168, 16, v1
v_and_b32 v169, s11, v1
v_accvgpr_read_b32 v1, a33
v_lshlrev_b32 v170, 16, v1
v_and_b32 v171, s11, v1
v_accvgpr_read_b32 v1, a34
v_lshlrev_b32 v172, 16, v1
v_and_b32 v173, s11, v1
v_accvgpr_read_b32 v1, a35
v_lshlrev_b32 v174, 16, v1
v_and_b32 v175, s11, v1
v_accvgpr_read_b32 v1, a36
v_lshlrev_b32 v176, 16, v1
v_and_b32 v177, s11, v1
v_accvgpr_read_b32 v1, a37
v_lshlrev_b32 v178, 16, v1
v_and_b32 v179, s11, v1
v_accvgpr_read_b32 v1, a38
v_lshlrev_b32 v180, 16, v1
v_and_b32 v181, s11, v1
v_accvgpr_read_b32 v1, a39
v_lshlrev_b32 v182, 16, v1
v_and_b32 v183, s11, v1
v_accvgpr_read_b32 v1, a40
v_lshlrev_b32 v184, 16, v1
v_and_b32 v185, s11, v1
v_accvgpr_read_b32 v1, a41
v_lshlrev_b32 v186, 16, v1
v_and_b32 v187, s11, v1
s_mov_b32 s12, s54
buffer_load_dword v21, v23, s[40:43], 0 offen sc1
s_waitcnt vmcnt(13)
v_mfma_f32_16x16x32_bf16 v[64:67], v[128:131], a[64:67], 0
ds_read_b128 v[164:167], v9 offset:21504
v_mfma_f32_16x16x32_bf16 v[68:71], v[132:135], a[64:67], 0
ds_read_b128 v[128:131], v8 offset:2048
buffer_load_dwordx4 a[112:115], v8, s[40:43], s12 offen offset:0 sc1
v_mfma_f32_16x16x32_bf16 v[72:75], v[136:139], a[64:67], 0
ds_read_b128 v[132:135], v8 offset:22528
v_mfma_f32_16x16x32_bf16 v[76:79], v[140:143], a[64:67], 0
ds_read_b128 v[136:139], v8 offset:43008
v_mfma_f32_16x16x32_bf16 v[80:83], v[144:147], a[64:67], 0
ds_read_b128 v[140:143], v9 offset:2048
s_waitcnt vmcnt(13)
v_mfma_f32_16x16x32_bf16 v[64:67], v[148:151], a[68:71], v[64:67]
ds_read_b128 v[144:147], v9 offset:22528
v_mfma_f32_16x16x32_bf16 v[68:71], v[152:155], a[68:71], v[68:71]
ds_read_b128 v[148:151], v8 offset:3072
buffer_load_dwordx4 a[116:119], v8, s[40:43], s12 offen offset:1024 sc1
v_mfma_f32_16x16x32_bf16 v[72:75], v[156:159], a[68:71], v[72:75]
ds_read_b128 v[152:155], v8 offset:23552
v_mfma_f32_16x16x32_bf16 v[76:79], v[160:163], a[68:71], v[76:79]
ds_read_b128 v[156:159], v8 offset:44032
s_waitcnt lgkmcnt(8)
v_mfma_f32_16x16x32_bf16 v[80:83], v[164:167], a[68:71], v[80:83]
ds_read_b128 v[160:163], v9 offset:3072
s_waitcnt vmcnt(13)
s_waitcnt lgkmcnt(8)
v_mfma_f32_16x16x32_bf16 v[64:67], v[128:131], a[72:75], v[64:67]
ds_read_b128 v[164:167], v9 offset:23552
s_waitcnt lgkmcnt(8)
v_mfma_f32_16x16x32_bf16 v[68:71], v[132:135], a[72:75], v[68:71]
ds_read_b128 v[128:131], v8 offset:4096
buffer_load_dwordx4 a[120:123], v8, s[40:43], s12 offen offset:2048 sc1
s_waitcnt lgkmcnt(8)
v_mfma_f32_16x16x32_bf16 v[72:75], v[136:139], a[72:75], v[72:75]
ds_read_b128 v[132:135], v8 offset:24576
s_waitcnt lgkmcnt(8)
v_mfma_f32_16x16x32_bf16 v[76:79], v[140:143], a[72:75], v[76:79]
ds_read_b128 v[136:139], v8 offset:45056
s_waitcnt lgkmcnt(8)
v_mfma_f32_16x16x32_bf16 v[80:83], v[144:147], a[72:75], v[80:83]
ds_read_b128 v[140:143], v9 offset:4096
s_waitcnt vmcnt(13)
s_waitcnt lgkmcnt(8)
v_mfma_f32_16x16x32_bf16 v[64:67], v[148:151], a[76:79], v[64:67]
ds_read_b128 v[144:147], v9 offset:24576
s_waitcnt lgkmcnt(8)
v_mfma_f32_16x16x32_bf16 v[68:71], v[152:155], a[76:79], v[68:71]
ds_read_b128 v[148:151], v8 offset:5120
buffer_load_dwordx4 a[124:127], v8, s[40:43], s12 offen offset:3072 sc1
s_add_u32 s12, s12, 4096
s_waitcnt lgkmcnt(8)
v_mfma_f32_16x16x32_bf16 v[72:75], v[156:159], a[76:79], v[72:75]
ds_read_b128 v[152:155], v8 offset:25600
s_waitcnt lgkmcnt(8)
v_mfma_f32_16x16x32_bf16 v[76:79], v[160:163], a[76:79], v[76:79]
ds_read_b128 v[156:159], v8 offset:46080
s_waitcnt lgkmcnt(8)
v_mfma_f32_16x16x32_bf16 v[80:83], v[164:167], a[76:79], v[80:83]
ds_read_b128 v[160:163], v9 offset:5120
s_waitcnt vmcnt(13)
s_waitcnt lgkmcnt(8)
v_mfma_f32_16x16x32_bf16 v[64:67], v[128:131], a[80:83], v[64:67]
ds_read_b128 v[164:167], v9 offset:25600
s_waitcnt lgkmcnt(8)
v_mfma_f32_16x16x32_bf16 v[68:71], v[132:135], a[80:83], v[68:71]
ds_read_b128 v[128:131], v8 offset:6144
buffer_load_dwordx4 a[128:131], v8, s[40:43], s12 offen offset:0 sc1
s_waitcnt lgkmcnt(8)
v_mfma_f32_16x16x32_bf16 v[72:75], v[136:139], a[80:83], v[72:75]
ds_read_b128 v[132:135], v8 offset:26624
s_waitcnt lgkmcnt(8)
v_mfma_f32_16x16x32_bf16 v[76:79], v[140:143], a[80:83], v[76:79]
ds_read_b128 v[136:139], v8 offset:47104
s_waitcnt lgkmcnt(8)
v_mfma_f32_16x16x32_bf16 v[80:83], v[144:147], a[80:83], v[80:83]
ds_read_b128 v[140:143], v9 offset:6144
s_waitcnt vmcnt(13)
s_waitcnt lgkmcnt(8)
v_mfma_f32_16x16x32_bf16 v[64:67], v[148:151], a[84:87], v[64:67]
ds_read_b128 v[144:147], v9 offset:26624
s_waitcnt lgkmcnt(8)
v_mfma_f32_16x16x32_bf16 v[68:71], v[152:155], a[84:87], v[68:71]
ds_read_b128 v[148:151], v8 offset:7168
buffer_load_dwordx4 a[132:135], v8, s[40:43], s12 offen offset:1024 sc1
s_waitcnt lgkmcnt(8)
v_mfma_f32_16x16x32_bf16 v[72:75], v[156:159], a[84:87], v[72:75]
ds_read_b128 v[152:155], v8 offset:27648
s_waitcnt lgkmcnt(8)
v_mfma_f32_16x16x32_bf16 v[76:79], v[160:163], a[84:87], v[76:79]
ds_read_b128 v[156:159], v8 offset:48128
s_waitcnt lgkmcnt(8)
v_mfma_f32_16x16x32_bf16 v[80:83], v[164:167], a[84:87], v[80:83]
ds_read_b128 v[160:163], v9 offset:7168
s_waitcnt vmcnt(13)
s_waitcnt lgkmcnt(8)
v_mfma_f32_16x16x32_bf16 v[64:67], v[128:131], a[88:91], v[64:67]
ds_read_b128 v[164:167], v9 offset:27648
s_waitcnt vmcnt(6)
s_add_u32 s72, s8, 4
v_subrev_u32 v21, s72, v21
v_cmp_lt_u32 vcc, 11, v21
s_nop 3
s_cbranch_vccnz L_slow_23
L_back_24:
s_barrier
s_waitcnt lgkmcnt(8)
v_mfma_f32_16x16x32_bf16 v[68:71], v[132:135], a[88:91], v[68:71]
ds_read_b128 v[128:131], v8 offset:8192
buffer_load_dwordx4 a[136:139], v8, s[40:43], s12 offen offset:2048 sc1
s_waitcnt lgkmcnt(8)
v_mfma_f32_16x16x32_bf16 v[72:75], v[136:139], a[88:91], v[72:75]
ds_read_b128 v[132:135], v8 offset:28672
s_waitcnt lgkmcnt(8)
v_mfma_f32_16x16x32_bf16 v[76:79], v[140:143], a[88:91], v[76:79]
ds_read_b128 v[136:139], v8 offset:49152
s_add_u32 m0, s90, 102400
s_add_u32 s91, s88, 0
buffer_load_dwordx4 v8, s[40:43], s91 offen sc1 lds
s_waitcnt lgkmcnt(8)
v_mfma_f32_16x16x32_bf16 v[80:83], v[144:147], a[88:91], v[80:83]
ds_read_b128 v[140:143], v9 offset:8192
s_waitcnt lgkmcnt(8)
v_mfma_f32_16x16x32_bf16 v[64:67], v[148:151], a[92:95], v[64:67]
ds_read_b128 v[144:147], v9 offset:28672
s_waitcnt lgkmcnt(8)
v_mfma_f32_16x16x32_bf16 v[68:71], v[152:155], a[92:95], v[68:71]
ds_read_b128 v[148:151], v8 offset:9216
buffer_load_dwordx4 a[140:143], v8, s[40:43], s12 offen offset:3072 sc1
s_waitcnt lgkmcnt(8)
v_mfma_f32_16x16x32_bf16 v[72:75], v[156:159], a[92:95], v[72:75]
ds_read_b128 v[152:155], v8 offset:29696
s_waitcnt lgkmcnt(8)
v_mfma_f32_16x16x32_bf16 v[76:79], v[160:163], a[92:95], v[76:79]
ds_read_b128 v[156:159], v8 offset:50176
s_add_u32 m0, s90, 106496
s_add_u32 s91, s88, 4096
buffer_load_dwordx4 v8, s[40:43], s91 offen sc1 lds
s_waitcnt lgkmcnt(8)
v_mfma_f32_16x16x32_bf16 v[80:83], v[164:167], a[92:95], v[80:83]
ds_read_b128 v[160:163], v9 offset:9216
s_waitcnt lgkmcnt(8)
v_mfma_f32_16x16x32_bf16 v[64:67], v[128:131], a[96:99], v[64:67]
ds_read_b128 v[164:167], v9 offset:29696
s_waitcnt lgkmcnt(8)
v_mfma_f32_16x16x32_bf16 v[68:71], v[132:135], a[96:99], v[68:71]
ds_read_b128 v[128:131], v8 offset:10240
s_waitcnt lgkmcnt(8)
v_mfma_f32_16x16x32_bf16 v[72:75], v[136:139], a[96:99], v[72:75]
ds_read_b128 v[132:135], v8 offset:30720
s_waitcnt lgkmcnt(8)
v_mfma_f32_16x16x32_bf16 v[76:79], v[140:143], a[96:99], v[76:79]
ds_read_b128 v[136:139], v8 offset:51200
s_add_u32 m0, s90, 110592
s_add_u32 s91, s88, 8192
buffer_load_dwordx4 v8, s[40:43], s91 offen sc1 lds
s_waitcnt lgkmcnt(8)
v_mfma_f32_16x16x32_bf16 v[80:83], v[144:147], a[96:99], v[80:83]
ds_read_b128 v[140:143], v9 offset:10240
s_waitcnt lgkmcnt(8)
v_mfma_f32_16x16x32_bf16 v[64:67], v[148:151], a[100:103], v[64:67]
ds_read_b128 v[144:147], v9 offset:30720
s_waitcnt lgkmcnt(8)
v_mfma_f32_16x16x32_bf16 v[68:71], v[152:155], a[100:103], v[68:71]
ds_read_b128 v[148:151], v8 offset:11264
s_waitcnt lgkmcnt(8)
v_mfma_f32_16x16x32_bf16 v[72:75], v[156:159], a[100:103], v[72:75]
ds_read_b128 v[152:155], v8 offset:31744
s_waitcnt lgkmcnt(8)
v_mfma_f32_16x16x32_bf16 v[76:79], v[160:163], a[100:103], v[76:79]
ds_read_b128 v[156:159], v8 offset:52224
s_add_u32 m0, s90, 114688
s_add_u32 s91, s88, 12288
buffer_load_dwordx4 v8, s[40:43], s91 offen sc1 lds
s_waitcnt lgkmcnt(8)
v_mfma_f32_16x16x32_bf16 v[80:83], v[164:167], a[100:103], v[80:83]
ds_read_b128 v[160:163], v9 offset:11264
s_waitcnt lgkmcnt(8)
v_mfma_f32_16x16x32_bf16 v[64:67], v[128:131], a[104:107], v[64:67]
ds_read_b128 v[164:167], v9 offset:31744
s_waitcnt lgkmcnt(8)
v_mfma_f32_16x16x32_bf16 v[68:71], v[132:135], a[104:107], v[68:71]
ds_read_b128 v[128:131], v8 offset:12288
s_waitcnt lgkmcnt(8)
v_mfma_f32_16x16x32_bf16 v[72:75], v[136:139], a[104:107], v[72:75]
ds_read_b128 v[132:135], v8 offset:32768
s_waitcnt lgkmcnt(8)
v_mfma_f32_16x16x32_bf16 v[76:79], v[140:143], a[104:107], v[76:79]
ds_read_b128 v[136:139], v8 offset:53248
s_add_u32 m0, s90, 118784
s_add_u32 s91, s88, 16384
buffer_load_dwordx4 v8, s[40:43], s91 offen sc1 lds
s_waitcnt lgkmcnt(8)
v_mfma_f32_16x16x32_bf16 v[80:83], v[144:147], a[104:107], v[80:83]
ds_read_b128 v[140:143], v9 offset:12288
s_waitcnt lgkmcnt(8)
v_mfma_f32_16x16x32_bf16 v[64:67], v[148:151], a[108:111], v[64:67]
ds_read_b128 v[144:147], v9 offset:32768
s_waitcnt lgkmcnt(8)
v_mfma_f32_16x16x32_bf16 v[68:71], v[152:155], a[108:111], v[68:71]
ds_read_b128 v[148:151], v8 offset:13312
s_waitcnt lgkmcnt(8)
v_mfma_f32_16x16x32_bf16 v[72:75], v[156:159], a[108:111], v[72:75]
ds_read_b128 v[152:155], v8 offset:33792
s_waitcnt lgkmcnt(8)
v_mfma_f32_16x16x32_bf16 v[76:79], v[160:163], a[108:111], v[76:79]
ds_read_b128 v[156:159], v8 offset:54272
s_add_u32 m0, s90, 122880
s_add_u32 s91, s88, 20480
buffer_load_dwordx4 v8, s[40:43], s91 offen sc1 lds
s_waitcnt lgkmcnt(8)
v_mfma_f32_16x16x32_bf16 v[80:83], v[164:167], a[108:111], v[80:83]
ds_read_b128 v[160:163], v9 offset:13312
s_waitcnt vmcnt(13)
s_waitcnt lgkmcnt(8)
v_mfma_f32_16x16x32_bf16 v[64:67], v[128:131], a[112:115], v[64:67]
ds_read_b128 v[164:167], v9 offset:33792
s_add_u32 s72, s8, 5
v_mov_b32 v1, s72
s_mov_b64 exec, 1
buffer_store_dword v1, off, s[40:43], s10 sc1
s_mov_b64 exec, -1
s_waitcnt lgkmcnt(8)
v_mfma_f32_16x16x32_bf16 v[68:71], v[132:135], a[112:115], v[68:71]
ds_read_b128 v[128:131], v8 offset:14336
s_waitcnt lgkmcnt(8)
v_mfma_f32_16x16x32_bf16 v[72:75], v[136:139], a[112:115], v[72:75]
ds_read_b128 v[132:135], v8 offset:34816
s_and_b32 s11, s4, 3
s_mul_i32 s11, s11, 25600
s_lshl_b32 s13, s3, 13
s_add_u32 s11, s11, s13
s_sub_u32 s13, s88, s90
s_add_u32 s11, s11, s13
s_add_u32 s11, s11, 53248
v_lshlrev_b32 v27, 7, v0
s_waitcnt lgkmcnt(8)
v_mfma_f32_16x16x32_bf16 v[76:79], v[140:143], a[112:115], v[76:79]
ds_read_b128 v[136:139], v8 offset:55296
s_add_u32 m0, s90, 126976
s_add_u32 s91, s88, 24576
buffer_load_dwordx4 v8, s[40:43], s91 offen sc1 lds
s_waitcnt lgkmcnt(8)
v_mfma_f32_16x16x32_bf16 v[80:83], v[144:147], a[112:115], v[80:83]
ds_read_b128 v[140:143], v9 offset:14336
buffer_load_dword v254, v27, s[40:43], s11 offen sc1
s_add_u32 s11, s11, 32768
s_waitcnt vmcnt(13)
s_waitcnt lgkmcnt(8)
v_mfma_f32_16x16x32_bf16 v[64:67], v[148:151], a[116:119], v[64:67]
ds_read_b128 v[144:147], v9 offset:34816
s_waitcnt lgkmcnt(8)
v_mfma_f32_16x16x32_bf16 v[68:71], v[152:155], a[116:119], v[68:71]
ds_read_b128 v[148:151], v8 offset:15360
s_waitcnt lgkmcnt(8)
v_mfma_f32_16x16x32_bf16 v[72:75], v[156:159], a[116:119], v[72:75]
ds_read_b128 v[152:155], v8 offset:35840
s_waitcnt lgkmcnt(8)
v_mfma_f32_16x16x32_bf16 v[76:79], v[160:163], a[116:119], v[76:79]
ds_read_b128 v[156:159], v8 offset:56320
s_add_u32 m0, s90, 131072
s_add_u32 s91, s88, 28672
buffer_load_dwordx4 v8, s[40:43], s91 offen sc1 lds
s_waitcnt lgkmcnt(8)
v_mfma_f32_16x16x32_bf16 v[80:83], v[164:167], a[116:119], v[80:83]
ds_read_b128 v[160:163], v9 offset:15360
s_waitcnt vmcnt(13)
s_waitcnt lgkmcnt(8)
v_mfma_f32_16x16x32_bf16 v[64:67], v[128:131], a[120:123], v[64:67]
ds_read_b128 v[164:167], v9 offset:35840
s_waitcnt lgkmcnt(8)
v_mfma_f32_16x16x32_bf16 v[68:71], v[132:135], a[120:123], v[68:71]
ds_read_b128 v[128:131], v8 offset:16384
s_waitcnt lgkmcnt(8)
v_mfma_f32_16x16x32_bf16 v[72:75], v[136:139], a[120:123], v[72:75]
ds_read_b128 v[132:135], v8 offset:36864
s_waitcnt lgkmcnt(8)
v_mfma_f32_16x16x32_bf16 v[76:79], v[140:143], a[120:123], v[76:79]
ds_read_b128 v[136:139], v8 offset:57344
s_add_u32 m0, s90, 135168
s_add_u32 s91, s88, 32768
buffer_load_dwordx4 v8, s[40:43], s91 offen sc1 lds
s_waitcnt lgkmcnt(8)
v_mfma_f32_16x16x32_bf16 v[80:83], v[144:147], a[120:123], v[80:83]
ds_read_b128 v[140:143], v9 offset:16384
s_waitcnt vmcnt(13)
s_waitcnt lgkmcnt(8)
v_mfma_f32_16x16x32_bf16 v[64:67], v[148:151], a[124:127], v[64:67]
ds_read_b128 v[144:147], v9 offset:36864
s_waitcnt lgkmcnt(8)
v_mfma_f32_16x16x32_bf16 v[68:71], v[152:155], a[124:127], v[68:71]
ds_read_b128 v[148:151], v8 offset:17408
s_waitcnt lgkmcnt(8)
v_mfma_f32_16x16x32_bf16 v[72:75], v[156:159], a[124:127], v[72:75]
ds_read_b128 v[152:155], v8 offset:37888
s_waitcnt lgkmcnt(8)
v_mfma_f32_16x16x32_bf16 v[76:79], v[160:163], a[124:127], v[76:79]
ds_read_b128 v[156:159], v8 offset:58368
s_add_u32 m0, s90, 139264
s_add_u32 s91, s88, 36864
buffer_load_dwordx4 v8, s[40:43], s91 offen sc1 lds
s_waitcnt lgkmcnt(8)
v_mfma_f32_16x16x32_bf16 v[80:83], v[164:167], a[124:127], v[80:83]
ds_read_b128 v[160:163], v9 offset:17408
s_waitcnt vmcnt(13)
s_waitcnt lgkmcnt(8)
v_mfma_f32_16x16x32_bf16 v[64:67], v[128:131], a[128:131], v[64:67]
ds_read_b128 v[164:167], v9 offset:37888
s_waitcnt lgkmcnt(8)
v_mfma_f32_16x16x32_bf16 v[68:71], v[132:135], a[128:131], v[68:71]
ds_read_b128 v[128:131], v8 offset:18432
s_waitcnt lgkmcnt(8)
v_mfma_f32_16x16x32_bf16 v[72:75], v[136:139], a[128:131], v[72:75]
ds_read_b128 v[132:135], v8 offset:38912
s_waitcnt lgkmcnt(8)
v_mfma_f32_16x16x32_bf16 v[76:79], v[140:143], a[128:131], v[76:79]
ds_read_b128 v[136:139], v8 offset:59392
s_add_u32 m0, s90, 143360
s_add_u32 s91, s88, 40960
buffer_load_dwordx4 v8, s[40:43], s91 offen sc1 lds
s_waitcnt lgkmcnt(8)
v_mfma_f32_16x16x32_bf16 v[80:83], v[144:147], a[128:131], v[80:83]
ds_read_b128 v[140:143], v9 offset:18432
s_waitcnt vmcnt(13)
s_waitcnt lgkmcnt(8)
v_mfma_f32_16x16x32_bf16 v[64:67], v[148:151], a[132:135], v[64:67]
ds_read_b128 v[144:147], v9 offset:38912
s_waitcnt lgkmcnt(8)
v_mfma_f32_16x16x32_bf16 v[68:71], v[152:155], a[132:135], v[68:71]
ds_read_b128 v[148:151], v8 offset:19456
s_waitcnt lgkmcnt(8)
v_mfma_f32_16x16x32_bf16 v[72:75], v[156:159], a[132:135], v[72:75]
ds_read_b128 v[152:155], v8 offset:39936
s_waitcnt lgkmcnt(8)
v_mfma_f32_16x16x32_bf16 v[76:79], v[160:163], a[132:135], v[76:79]
ds_read_b128 v[156:159], v8 offset:60416
s_add_u32 m0, s90, 147456
s_add_u32 s91, s88, 45056
buffer_load_dwordx4 v8, s[40:43], s91 offen sc1 lds
s_waitcnt lgkmcnt(8)
v_mfma_f32_16x16x32_bf16 v[80:83], v[164:167], a[132:135], v[80:83]
ds_read_b128 v[160:163], v9 offset:19456
s_waitcnt vmcnt(13)
s_waitcnt lgkmcnt(8)
v_mfma_f32_16x16x32_bf16 v[64:67], v[128:131], a[136:139], v[64:67]
ds_read_b128 v[164:167], v9 offset:39936
s_waitcnt lgkmcnt(8)
v_mfma_f32_16x16x32_bf16 v[68:71], v[132:135], a[136:139], v[68:71]
s_waitcnt lgkmcnt(7)
v_mfma_f32_16x16x32_bf16 v[72:75], v[136:139], a[136:139], v[72:75]
s_waitcnt lgkmcnt(6)
v_mfma_f32_16x16x32_bf16 v[76:79], v[140:143], a[136:139], v[76:79]
s_add_u32 m0, s90, 151552
s_add_u32 s91, s88, 49152
buffer_load_dwordx4 v8, s[40:43], s91 offen sc1 lds
s_waitcnt lgkmcnt(5)
v_mfma_f32_16x16x32_bf16 v[80:83], v[144:147], a[136:139], v[80:83]
s_waitcnt vmcnt(12)
s_waitcnt lgkmcnt(4)
v_mfma_f32_16x16x32_bf16 v[64:67], v[148:151], a[140:143], v[64:67]
s_waitcnt lgkmcnt(3)
v_mfma_f32_16x16x32_bf16 v[68:71], v[152:155], a[140:143], v[68:71]
s_waitcnt lgkmcnt(2)
v_mfma_f32_16x16x32_bf16 v[72:75], v[156:159], a[140:143], v[72:75]
s_waitcnt lgkmcnt(1)
v_mfma_f32_16x16x32_bf16 v[76:79], v[160:163], a[140:143], v[76:79]
s_waitcnt lgkmcnt(0)
v_mfma_f32_16x16x32_bf16 v[80:83], v[164:167], a[140:143], v[80:83]
v_pk_fma_f32 v[168:169], v[32:33], v[64:65], v[168:169]
v_pk_fma_f32 v[170:171], v[34:35], v[66:67], v[170:171]
v_pk_fma_f32 v[172:173], v[36:37], v[68:69], v[172:173]
v_pk_fma_f32 v[174:175], v[38:39], v[70:71], v[174:175]
v_pk_fma_f32 v[176:177], v[40:41], v[72:73], v[176:177]
v_pk_fma_f32 v[178:179], v[42:43], v[74:75], v[178:179]
v_pk_fma_f32 v[180:181], v[44:45], v[76:77], v[180:181]
v_pk_fma_f32 v[182:183], v[46:47], v[78:79], v[182:183]
v_pk_fma_f32 v[184:185], v[48:49], v[80:81], v[184:185]
v_pk_fma_f32 v[186:187], v[50:51], v[82:83], v[186:187]
v_cvt_pk_bf16_f32 v148, v168, v169
v_cvt_pk_bf16_f32 v149, v170, v171
v_cvt_pk_bf16_f32 v150, v172, v173
v_cvt_pk_bf16_f32 v151, v174, v175
v_cvt_pk_bf16_f32 v152, v176, v177
v_cvt_pk_bf16_f32 v153, v178, v179
v_cvt_pk_bf16_f32 v154, v180, v181
v_cvt_pk_bf16_f32 v155, v182, v183
v_cvt_pk_bf16_f32 v156, v184, v185
v_cvt_pk_bf16_f32 v157, v186, v187
s_mov_b32 s11, 0xffff0000
v_lshlrev_b32 v168, 16, v148
v_and_b32 v169, s11, v148
v_lshlrev_b32 v170, 16, v149
v_and_b32 v171, s11, v149
v_lshlrev_b32 v172, 16, v150
v_and_b32 v173, s11, v150
v_lshlrev_b32 v174, 16, v151
v_and_b32 v175, s11, v151
v_lshlrev_b32 v176, 16, v152
v_and_b32 v177, s11, v152
v_lshlrev_b32 v178, 16, v153
v_and_b32 v179, s11, v153
v_lshlrev_b32 v180, 16, v154
v_and_b32 v181, s11, v154
v_lshlrev_b32 v182, 16, v155
v_and_b32 v183, s11, v155
v_lshlrev_b32 v184, 16, v156
v_and_b32 v185, s11, v156
v_lshlrev_b32 v186, 16, v157
v_and_b32 v187, s11, v157
v_pk_mul_f32 v[96:97], v[96:97], v[168:169]
v_pk_mul_f32 v[98:99], v[98:99], v[170:171]
v_pk_mul_f32 v[100:101], v[100:101], v[172:173]
v_pk_mul_f32 v[102:103], v[102:103], v[174:175]
v_pk_mul_f32 v[104:105], v[104:105], v[176:177]
v_pk_mul_f32 v[106:107], v[106:107], v[178:179]
v_pk_mul_f32 v[108:109], v[108:109], v[180:181]
v_pk_mul_f32 v[110:111], v[110:111], v[182:183]
v_pk_mul_f32 v[112:113], v[112:113], v[184:185]
v_pk_mul_f32 v[114:115], v[114:115], v[186:187]
v_cvt_pk_bf16_f32 v128, v96, v97
v_cvt_pk_bf16_f32 v129, v98, v99
v_cvt_pk_bf16_f32 v130, v100, v101
v_cvt_pk_bf16_f32 v131, v102, v103
v_cvt_pk_bf16_f32 v132, v104, v105
v_cvt_pk_bf16_f32 v133, v106, v107
v_cvt_pk_bf16_f32 v134, v108, v109
v_cvt_pk_bf16_f32 v135, v110, v111
v_cvt_pk_bf16_f32 v136, v112, v113
v_cvt_pk_bf16_f32 v137, v114, v115
v_mov_b32 v138, v136
v_mov_b32 v139, v137
v_permlane16_swap_b32 v128, v130
v_permlane16_swap_b32 v129, v131
v_permlane16_swap_b32 v132, v134
v_permlane16_swap_b32 v133, v135
v_permlane16_swap_b32 v136, v138
v_permlane16_swap_b32 v137, v139
buffer_store_dwordx4 v[128:131], v25, s[40:43], s77 offen sc1
buffer_store_dwordx4 v[132:135], v25, s[40:43], s77 offen offset:1024 sc1
s_mov_b32 exec_lo, 0xffff
s_mov_b32 exec_hi, 0xffff
buffer_store_dwordx4 v[136:139], v25, s[40:43], s77 offen offset:2048 sc1
s_mov_b64 exec, -1
v_pk_add_f32 v[12:13], v[168:169], v[170:171]
v_pk_mul_f32 v[14:15], v[168:169], v[168:169]
v_pk_fma_f32 v[14:15], v[170:171], v[170:171], v[14:15]
v_pk_add_f32 v[12:13], v[12:13], v[172:173]
v_pk_fma_f32 v[14:15], v[172:173], v[172:173], v[14:15]
v_pk_add_f32 v[12:13], v[12:13], v[174:175]
v_pk_fma_f32 v[14:15], v[174:175], v[174:175], v[14:15]
v_pk_add_f32 v[12:13], v[12:13], v[176:177]
v_pk_fma_f32 v[14:15], v[176:177], v[176:177], v[14:15]
v_pk_add_f32 v[12:13], v[12:13], v[178:179]
v_pk_fma_f32 v[14:15], v[178:179], v[178:179], v[14:15]
v_pk_add_f32 v[12:13], v[12:13], v[180:181]
v_pk_fma_f32 v[14:15], v[180:181], v[180:181], v[14:15]
v_pk_add_f32 v[12:13], v[12:13], v[182:183]
v_pk_fma_f32 v[14:15], v[182:183], v[182:183], v[14:15]
v_pk_add_f32 v[12:13], v[12:13], v[184:185]
v_pk_fma_f32 v[14:15], v[184:185], v[184:185], v[14:15]
v_pk_add_f32 v[12:13], v[12:13], v[186:187]
v_pk_fma_f32 v[14:15], v[186:187], v[186:187], v[14:15]
v_add_f32 v12, v12, v13
v_add_f32 v13, v14, v15
v_mov_b32 v14, v12
v_mov_b32 v15, v12
v_mov_b32 v28, v13
v_mov_b32 v29, v13
v_permlane16_swap_b32 v14, v15
s_nop 0
v_permlane16_swap_b32 v28, v29
v_add_f32 v12, v14, v15
v_add_f32 v13, v28, v29
v_mov_b32 v14, v12
v_mov_b32 v15, v12
v_mov_b32 v28, v13
v_mov_b32 v29, v13
v_permlane32_swap_b32 v14, v15
s_nop 0
v_permlane32_swap_b32 v28, v29
v_add_f32 v12, v14, v15
v_add_f32 v13, v28, v29
s_mov_b32 exec_lo, 0xffff
s_mov_b32 exec_hi, 0x0
buffer_store_dwordx2 v[12:13], v26, s[40:43], s76 offen sc1
s_mov_b64 exec, -1
v_accvgpr_write_b32 a240, v148
v_accvgpr_write_b32 a241, v149
v_accvgpr_write_b32 a242, v150
v_accvgpr_write_b32 a243, v151
v_accvgpr_write_b32 a244, v152
v_accvgpr_write_b32 a245, v153
v_accvgpr_write_b32 a246, v154
v_accvgpr_write_b32 a247, v155
v_accvgpr_write_b32 a248, v156
v_accvgpr_write_b32 a249, v157
s_barrier
s_add_u32 m0, s90, 0
s_add_u32 s91, s88, 53248
buffer_load_dwordx4 v8, s[40:43], s91 offen sc1 lds
s_add_u32 m0, s90, 4096
s_add_u32 s91, s88, 57344
buffer_load_dwordx4 v8, s[40:43], s91 offen sc1 lds
s_add_u32 m0, s90, 8192
s_add_u32 s91, s88, 61440
buffer_load_dwordx4 v8, s[40:43], s91 offen sc1 lds
s_add_u32 m0, s90, 12288
s_add_u32 s91, s88, 65536
buffer_load_dwordx4 v8, s[40:43], s91 offen sc1 lds
s_add_u32 m0, s90, 16384
s_add_u32 s91, s88, 69632
buffer_load_dwordx4 v8, s[40:43], s91 offen sc1 lds
s_add_u32 m0, s90, 20480
s_add_u32 s91, s88, 73728
buffer_load_dwordx4 v8, s[40:43], s91 offen sc1 lds
s_add_u32 m0, s90, 24576
s_add_u32 s91, s88, 77824
buffer_load_dwordx4 v8, s[40:43], s91 offen sc1 lds
L_p3:
s_lshr_b32 s11, s3, 1
s_lshl_b32 s11, s11, 5
s_lshl_b32 s12, s3, 1
s_and_b32 s12, s12, 3
s_add_u32 s11, s11, s12
s_lshl_b32 s12, s4, 6
s_add_u32 s11, s11, s12
v_lshrrev_b32 v5, 1, v0
v_lshlrev_b32 v5, 2, v5
v_and_b32 v6, 1, v0
v_add_u32 v5, v5, v6
v_add_u32 v5, s11, v5
v_lshlrev_b32 v5, 7, v5
v_add_u32 v5, 8192, v5
v_and_b32 v2, 15, v0
v_bfe_u32 v3, v0, 4, 1
v_lshrrev_b32 v4, 5, v0
v_mul_u32_u24 v9, 20480, v3
v_lshl_add_u32 v9, v4, 8, v9
v_lshl_add_u32 v9, v2, 4, v9
v_mul_u32_u24 v19, 49152, v3
v_lshl_add_u32 v19, v4, 8, v19
v_lshl_add_u32 v19, v2, 4, v19
v_lshlrev_b32 v18, 4, v4
v_add_u32 v18, 161536, v18
v_and_b32 v27, 31, v0
v_lshlrev_b32 v27, 3, v27
v_lshl_add_u32 v27, v4, 11, v27
s_lshl_b32 s11, s4, 3
s_lshl_b32 s12, s3, 1
s_add_u32 s85, s11, s12
s_mul_i32 s86, s85, 49152
s_mul_i32 s12, s5, 3072
s_add_u32 s86, s86, s12
s_add_u32 s86, s86, 10485760
s_mul_i32 s85, s85, 20480
s_add_u32 s85, s85, 7340032
s_lshl_b32 s84, s4, 1
s_lshr_b32 s12, s3, 1
s_add_u32 s84, s84, s12
s_lshl_b32 s84, s84, 12
s_and_b32 s12, s3, 1
s_lshl_b32 s12, s12, 8
s_add_u32 s84, s84, s12
s_add_u32 s84, s84, 524288
v_add_u32 v16, 65536, v8
v_add_u32 v17, 131072, v8
v_mov_b32 v20, 0xc0135761
v_mov_b32 v21, 0xbdd2d3e8
v_mov_b32 v22, 1.0
s_mul_i32 s11, s3, 1536
s_mul_i32 s12, s5, 96
s_add_u32 s11, s11, s12
s_lshl_b32 s11, s11, 2
s_add_u32 s83, s11, 393216
v_lshlrev_b32 v28, 3, v0
s_waitcnt vmcnt(7)
s_add_u32 s72, s8, 6
v_mov_b32 v1, s72
s_mov_b64 exec, 1
buffer_store_dword v1, off, s[40:43], s10 sc1
s_mov_b64 exec, -1
s_add_u32 m0, s90, 28672
s_add_u32 s91, s88, 81920
buffer_load_dwordx4 v8, s[40:43], s91 offen sc1 lds
s_add_u32 m0, s90, 32768
s_add_u32 s91, s88, 86016
buffer_load_dwordx4 v8, s[40:43], s91 offen sc1 lds
s_add_u32 m0, s90, 36864
s_add_u32 s91, s88, 90112
buffer_load_dwordx4 v8, s[40:43], s91 offen sc1 lds
s_add_u32 m0, s90, 40960
s_add_u32 s91, s88, 94208
buffer_load_dwordx4 v8, s[40:43], s91 offen sc1 lds
s_add_u32 m0, s90, 45056
s_add_u32 s91, s88, 98304
buffer_load_dwordx4 v8, s[40:43], s91 offen sc1 lds
s_add_u32 m0, s90, 49152
s_add_u32 s91, s88, 102400
buffer_load_dwordx4 v8, s[40:43], s91 offen sc1 lds
s_add_u32 m0, s90, 53248
s_add_u32 s91, s88, 106496
buffer_load_dwordx4 v8, s[40:43], s91 offen sc1 lds
s_add_u32 m0, s90, 57344
s_add_u32 s91, s88, 110592
buffer_load_dwordx4 v8, s[40:43], s91 offen sc1 lds
s_add_u32 m0, s90, 61440
s_add_u32 s91, s88, 114688
buffer_load_dwordx4 v8, s[40:43], s91 offen sc1 lds
s_add_u32 m0, s90, 65536
s_add_u32 s91, s88, 118784
buffer_load_dwordx4 v8, s[40:43], s91 offen sc1 lds
s_add_u32 m0, s90, 69632
s_add_u32 s91, s88, 122880
buffer_load_dwordx4 v8, s[40:43], s91 offen sc1 lds
s_add_u32 m0, s90, 73728
s_add_u32 s91, s88, 126976
buffer_load_dwordx4 v8, s[40:43], s91 offen sc1 lds
s_add_u32 m0, s90, 77824
s_add_u32 s91, s88, 131072
buffer_load_dwordx4 v8, s[40:43], s91 offen sc1 lds
s_add_u32 m0, s90, 81920
s_add_u32 s91, s88, 135168
buffer_load_dwordx4 v8, s[40:43], s91 offen sc1 lds
s_add_u32 m0, s90, 86016
s_add_u32 s91, s88, 139264
buffer_load_dwordx4 v8, s[40:43], s91 offen sc1 lds
s_add_u32 m0, s90, 90112
s_add_u32 s91, s88, 143360
buffer_load_dwordx4 v8, s[40:43], s91 offen sc1 lds
s_add_u32 m0, s90, 94208
s_add_u32 s91, s88, 147456
buffer_load_dwordx4 v8, s[40:43], s91 offen sc1 lds
s_add_u32 m0, s90, 98304
s_add_u32 s91, s88, 151552
buffer_load_dwordx4 v8, s[40:43], s91 offen sc1 lds
s_waitcnt vmcnt(18)
s_barrier
ds_read_b128 v[96:99], v16 offset:36864
ds_read_b128 v[100:103], v16 offset:37888
ds_read_b128 v[104:107], v16 offset:38912
ds_read_b128 v[108:111], v16 offset:39936
ds_read_b128 v[112:115], v16 offset:40960
ds_read_b128 v[116:119], v16 offset:41984
s_mov_b32 exec_lo, 0xffff
s_mov_b32 exec_hi, 0x0
s_add_u32 s72, s8, 6
s_mov_b32 s73, 200000
L_poll_25:
buffer_load_dword v6, v5, s[40:43], 0 offen sc1
s_waitcnt vmcnt(0)
v_subrev_u32 v6, s72, v6
v_cmp_lt_u32 vcc, 9, v6
s_sub_u32 s73, s73, 1
s_cmp_eq_u32 s73, 0
s_cbranch_scc1 L_polld_26
s_nop 0
s_cbranch_vccnz L_poll_25
L_polld_26:
s_mov_b64 exec, -1
buffer_load_dwordx4 a[0:3], v9, s[40:43], s85 offen offset:0 sc1
buffer_load_dwordx4 a[4:7], v9, s[40:43], s85 offen offset:512 sc1
buffer_load_dwordx4 a[8:11], v9, s[40:43], s85 offen offset:1024 sc1
buffer_load_dwordx4 a[12:15], v9, s[40:43], s85 offen offset:1536 sc1
buffer_load_dwordx4 a[16:19], v9, s[40:43], s85 offen offset:2048 sc1
buffer_load_dwordx4 a[20:23], v9, s[40:43], s85 offen offset:2560 sc1
buffer_load_dwordx4 a[24:27], v9, s[40:43], s85 offen offset:3072 sc1
buffer_load_dwordx4 a[28:31], v9, s[40:43], s85 offen offset:3584 sc1
s_add_u32 s85, s85, 4096
buffer_load_dwordx4 a[32:35], v9, s[40:43], s85 offen offset:0 sc1
buffer_load_dwordx4 a[36:39], v9, s[40:43], s85 offen offset:512 sc1
buffer_load_dwordx4 a[40:43], v9, s[40:43], s85 offen offset:1024 sc1
buffer_load_dwordx4 a[44:47], v9, s[40:43], s85 offen offset:1536 sc1
buffer_load_dwordx4 a[48:51], v9, s[40:43], s85 offen offset:2048 sc1
buffer_load_dwordx4 a[52:55], v9, s[40:43], s85 offen offset:2560 sc1
s_waitcnt vmcnt(13)
s_waitcnt lgkmcnt(4)
v_mfma_f32_32x32x16_bf16 v[32:47], v[96:99], a[0:3], 0
ds_read_b128 v[120:123], v16 offset:43008
buffer_load_dwordx4 a[56:59], v9, s[40:43], s85 offen offset:3072 sc1
v_mfma_f32_32x32x16_bf16 v[48:63], v[100:103], a[0:3], 0
ds_read_b128 v[124:127], v16 offset:44032
s_waitcnt vmcnt(13)
s_waitcnt lgkmcnt(4)
v_mfma_f32_32x32x16_bf16 v[32:47], v[104:107], a[4:7], v[32:47]
ds_read_b128 v[96:99], v16 offset:45056
buffer_load_dwordx4 a[60:63], v9, s[40:43], s85 offen offset:3584 sc1
s_add_u32 s85, s85, 4096
v_mfma_f32_32x32x16_bf16 v[48:63], v[108:111], a[4:7], v[48:63]
ds_read_b128 v[100:103], v16 offset:46080
s_waitcnt vmcnt(13)
s_waitcnt lgkmcnt(4)
v_mfma_f32_32x32x16_bf16 v[32:47], v[112:115], a[8:11], v[32:47]
ds_read_b128 v[104:107], v16 offset:47104
buffer_load_dwordx4 a[64:67], v9, s[40:43], s85 offen offset:0 sc1
v_mfma_f32_32x32x16_bf16 v[48:63], v[116:119], a[8:11], v[48:63]
ds_read_b128 v[108:111], v16 offset:48128
s_waitcnt vmcnt(13)
s_waitcnt lgkmcnt(4)
v_mfma_f32_32x32x16_bf16 v[32:47], v[120:123], a[12:15], v[32:47]
ds_read_b128 v[112:115], v16 offset:49152
buffer_load_dwordx4 a[68:71], v9, s[40:43], s85 offen offset:512 sc1
v_mfma_f32_32x32x16_bf16 v[48:63], v[124:127], a[12:15], v[48:63]
ds_read_b128 v[116:119], v16 offset:50176
s_waitcnt vmcnt(13)
s_waitcnt lgkmcnt(4)
v_mfma_f32_32x32x16_bf16 v[32:47], v[96:99], a[16:19], v[32:47]
ds_read_b128 v[120:123], v16 offset:51200
buffer_load_dwordx4 a[72:75], v9, s[40:43], s85 offen offset:1024 sc1
v_mfma_f32_32x32x16_bf16 v[48:63], v[100:103], a[16:19], v[48:63]
ds_read_b128 v[124:127], v16 offset:52224
s_waitcnt vmcnt(13)
s_waitcnt lgkmcnt(4)
v_mfma_f32_32x32x16_bf16 v[32:47], v[104:107], a[20:23], v[32:47]
ds_read_b128 v[96:99], v16 offset:53248
buffer_load_dwordx4 a[76:79], v9, s[40:43], s85 offen offset:1536 sc1
v_mfma_f32_32x32x16_bf16 v[48:63], v[108:111], a[20:23], v[48:63]
ds_read_b128 v[100:103], v16 offset:54272
s_waitcnt vmcnt(13)
s_waitcnt lgkmcnt(4)
v_mfma_f32_32x32x16_bf16 v[32:47], v[112:115], a[24:27], v[32:47]
ds_read_b128 v[104:107], v16 offset:55296
buffer_load_dwordx4 a[80:83], v9, s[40:43], s85 offen offset:2048 sc1
v_mfma_f32_32x32x16_bf16 v[48:63], v[116:119], a[24:27], v[48:63]
ds_read_b128 v[108:111], v16 offset:56320
s_waitcnt vmcnt(13)
s_waitcnt lgkmcnt(4)
v_mfma_f32_32x32x16_bf16 v[32:47], v[120:123], a[28:31], v[32:47]
ds_read_b128 v[112:115], v16 offset:57344
buffer_load_dwordx4 a[84:87], v9, s[40:43], s85 offen offset:2560 sc1
v_mfma_f32_32x32x16_bf16 v[48:63], v[124:127], a[28:31], v[48:63]
ds_read_b128 v[116:119], v16 offset:58368
s_waitcnt vmcnt(13)
s_waitcnt lgkmcnt(4)
v_mfma_f32_32x32x16_bf16 v[32:47], v[96:99], a[32:35], v[32:47]
ds_read_b128 v[120:123], v16 offset:59392
buffer_load_dwordx4 a[88:91], v9, s[40:43], s85 offen offset:3072 sc1
v_mfma_f32_32x32x16_bf16 v[48:63], v[100:103], a[32:35], v[48:63]
ds_read_b128 v[124:127], v16 offset:60416
s_waitcnt vmcnt(13)
s_waitcnt lgkmcnt(4)
v_mfma_f32_32x32x16_bf16 v[32:47], v[104:107], a[36:39], v[32:47]
ds_read_b128 v[96:99], v16 offset:61440
buffer_load_dwordx4 a[92:95], v9, s[40:43], s85 offen offset:3584 sc1
s_add_u32 s85, s85, 4096
v_mfma_f32_32x32x16_bf16 v[48:63], v[108:111], a[36:39], v[48:63]
ds_read_b128 v[100:103], v16 offset:62464
s_waitcnt vmcnt(13)
s_waitcnt lgkmcnt(4)
v_mfma_f32_32x32x16_bf16 v[32:47], v[112:115], a[40:43], v[32:47]
ds_read_b128 v[104:107], v16 offset:63488
buffer_load_dwordx4 a[96:99], v9, s[40:43], s85 offen offset:0 sc1
v_mfma_f32_32x32x16_bf16 v[48:63], v[116:119], a[40:43], v[48:63]
ds_read_b128 v[108:111], v16 offset:64512
s_waitcnt vmcnt(13)
s_waitcnt lgkmcnt(4)
v_mfma_f32_32x32x16_bf16 v[32:47], v[120:123], a[44:47], v[32:47]
ds_read_b128 v[112:115], v17 offset:0
buffer_load_dwordx4 a[100:103], v9, s[40:43], s85 offen offset:512 sc1
v_mfma_f32_32x32x16_bf16 v[48:63], v[124:127], a[44:47], v[48:63]
ds_read_b128 v[116:119], v17 offset:1024
s_waitcnt vmcnt(13)
s_waitcnt lgkmcnt(4)
v_mfma_f32_32x32x16_bf16 v[32:47], v[96:99], a[48:51], v[32:47]
ds_read_b128 v[120:123], v17 offset:2048
buffer_load_dwordx4 a[104:107], v9, s[40:43], s85 offen offset:1024 sc1
v_mfma_f32_32x32x16_bf16 v[48:63], v[100:103], a[48:51], v[48:63]
ds_read_b128 v[124:127], v17 offset:3072
s_waitcnt vmcnt(13)
s_waitcnt lgkmcnt(4)
v_mfma_f32_32x32x16_bf16 v[32:47], v[104:107], a[52:55], v[32:47]
ds_read_b128 v[96:99], v17 offset:4096
buffer_load_dwordx4 a[108:111], v9, s[40:43], s85 offen offset:1536 sc1
v_mfma_f32_32x32x16_bf16 v[48:63], v[108:111], a[52:55], v[48:63]
ds_read_b128 v[100:103], v17 offset:5120
s_waitcnt vmcnt(13)
s_waitcnt lgkmcnt(4)
v_mfma_f32_32x32x16_bf16 v[32:47], v[112:115], a[56:59], v[32:47]
ds_read_b128 v[104:107], v17 offset:6144
buffer_load_dwordx4 a[112:115], v9, s[40:43], s85 offen offset:2048 sc1
v_mfma_f32_32x32x16_bf16 v[48:63], v[116:119], a[56:59], v[48:63]
ds_read_b128 v[108:111], v17 offset:7168
s_waitcnt vmcnt(13)
s_waitcnt lgkmcnt(4)
v_mfma_f32_32x32x16_bf16 v[32:47], v[120:123], a[60:63], v[32:47]
ds_read_b128 v[112:115], v17 offset:8192
buffer_load_dwordx4 a[116:119], v9, s[40:43], s85 offen offset:2560 sc1
buffer_load_dword v23, v24, s[40:43], 0 offen sc1
v_mfma_f32_32x32x16_bf16 v[48:63], v[124:127], a[60:63], v[48:63]
ds_read_b128 v[116:119], v17 offset:9216
s_waitcnt vmcnt(14)
s_waitcnt lgkmcnt(4)
v_mfma_f32_32x32x16_bf16 v[32:47], v[96:99], a[64:67], v[32:47]
ds_read_b128 v[120:123], v17 offset:10240
buffer_load_dwordx4 a[120:123], v9, s[40:43], s85 offen offset:3072 sc1
v_mfma_f32_32x32x16_bf16 v[48:63], v[100:103], a[64:67], v[48:63]
ds_read_b128 v[124:127], v17 offset:11264
s_waitcnt vmcnt(14)
s_waitcnt lgkmcnt(4)
v_mfma_f32_32x32x16_bf16 v[32:47], v[104:107], a[68:71], v[32:47]
ds_read_b128 v[96:99], v17 offset:12288
buffer_load_dwordx4 a[124:127], v9, s[40:43], s85 offen offset:3584 sc1
s_add_u32 s85, s85, 4096
v_mfma_f32_32x32x16_bf16 v[48:63], v[108:111], a[68:71], v[48:63]
ds_read_b128 v[100:103], v17 offset:13312
s_waitcnt vmcnt(14)
s_waitcnt lgkmcnt(4)
v_mfma_f32_32x32x16_bf16 v[32:47], v[112:115], a[72:75], v[32:47]
ds_read_b128 v[104:107], v17 offset:14336
buffer_load_dwordx4 a[128:131], v9, s[40:43], s85 offen offset:0 sc1
v_mfma_f32_32x32x16_bf16 v[48:63], v[116:119], a[72:75], v[48:63]
ds_read_b128 v[108:111], v17 offset:15360
s_waitcnt vmcnt(14)
s_waitcnt lgkmcnt(4)
v_mfma_f32_32x32x16_bf16 v[32:47], v[120:123], a[76:79], v[32:47]
ds_read_b128 v[112:115], v17 offset:16384
buffer_load_dwordx4 a[132:135], v9, s[40:43], s85 offen offset:512 sc1
v_mfma_f32_32x32x16_bf16 v[48:63], v[124:127], a[76:79], v[48:63]
ds_read_b128 v[116:119], v17 offset:17408
s_waitcnt vmcnt(14)
s_waitcnt lgkmcnt(4)
v_mfma_f32_32x32x16_bf16 v[32:47], v[96:99], a[80:83], v[32:47]
ds_read_b128 v[120:123], v17 offset:18432
buffer_load_dwordx4 a[136:139], v9, s[40:43], s85 offen offset:1024 sc1
v_mfma_f32_32x32x16_bf16 v[48:63], v[100:103], a[80:83], v[48:63]
ds_read_b128 v[124:127], v17 offset:19456
s_waitcnt vmcnt(14)
s_waitcnt lgkmcnt(4)
v_mfma_f32_32x32x16_bf16 v[32:47], v[104:107], a[84:87], v[32:47]
ds_read_b128 v[96:99], v17 offset:20480
buffer_load_dwordx4 a[140:143], v9, s[40:43], s85 offen offset:1536 sc1
v_mfma_f32_32x32x16_bf16 v[48:63], v[108:111], a[84:87], v[48:63]
ds_read_b128 v[100:103], v17 offset:21504
s_waitcnt vmcnt(14)
s_waitcnt lgkmcnt(4)
v_mfma_f32_32x32x16_bf16 v[32:47], v[112:115], a[88:91], v[32:47]
ds_read_b128 v[104:107], v17 offset:22528
buffer_load_dwordx4 a[144:147], v9, s[40:43], s85 offen offset:2048 sc1
v_mfma_f32_32x32x16_bf16 v[48:63], v[116:119], a[88:91], v[48:63]
ds_read_b128 v[108:111], v17 offset:23552
s_waitcnt vmcnt(14)
s_waitcnt lgkmcnt(4)
v_mfma_f32_32x32x16_bf16 v[32:47], v[120:123], a[92:95], v[32:47]
ds_read_b128 v[112:115], v8 offset:0
buffer_load_dwordx4 a[148:151], v9, s[40:43], s85 offen offset:2560 sc1
v_mfma_f32_32x32x16_bf16 v[48:63], v[124:127], a[92:95], v[48:63]
ds_read_b128 v[116:119], v8 offset:1024
s_waitcnt vmcnt(14)
s_waitcnt lgkmcnt(4)
v_mfma_f32_32x32x16_bf16 v[32:47], v[96:99], a[96:99], v[32:47]
ds_read_b128 v[120:123], v8 offset:2048
buffer_load_dwordx4 a[152:155], v9, s[40:43], s85 offen offset:3072 sc1
v_mfma_f32_32x32x16_bf16 v[48:63], v[100:103], a[96:99], v[48:63]
ds_read_b128 v[124:127], v8 offset:3072
s_waitcnt vmcnt(14)
s_waitcnt lgkmcnt(4)
v_mfma_f32_32x32x16_bf16 v[32:47], v[104:107], a[100:103], v[32:47]
ds_read_b128 v[96:99], v8 offset:4096
buffer_load_dwordx4 a[156:159], v9, s[40:43], s85 offen offset:3584 sc1
s_waitcnt vmcnt(10)
s_add_u32 s72, s8, 5
v_subrev_u32 v23, s72, v23
v_cmp_lt_u32 vcc, 10, v23
s_nop 3
s_cbranch_vccnz L_slow_27
L_back_28:
s_mov_b32 exec_lo, 0xffffffff
s_mov_b32 exec_hi, 0xffff
buffer_load_dwordx2 v[168:169], v28, s[40:43], s83 offen sc1
s_add_u32 s83, s83, 24576
buffer_load_dwordx2 v[170:171], v28, s[40:43], s83 offen sc1
s_add_u32 s83, s83, 24576
buffer_load_dwordx2 v[172:173], v28, s[40:43], s83 offen sc1
s_add_u32 s83, s83, 24576
buffer_load_dwordx2 v[174:175], v28, s[40:43], s83 offen sc1
s_mov_b64 exec, -1
v_mfma_f32_32x32x16_bf16 v[48:63], v[108:111], a[100:103], v[48:63]
ds_read_b128 v[100:103], v8 offset:5120
s_waitcnt lgkmcnt(4)
v_mfma_f32_32x32x16_bf16 v[32:47], v[112:115], a[104:107], v[32:47]
ds_read_b128 v[104:107], v8 offset:6144
v_mfma_f32_32x32x16_bf16 v[48:63], v[116:119], a[104:107], v[48:63]
ds_read_b128 v[108:111], v8 offset:7168
s_waitcnt lgkmcnt(4)
v_mfma_f32_32x32x16_bf16 v[32:47], v[120:123], a[108:111], v[32:47]
ds_read_b128 v[112:115], v8 offset:8192
v_mfma_f32_32x32x16_bf16 v[48:63], v[124:127], a[108:111], v[48:63]
ds_read_b128 v[116:119], v8 offset:9216
s_waitcnt lgkmcnt(4)
v_mfma_f32_32x32x16_bf16 v[32:47], v[96:99], a[112:115], v[32:47]
ds_read_b128 v[120:123], v8 offset:10240
v_mfma_f32_32x32x16_bf16 v[48:63], v[100:103], a[112:115], v[48:63]
ds_read_b128 v[124:127], v8 offset:11264
s_waitcnt lgkmcnt(4)
v_mfma_f32_32x32x16_bf16 v[32:47], v[104:107], a[116:119], v[32:47]
ds_read_b128 v[96:99], v8 offset:12288
v_mfma_f32_32x32x16_bf16 v[48:63], v[108:111], a[116:119], v[48:63]
ds_read_b128 v[100:103], v8 offset:13312
s_waitcnt vmcnt(13)
s_waitcnt lgkmcnt(4)
v_mfma_f32_32x32x16_bf16 v[32:47], v[112:115], a[120:123], v[32:47]
ds_read_b128 v[104:107], v8 offset:14336
v_mfma_f32_32x32x16_bf16 v[48:63], v[116:119], a[120:123], v[48:63]
ds_read_b128 v[108:111], v8 offset:15360
s_waitcnt vmcnt(12)
s_waitcnt lgkmcnt(4)
v_mfma_f32_32x32x16_bf16 v[32:47], v[120:123], a[124:127], v[32:47]
ds_read_b128 v[112:115], v8 offset:16384
v_mfma_f32_32x32x16_bf16 v[48:63], v[124:127], a[124:127], v[48:63]
ds_read_b128 v[116:119], v8 offset:17408
s_waitcnt vmcnt(11)
s_waitcnt lgkmcnt(4)
v_mfma_f32_32x32x16_bf16 v[32:47], v[96:99], a[128:131], v[32:47]
ds_read_b128 v[120:123], v8 offset:18432
buffer_load_dwordx2 v[12:13], v27, s[40:43], s84 offen offset:0 sc1
buffer_load_dwordx2 v[14:15], v27, s[40:43], s84 offen offset:512 sc1
buffer_load_dwordx2 v[24:25], v27, s[40:43], s84 offen offset:1024 sc1
buffer_load_dwordx2 v[26:27], v27, s[40:43], s84 offen offset:1536 sc1
v_lshrrev_b32 v5, 2, v0
v_lshlrev_b32 v5, 4, v5
s_and_b32 s11, s5, 7
s_add_u32 s11, s11, 0
v_add_u32 v5, s11, v5
v_and_b32 v6, 3, v0
v_lshl_add_u32 v5, v5, 2, v6
v_lshlrev_b32 v5, 7, v5
v_add_u32 v29, 8192, v5
v_lshrrev_b32 v5, 2, v0
v_lshlrev_b32 v5, 4, v5
s_and_b32 s11, s5, 7
s_add_u32 s11, s11, 8
v_add_u32 v5, s11, v5
v_and_b32 v6, 3, v0
v_lshl_add_u32 v5, v5, 2, v6
v_lshlrev_b32 v5, 7, v5
v_add_u32 v30, 8192, v5
buffer_load_dword v5, v29, s[40:43], 0 offen sc1
buffer_load_dword v6, v30, s[40:43], 0 offen sc1
v_and_b32 v176, 15, v0
v_lshlrev_b32 v176, 13, v176
v_add_u32 v176, 8192, v176
v_mov_b32 v177, s10
s_cmp_eq_u32 s9, 0
s_cselect_b64 s[74:75], -1, 0
v_cndmask_b32 v176, v177, v176, s[74:75]
buffer_load_dword v177, v176, s[40:43], 0 offen sc1
s_lshr_b32 s11, s5, 3
s_lshl_b32 s11, s11, 2
s_add_u32 s11, s11, s3
s_lshr_b32 s11, s11, 1
s_lshl_b32 s12, s4, 6
s_add_u32 s11, s11, s12
v_and_b32 v31, 15, v0
v_lshl_add_u32 v31, v31, 2, s11
v_lshlrev_b32 v31, 7, v31
v_add_u32 v31, 8192, v31
s_lshr_b32 s11, s5, 3
s_lshl_b32 s11, s11, 2
s_add_u32 s11, s11, s3
s_lshl_b32 s12, s4, 3
s_add_u32 s87, s11, s12
s_mul_i32 s82, s87, 49152
s_add_u32 s82, s82, 10485760
v_mfma_f32_32x32x16_bf16 v[48:63], v[100:103], a[128:131], v[48:63]
ds_read_b128 v[124:127], v8 offset:19456
s_waitcnt vmcnt(17)
s_waitcnt lgkmcnt(4)
v_mfma_f32_32x32x16_bf16 v[32:47], v[104:107], a[132:135], v[32:47]
ds_read_b128 v[96:99], v8 offset:20480
v_mfma_f32_32x32x16_bf16 v[48:63], v[108:111], a[132:135], v[48:63]
ds_read_b128 v[100:103], v8 offset:21504
s_waitcnt vmcnt(16)
s_waitcnt lgkmcnt(4)
v_mfma_f32_32x32x16_bf16 v[32:47], v[112:115], a[136:139], v[32:47]
ds_read_b128 v[104:107], v8 offset:22528
v_mfma_f32_32x32x16_bf16 v[48:63], v[116:119], a[136:139], v[48:63]
ds_read_b128 v[108:111], v8 offset:23552
s_waitcnt vmcnt(15)
s_waitcnt lgkmcnt(4)
v_mfma_f32_32x32x16_bf16 v[32:47], v[120:123], a[140:143], v[32:47]
ds_read_b128 v[112:115], v8 offset:24576
s_waitcnt vmcnt(7)
s_mov_b32 exec_lo, 0xffffffff
s_mov_b32 exec_hi, 0xffff
v_add_f32 v168, v168, v170
v_add_f32 v172, v172, v174
v_add_f32 v168, v168, v172
v_add_f32 v169, v169, v171
v_add_f32 v173, v173, v175
v_add_f32 v169, v169, v173
s_mul_i32 s11, s3, 384
s_add_u32 s11, s11, 161536
v_add_u32 v28, s11, v28
ds_write_b64 v28, v[168:169]
s_mov_b64 exec, -1
v_mfma_f32_32x32x16_bf16 v[48:63], v[124:127], a[140:143], v[48:63]
ds_read_b128 v[116:119], v8 offset:25600
s_waitcnt lgkmcnt(5)
v_mfma_f32_32x32x16_bf16 v[32:47], v[96:99], a[144:147], v[32:47]
ds_read_b128 v[120:123], v8 offset:26624
v_mfma_f32_32x32x16_bf16 v[48:63], v[100:103], a[144:147], v[48:63]
ds_read_b128 v[124:127], v8 offset:27648
s_barrier
s_waitcnt lgkmcnt(5)
v_mfma_f32_32x32x16_bf16 v[32:47], v[104:107], a[148:151], v[32:47]
ds_read_b128 v[96:99], v8 offset:28672
v_mfma_f32_32x32x16_bf16 v[48:63], v[108:111], a[148:151], v[48:63]
ds_read_b128 v[100:103], v8 offset:29696
s_waitcnt lgkmcnt(4)
v_mfma_f32_32x32x16_bf16 v[32:47], v[112:115], a[152:155], v[32:47]
ds_read_b128 v[104:107], v8 offset:30720
v_mfma_f32_32x32x16_bf16 v[48:63], v[116:119], a[152:155], v[48:63]
ds_read_b128 v[108:111], v8 offset:31744
s_waitcnt lgkmcnt(4)
v_mfma_f32_32x32x16_bf16 v[32:47], v[120:123], a[156:159], v[32:47]
ds_read_b128 v[112:115], v8 offset:32768
v_mfma_f32_32x32x16_bf16 v[48:63], v[124:127], a[156:159], v[48:63]
ds_read_b128 v[116:119], v8 offset:33792
s_waitcnt lgkmcnt(4)
v_mfma_f32_32x32x16_bf16 v[64:79], v[96:99], a[0:3], 0
ds_read_b128 v[120:123], v8 offset:34816
v_mfma_f32_32x32x16_bf16 v[80:95], v[100:103], a[0:3], 0
ds_read_b128 v[124:127], v8 offset:35840
s_add_u32 m0, s90, 102400
s_add_u32 s91, s88, 155648
buffer_load_dwordx4 v8, s[40:43], s91 offen sc1 lds
s_waitcnt lgkmcnt(4)
v_mfma_f32_32x32x16_bf16 v[64:79], v[104:107], a[4:7], v[64:79]
ds_read_b128 v[96:99], v8 offset:36864
s_waitcnt vmcnt(4)
v_pk_add_f32 v[12:13], v[12:13], v[14:15]
v_pk_add_f32 v[24:25], v[24:25], v[26:27]
v_pk_add_f32 v[12:13], v[12:13], v[24:25]
v_mov_b32 v14, v12
v_mov_b32 v15, v12
s_nop 1
v_permlane32_swap_b32 v14, v15
v_add_f32 v12, v14, v15
v_mov_b32 v14, v13
v_mov_b32 v15, v13
s_nop 1
v_permlane32_swap_b32 v14, v15
v_add_f32 v13, v14, v15
v_mul_f32 v12, 0x3acccccd, v12
v_mul_f32 v13, 0x3acccccd, v13
v_fma_f32 v13, -v12, v12, v13
v_max_f32 v13, 0, v13
v_add_f32 v13, 0x3727c5ac, v13
v_rsq_f32 v10, v13
s_nop 0
v_mul_f32 v11, v10, v12
v_sub_f32 v11, 0, v11
ds_read_b128 v[128:131], v18 offset:0
ds_read_b128 v[132:135], v18 offset:384
ds_read_b128 v[136:139], v18 offset:768
v_mfma_f32_32x32x16_bf16 v[80:95], v[108:111], a[4:7], v[80:95]
ds_read_b128 v[100:103], v8 offset:37888
s_add_u32 m0, s90, 106496
s_add_u32 s91, s88, 159744
buffer_load_dwordx4 v8, s[40:43], s91 offen sc1 lds
ds_read_b128 v[140:143], v18 offset:1152
ds_read_b128 v[144:147], v18 offset:32
ds_read_b128 v[148:151], v18 offset:416
s_waitcnt lgkmcnt(10)
v_mfma_f32_32x32x16_bf16 v[64:79], v[112:115], a[8:11], v[64:79]
ds_read_b128 v[104:107], v8 offset:38912
ds_read_b128 v[152:155], v18 offset:800
ds_read_b128 v[156:159], v18 offset:1184
s_waitcnt lgkmcnt(5)
v_fma_f32 v132, v11, v128, v132
v_fma_f32 v140, v11, v136, v140
v_mfma_f32_32x32x16_bf16 v[80:95], v[116:119], a[8:11], v[80:95]
ds_read_b128 v[108:111], v8 offset:39936
s_add_u32 m0, s90, 110592
s_add_u32 s91, s88, 163840
buffer_load_dwordx4 v8, s[40:43], s91 offen sc1 lds
v_fma_f32 v133, v11, v129, v133
v_fma_f32 v141, v11, v137, v141
v_fma_f32 v134, v11, v130, v134
v_mfma_f32_32x32x16_bf16 v[64:79], v[120:123], a[12:15], v[64:79]
ds_read_b128 v[112:115], v8 offset:40960
v_fma_f32 v142, v11, v138, v142
v_fma_f32 v135, v11, v131, v135
v_fma_f32 v143, v11, v139, v143
v_mfma_f32_32x32x16_bf16 v[80:95], v[124:127], a[12:15], v[80:95]
ds_read_b128 v[116:119], v8 offset:41984
v_fma_f32 v32, v10, v32, v132
v_fma_f32 v33, v10, v33, v133
v_fma_f32 v34, v10, v34, v134
v_fma_f32 v35, v10, v35, v135
v_mfma_f32_32x32x16_bf16 v[64:79], v[96:99], a[16:19], v[64:79]
ds_read_b128 v[120:123], v8 offset:43008
s_add_u32 m0, s90, 114688
s_add_u32 s91, s88, 167936
buffer_load_dwordx4 v8, s[40:43], s91 offen sc1 lds
v_mul_f32 v160, v32, v32
v_mul_f32 v161, v33, v33
v_mul_f32 v162, v34, v34
v_mfma_f32_32x32x16_bf16 v[80:95], v[100:103], a[16:19], v[80:95]
ds_read_b128 v[124:127], v8 offset:44032
v_mul_f32 v163, v35, v35
v_fma_f32 v48, v10, v48, v140
v_fma_f32 v49, v10, v49, v141
v_fma_f32 v50, v10, v50, v142
s_waitcnt lgkmcnt(4)
v_mfma_f32_32x32x16_bf16 v[64:79], v[104:107], a[20:23], v[64:79]
ds_read_b128 v[96:99], v8 offset:45056
s_add_u32 m0, s90, 118784
s_add_u32 s91, s88, 172032
buffer_load_dwordx4 v8, s[40:43], s91 offen sc1 lds
v_fma_f32 v51, v10, v51, v143
v_fmamk_f32 v160, v160, 0xbdd2d3e8, v20
v_fmamk_f32 v161, v161, 0xbdd2d3e8, v20
v_mfma_f32_32x32x16_bf16 v[80:95], v[108:111], a[20:23], v[80:95]
ds_read_b128 v[100:103], v8 offset:46080
v_fmamk_f32 v162, v162, 0xbdd2d3e8, v20
v_fmamk_f32 v163, v163, 0xbdd2d3e8, v20
v_mul_f32 v160, v160, v32
s_waitcnt lgkmcnt(4)
v_mfma_f32_32x32x16_bf16 v[64:79], v[112:115], a[24:27], v[64:79]
ds_read_b128 v[104:107], v8 offset:47104
v_mul_f32 v161, v161, v33
v_mul_f32 v162, v162, v34
v_mul_f32 v163, v163, v35
v_exp_f32 v160, v160
v_mfma_f32_32x32x16_bf16 v[80:95], v[116:119], a[24:27], v[80:95]
ds_read_b128 v[108:111], v8 offset:48128
s_add_u32 m0, s90, 122880
s_add_u32 s91, s88, 176128
buffer_load_dwordx4 v8, s[40:43], s91 offen sc1 lds
v_exp_f32 v161, v161
s_waitcnt lgkmcnt(4)
v_mfma_f32_32x32x16_bf16 v[64:79], v[120:123], a[28:31], v[64:79]
ds_read_b128 v[112:115], v8 offset:49152
v_exp_f32 v162, v162
v_exp_f32 v163, v163
v_mfma_f32_32x32x16_bf16 v[80:95], v[124:127], a[28:31], v[80:95]
ds_read_b128 v[116:119], v8 offset:50176
s_add_u32 m0, s90, 126976
s_add_u32 s91, s88, 180224
buffer_load_dwordx4 v8, s[40:43], s91 offen sc1 lds
v_mul_f32 v32, v32, v48
v_mul_f32 v33, v33, v49
v_mul_f32 v34, v34, v50
s_waitcnt lgkmcnt(4)
v_mfma_f32_32x32x16_bf16 v[64:79], v[96:99], a[32:35], v[64:79]
ds_read_b128 v[120:123], v8 offset:51200
v_mul_f32 v35, v35, v51
v_add_f32 v160, 1.0, v160
v_add_f32 v161, 1.0, v161
v_mfma_f32_32x32x16_bf16 v[80:95], v[100:103], a[32:35], v[80:95]
ds_read_b128 v[124:127], v8 offset:52224
v_add_f32 v162, 1.0, v162
v_add_f32 v163, 1.0, v163
v_rcp_f32 v160, v160
s_waitcnt lgkmcnt(4)
v_mfma_f32_32x32x16_bf16 v[64:79], v[104:107], a[36:39], v[64:79]
ds_read_b128 v[96:99], v8 offset:53248
s_add_u32 m0, s90, 131072
s_add_u32 s91, s88, 184320
buffer_load_dwordx4 v8, s[40:43], s91 offen sc1 lds
v_rcp_f32 v161, v161
v_rcp_f32 v162, v162
v_mfma_f32_32x32x16_bf16 v[80:95], v[108:111], a[36:39], v[80:95]
ds_read_b128 v[100:103], v8 offset:54272
v_rcp_f32 v163, v163
v_mul_f32 v32, v32, v160
s_waitcnt lgkmcnt(4)
v_mfma_f32_32x32x16_bf16 v[64:79], v[112:115], a[40:43], v[64:79]
ds_read_b128 v[104:107], v8 offset:55296
s_add_u32 m0, s90, 135168
s_add_u32 s91, s88, 188416
buffer_load_dwordx4 v8, s[40:43], s91 offen sc1 lds
v_mul_f32 v33, v33, v161
v_mul_f32 v34, v34, v162
v_mul_f32 v35, v35, v163
v_mfma_f32_32x32x16_bf16 v[80:95], v[116:119], a[40:43], v[80:95]
ds_read_b128 v[108:111], v8 offset:56320
v_cvt_pk_bf16_f32 v168, v32, v33
v_cvt_pk_bf16_f32 v169, v34, v35
ds_read_b128 v[128:131], v18 offset:64
s_waitcnt lgkmcnt(5)
v_mfma_f32_32x32x16_bf16 v[64:79], v[120:123], a[44:47], v[64:79]
ds_read_b128 v[112:115], v8 offset:57344
ds_read_b128 v[132:135], v18 offset:448
ds_read_b128 v[136:139], v18 offset:832
ds_read_b128 v[140:143], v18 offset:1216
v_fma_f32 v148, v11, v144, v148
v_mfma_f32_32x32x16_bf16 v[80:95], v[124:127], a[44:47], v[80:95]
ds_read_b128 v[116:119], v8 offset:58368
s_add_u32 m0, s90, 139264
s_add_u32 s91, s88, 192512
buffer_load_dwordx4 v8, s[40:43], s91 offen sc1 lds
v_fma_f32 v156, v11, v152, v156
v_fma_f32 v149, v11, v145, v149
v_fma_f32 v157, v11, v153, v157
s_waitcnt lgkmcnt(8)
v_mfma_f32_32x32x16_bf16 v[64:79], v[96:99], a[48:51], v[64:79]
ds_read_b128 v[120:123], v8 offset:59392
v_fma_f32 v150, v11, v146, v150
v_fma_f32 v158, v11, v154, v158
v_fma_f32 v151, v11, v147, v151
v_fma_f32 v159, v11, v155, v159
v_mfma_f32_32x32x16_bf16 v[80:95], v[100:103], a[48:51], v[80:95]
ds_read_b128 v[124:127], v8 offset:60416
s_add_u32 m0, s90, 143360
s_add_u32 s91, s88, 196608
buffer_load_dwordx4 v8, s[40:43], s91 offen sc1 lds
v_fma_f32 v36, v10, v36, v148
v_fma_f32 v37, v10, v37, v149
v_fma_f32 v38, v10, v38, v150
s_waitcnt lgkmcnt(8)
v_mfma_f32_32x32x16_bf16 v[64:79], v[104:107], a[52:55], v[64:79]
ds_read_b128 v[96:99], v8 offset:61440
v_fma_f32 v39, v10, v39, v151
v_mul_f32 v160, v36, v36
v_mul_f32 v161, v37, v37
v_mfma_f32_32x32x16_bf16 v[80:95], v[108:111], a[52:55], v[80:95]
ds_read_b128 v[100:103], v8 offset:62464
v_mul_f32 v162, v38, v38
v_mul_f32 v163, v39, v39
v_fma_f32 v52, v10, v52, v156
v_fma_f32 v53, v10, v53, v157
s_waitcnt lgkmcnt(4)
v_mfma_f32_32x32x16_bf16 v[64:79], v[112:115], a[56:59], v[64:79]
ds_read_b128 v[104:107], v8 offset:63488
s_add_u32 m0, s90, 147456
s_add_u32 s91, s88, 200704
buffer_load_dwordx4 v8, s[40:43], s91 offen sc1 lds
v_fma_f32 v54, v10, v54, v158
v_fma_f32 v55, v10, v55, v159
v_fmamk_f32 v160, v160, 0xbdd2d3e8, v20
v_mfma_f32_32x32x16_bf16 v[80:95], v[116:119], a[56:59], v[80:95]
ds_read_b128 v[108:111], v8 offset:64512
v_fmamk_f32 v161, v161, 0xbdd2d3e8, v20
v_fmamk_f32 v162, v162, 0xbdd2d3e8, v20
v_fmamk_f32 v163, v163, 0xbdd2d3e8, v20
v_mul_f32 v160, v160, v36
s_waitcnt lgkmcnt(4)
v_mfma_f32_32x32x16_bf16 v[64:79], v[120:123], a[60:63], v[64:79]
ds_read_b128 v[112:115], v16 offset:0
s_add_u32 m0, s90, 151552
s_add_u32 s91, s88, 204800
buffer_load_dwordx4 v8, s[40:43], s91 offen sc1 lds
v_mul_f32 v161, v161, v37
v_mul_f32 v162, v162, v38
v_mul_f32 v163, v163, v39
v_mfma_f32_32x32x16_bf16 v[80:95], v[124:127], a[60:63], v[80:95]
ds_read_b128 v[116:119], v16 offset:1024
v_exp_f32 v160, v160
v_exp_f32 v161, v161
s_waitcnt lgkmcnt(4)
v_mfma_f32_32x32x16_bf16 v[64:79], v[96:99], a[64:67], v[64:79]
ds_read_b128 v[120:123], v16 offset:2048
v_exp_f32 v162, v162
v_exp_f32 v163, v163
v_mfma_f32_32x32x16_bf16 v[80:95], v[100:103], a[64:67], v[80:95]
ds_read_b128 v[124:127], v16 offset:3072
s_add_u32 m0, s90, 0
s_add_u32 s91, s88, 208896
buffer_load_dwordx4 v8, s[40:43], s91 offen sc1 lds
v_mul_f32 v36, v36, v52
v_mul_f32 v37, v37, v53
s_waitcnt lgkmcnt(4)
v_mfma_f32_32x32x16_bf16 v[64:79], v[104:107], a[68:71], v[64:79]
ds_read_b128 v[96:99], v16 offset:4096
v_mul_f32 v38, v38, v54
v_mul_f32 v39, v39, v55
v_add_f32 v160, 1.0, v160
v_add_f32 v161, 1.0, v161
v_mfma_f32_32x32x16_bf16 v[80:95], v[108:111], a[68:71], v[80:95]
ds_read_b128 v[100:103], v16 offset:5120
s_add_u32 m0, s90, 4096
s_add_u32 s91, s88, 212992
buffer_load_dwordx4 v8, s[40:43], s91 offen sc1 lds
v_add_f32 v162, 1.0, v162
v_add_f32 v163, 1.0, v163
v_rcp_f32 v160, v160
s_waitcnt lgkmcnt(4)
v_mfma_f32_32x32x16_bf16 v[64:79], v[112:115], a[72:75], v[64:79]
ds_read_b128 v[104:107], v16 offset:6144
v_rcp_f32 v161, v161
v_mfma_f32_32x32x16_bf16 v[80:95], v[116:119], a[72:75], v[80:95]
ds_read_b128 v[108:111], v16 offset:7168
v_rcp_f32 v162, v162
v_rcp_f32 v163, v163
s_waitcnt lgkmcnt(4)
v_mfma_f32_32x32x16_bf16 v[64:79], v[120:123], a[76:79], v[64:79]
ds_read_b128 v[112:115], v16 offset:8192
s_add_u32 m0, s90, 8192
s_add_u32 s91, s88, 217088
buffer_load_dwordx4 v8, s[40:43], s91 offen sc1 lds
v_mul_f32 v36, v36, v160
v_mul_f32 v37, v37, v161
v_mul_f32 v38, v38, v162
v_mfma_f32_32x32x16_bf16 v[80:95], v[124:127], a[76:79], v[80:95]
ds_read_b128 v[116:119], v16 offset:9216
v_mul_f32 v39, v39, v163
v_cvt_pk_bf16_f32 v170, v36, v37
v_cvt_pk_bf16_f32 v171, v38, v39
s_nop 0
v_permlane32_swap_b32 v168, v170
s_waitcnt lgkmcnt(4)
v_mfma_f32_32x32x16_bf16 v[64:79], v[96:99], a[80:83], v[64:79]
ds_read_b128 v[120:123], v16 offset:10240
s_add_u32 m0, s90, 12288
s_add_u32 s91, s88, 221184
buffer_load_dwordx4 v8, s[40:43], s91 offen sc1 lds
v_permlane32_swap_b32 v169, v171
v_mfma_f32_32x32x16_bf16 v[80:95], v[100:103], a[80:83], v[80:95]
ds_read_b128 v[124:127], v16 offset:11264
buffer_store_dwordx4 v[168:171], v19, s[40:43], s86 offen offset:0 sc1
ds_read_b128 v[144:147], v18 offset:96
ds_read_b128 v[148:151], v18 offset:480
s_waitcnt lgkmcnt(6)
v_mfma_f32_32x32x16_bf16 v[64:79], v[104:107], a[84:87], v[64:79]
ds_read_b128 v[96:99], v16 offset:12288
ds_read_b128 v[152:155], v18 offset:864
ds_read_b128 v[156:159], v18 offset:1248
v_fma_f32 v132, v11, v128, v132
v_fma_f32 v140, v11, v136, v140
v_mfma_f32_32x32x16_bf16 v[80:95], v[108:111], a[84:87], v[80:95]
ds_read_b128 v[100:103], v16 offset:13312
v_fma_f32 v133, v11, v129, v133
v_fma_f32 v141, v11, v137, v141
v_fma_f32 v134, v11, v130, v134
s_waitcnt lgkmcnt(8)
v_mfma_f32_32x32x16_bf16 v[64:79], v[112:115], a[88:91], v[64:79]
ds_read_b128 v[104:107], v16 offset:14336
v_fma_f32 v142, v11, v138, v142
v_fma_f32 v135, v11, v131, v135
v_fma_f32 v143, v11, v139, v143
v_mfma_f32_32x32x16_bf16 v[80:95], v[116:119], a[88:91], v[80:95]
ds_read_b128 v[108:111], v16 offset:15360
v_fma_f32 v40, v10, v40, v132
v_fma_f32 v41, v10, v41, v133
v_fma_f32 v42, v10, v42, v134
v_fma_f32 v43, v10, v43, v135
s_waitcnt lgkmcnt(8)
v_mfma_f32_32x32x16_bf16 v[64:79], v[120:123], a[92:95], v[64:79]
ds_read_b128 v[112:115], v16 offset:16384
v_mul_f32 v160, v40, v40
v_mul_f32 v161, v41, v41
v_mul_f32 v162, v42, v42
v_mfma_f32_32x32x16_bf16 v[80:95], v[124:127], a[92:95], v[80:95]
ds_read_b128 v[116:119], v16 offset:17408
v_mul_f32 v163, v43, v43
v_fma_f32 v56, v10, v56, v140
v_fma_f32 v57, v10, v57, v141
v_fma_f32 v58, v10, v58, v142
s_waitcnt vmcnt(16)
s_add_u32 s72, s8, 4
v_subrev_u32 v5, s72, v5
v_cmp_lt_u32 vcc, 11, v5
s_nop 3
s_cbranch_vccnz L_slow_29
L_back_30:
s_add_u32 s72, s8, 4
v_subrev_u32 v6, s72, v6
v_cmp_lt_u32 vcc, 11, v6
s_nop 3
s_cbranch_vccnz L_slow_31
L_back_32:
s_add_u32 s72, s8, 5
v_subrev_u32 v177, s72, v177
v_cmp_lt_u32 vcc, 10, v177
s_nop 3
s_cbranch_vccnz L_slow_33
L_back_34:
s_or_b32 s11, s9, s3
s_cmp_eq_u32 s11, 0
s_cselect_b32 s11, 0, 0x40000000
v_mov_b32 v1, s8
s_mov_b32 exec_lo, 0x1
s_mov_b32 exec_hi, 0x0
buffer_store_dword v1, off, s[40:43], s11 sc1
s_mov_b64 exec, -1
s_barrier
s_waitcnt lgkmcnt(4)
v_mfma_f32_32x32x16_bf16 v[64:79], v[96:99], a[96:99], v[64:79]
ds_read_b128 v[120:123], v16 offset:18432
s_add_u32 m0, s90, 16384
s_add_u32 s91, s88, 225280
buffer_load_dwordx4 v8, s[40:43], s91 offen sc1 lds
v_fma_f32 v59, v10, v59, v143
v_fmamk_f32 v160, v160, 0xbdd2d3e8, v20
v_fmamk_f32 v161, v161, 0xbdd2d3e8, v20
v_mfma_f32_32x32x16_bf16 v[80:95], v[100:103], a[96:99], v[80:95]
ds_read_b128 v[124:127], v16 offset:19456
v_fmamk_f32 v162, v162, 0xbdd2d3e8, v20
v_fmamk_f32 v163, v163, 0xbdd2d3e8, v20
v_mul_f32 v160, v160, v40
s_waitcnt lgkmcnt(4)
v_mfma_f32_32x32x16_bf16 v[64:79], v[104:107], a[100:103], v[64:79]
ds_read_b128 v[96:99], v16 offset:20480
s_add_u32 m0, s90, 20480
s_add_u32 s91, s88, 229376
buffer_load_dwordx4 v8, s[40:43], s91 offen sc1 lds
v_mul_f32 v161, v161, v41
v_mul_f32 v162, v162, v42
v_mul_f32 v163, v163, v43
v_exp_f32 v160, v160
v_mfma_f32_32x32x16_bf16 v[80:95], v[108:111], a[100:103], v[80:95]
ds_read_b128 v[100:103], v16 offset:21504
v_exp_f32 v161, v161
s_waitcnt lgkmcnt(4)
v_mfma_f32_32x32x16_bf16 v[64:79], v[112:115], a[104:107], v[64:79]
ds_read_b128 v[104:107], v16 offset:22528
s_add_u32 m0, s90, 24576
s_add_u32 s91, s88, 233472
buffer_load_dwordx4 v8, s[40:43], s91 offen sc1 lds
v_exp_f32 v162, v162
v_exp_f32 v163, v163
v_mfma_f32_32x32x16_bf16 v[80:95], v[116:119], a[104:107], v[80:95]
ds_read_b128 v[108:111], v16 offset:23552
v_mul_f32 v40, v40, v56
v_mul_f32 v41, v41, v57
v_mul_f32 v42, v42, v58
s_waitcnt lgkmcnt(4)
v_mfma_f32_32x32x16_bf16 v[64:79], v[120:123], a[108:111], v[64:79]
ds_read_b128 v[112:115], v16 offset:24576
s_add_u32 m0, s90, 28672
s_add_u32 s91, s88, 237568
buffer_load_dwordx4 v8, s[40:43], s91 offen sc1 lds
v_mul_f32 v43, v43, v59
v_add_f32 v160, 1.0, v160
v_add_f32 v161, 1.0, v161
v_mfma_f32_32x32x16_bf16 v[80:95], v[124:127], a[108:111], v[80:95]
ds_read_b128 v[116:119], v16 offset:25600
v_add_f32 v162, 1.0, v162
v_add_f32 v163, 1.0, v163
v_rcp_f32 v160, v160
s_waitcnt lgkmcnt(4)
v_mfma_f32_32x32x16_bf16 v[64:79], v[96:99], a[112:115], v[64:79]
ds_read_b128 v[120:123], v16 offset:26624
s_add_u32 m0, s90, 32768
s_add_u32 s91, s88, 241664
buffer_load_dwordx4 v8, s[40:43], s91 offen sc1 lds
v_rcp_f32 v161, v161
v_rcp_f32 v162, v162
v_mfma_f32_32x32x16_bf16 v[80:95], v[100:103], a[112:115], v[80:95]
ds_read_b128 v[124:127], v16 offset:27648
v_rcp_f32 v163, v163
v_mul_f32 v40, v40, v160
s_waitcnt lgkmcnt(4)
v_mfma_f32_32x32x16_bf16 v[64:79], v[104:107], a[116:119], v[64:79]
ds_read_b128 v[96:99], v16 offset:28672
s_add_u32 m0, s90, 36864
s_add_u32 s91, s89, 0
buffer_load_dwordx4 v8, s[40:43], s91 offen sc1 lds
v_mul_f32 v41, v41, v161
v_mul_f32 v42, v42, v162
v_mul_f32 v43, v43, v163
v_mfma_f32_32x32x16_bf16 v[80:95], v[108:111], a[116:119], v[80:95]
ds_read_b128 v[100:103], v16 offset:29696
v_cvt_pk_bf16_f32 v172, v40, v41
v_cvt_pk_bf16_f32 v173, v42, v43
v_fma_f32 v148, v11, v144, v148
s_waitcnt lgkmcnt(4)
v_mfma_f32_32x32x16_bf16 v[64:79], v[112:115], a[120:123], v[64:79]
ds_read_b128 v[104:107], v16 offset:30720
s_add_u32 m0, s90, 40960
s_add_u32 s91, s89, 4096
buffer_load_dwordx4 v8, s[40:43], s91 offen sc1 lds
v_fma_f32 v156, v11, v152, v156
v_fma_f32 v149, v11, v145, v149
v_fma_f32 v157, v11, v153, v157
v_fma_f32 v150, v11, v146, v150
v_mfma_f32_32x32x16_bf16 v[80:95], v[116:119], a[120:123], v[80:95]
ds_read_b128 v[108:111], v16 offset:31744
v_fma_f32 v158, v11, v154, v158
v_fma_f32 v151, v11, v147, v151
v_fma_f32 v159, v11, v155, v159
s_waitcnt lgkmcnt(4)
v_mfma_f32_32x32x16_bf16 v[64:79], v[120:123], a[124:127], v[64:79]
ds_read_b128 v[112:115], v16 offset:32768
s_add_u32 m0, s90, 45056
s_add_u32 s91, s89, 8192
buffer_load_dwordx4 v8, s[40:43], s91 offen sc1 lds
v_fma_f32 v44, v10, v44, v148
v_fma_f32 v45, v10, v45, v149
v_fma_f32 v46, v10, v46, v150
v_fma_f32 v47, v10, v47, v151
v_mfma_f32_32x32x16_bf16 v[80:95], v[124:127], a[124:127], v[80:95]
ds_read_b128 v[116:119], v16 offset:33792
v_mul_f32 v160, v44, v44
v_mul_f32 v161, v45, v45
v_mul_f32 v162, v46, v46
s_waitcnt lgkmcnt(4)
v_mfma_f32_32x32x16_bf16 v[64:79], v[96:99], a[128:131], v[64:79]
ds_read_b128 v[120:123], v16 offset:34816
s_add_u32 m0, s90, 49152
s_add_u32 s91, s89, 12288
buffer_load_dwordx4 v8, s[40:43], s91 offen sc1 lds
v_mul_f32 v163, v47, v47
v_fma_f32 v60, v10, v60, v156
v_fma_f32 v61, v10, v61, v157
v_mfma_f32_32x32x16_bf16 v[80:95], v[100:103], a[128:131], v[80:95]
ds_read_b128 v[124:127], v16 offset:35840
v_fma_f32 v62, v10, v62, v158
v_fma_f32 v63, v10, v63, v159
v_fmamk_f32 v160, v160, 0xbdd2d3e8, v20
v_fmamk_f32 v161, v161, 0xbdd2d3e8, v20
s_waitcnt lgkmcnt(4)
v_mfma_f32_32x32x16_bf16 v[64:79], v[104:107], a[132:135], v[64:79]
ds_read_b128 v[96:99], v16 offset:36864
s_add_u32 m0, s90, 53248
s_add_u32 s91, s89, 16384
buffer_load_dwordx4 v8, s[40:43], s91 offen sc1 lds
v_fmamk_f32 v162, v162, 0xbdd2d3e8, v20
v_fmamk_f32 v163, v163, 0xbdd2d3e8, v20
v_mul_f32 v160, v160, v44
v_mfma_f32_32x32x16_bf16 v[80:95], v[108:111], a[132:135], v[80:95]
ds_read_b128 v[100:103], v16 offset:37888
v_mul_f32 v161, v161, v45
v_mul_f32 v162, v162, v46
v_mul_f32 v163, v163, v47
v_exp_f32 v160, v160
s_waitcnt lgkmcnt(4)
v_mfma_f32_32x32x16_bf16 v[64:79], v[112:115], a[136:139], v[64:79]
ds_read_b128 v[104:107], v16 offset:38912
s_add_u32 m0, s90, 57344
s_add_u32 s91, s89, 20480
buffer_load_dwordx4 v8, s[40:43], s91 offen sc1 lds
v_exp_f32 v161, v161
v_mfma_f32_32x32x16_bf16 v[80:95], v[116:119], a[136:139], v[80:95]
ds_read_b128 v[108:111], v16 offset:39936
v_exp_f32 v162, v162
v_exp_f32 v163, v163
s_waitcnt lgkmcnt(4)
v_mfma_f32_32x32x16_bf16 v[64:79], v[120:123], a[140:143], v[64:79]
ds_read_b128 v[112:115], v16 offset:40960
s_add_u32 m0, s90, 61440
s_add_u32 s91, s89, 24576
buffer_load_dwordx4 v8, s[40:43], s91 offen sc1 lds
v_mul_f32 v44, v44, v60
v_mul_f32 v45, v45, v61
v_mul_f32 v46, v46, v62
v_mfma_f32_32x32x16_bf16 v[80:95], v[124:127], a[140:143], v[80:95]
ds_read_b128 v[116:119], v16 offset:41984
v_mul_f32 v47, v47, v63
v_add_f32 v160, 1.0, v160
v_add_f32 v161, 1.0, v161
s_waitcnt lgkmcnt(4)
v_mfma_f32_32x32x16_bf16 v[64:79], v[96:99], a[144:147], v[64:79]
ds_read_b128 v[120:123], v16 offset:43008
v_add_f32 v162, 1.0, v162
v_add_f32 v163, 1.0, v163
v_rcp_f32 v160, v160
v_mfma_f32_32x32x16_bf16 v[80:95], v[100:103], a[144:147], v[80:95]
ds_read_b128 v[124:127], v16 offset:44032
s_add_u32 m0, s90, 65536
s_add_u32 s91, s89, 28672
buffer_load_dwordx4 v8, s[40:43], s91 offen sc1 lds
v_rcp_f32 v161, v161
v_rcp_f32 v162, v162
s_waitcnt vmcnt(14)
s_barrier
s_waitcnt lgkmcnt(4)
v_mfma_f32_32x32x16_bf16 v[64:79], v[104:107], a[148:151], v[64:79]
ds_read_b128 v[96:99], v16 offset:45056
v_rcp_f32 v163, v163
v_mfma_f32_32x32x16_bf16 v[80:95], v[108:111], a[148:151], v[80:95]
ds_read_b128 v[100:103], v16 offset:46080
s_add_u32 m0, s90, 69632
s_add_u32 s91, s89, 32768
buffer_load_dwordx4 v8, s[40:43], s91 offen sc1 lds
v_mul_f32 v44, v44, v160
v_mul_f32 v45, v45, v161
v_mul_f32 v46, v46, v162
v_mul_f32 v47, v47, v163
s_waitcnt lgkmcnt(4)
v_mfma_f32_32x32x16_bf16 v[64:79], v[112:115], a[152:155], v[64:79]
ds_read_b128 v[104:107], v16 offset:47104
v_cvt_pk_bf16_f32 v174, v44, v45
v_cvt_pk_bf16_f32 v175, v46, v47
s_nop 0
v_permlane32_swap_b32 v172, v174
v_mfma_f32_32x32x16_bf16 v[80:95], v[116:119], a[152:155], v[80:95]
ds_read_b128 v[108:111], v16 offset:48128
v_permlane32_swap_b32 v173, v175
buffer_store_dwordx4 v[172:175], v19, s[40:43], s86 offen offset:512 sc1
s_waitcnt lgkmcnt(4)
v_mfma_f32_32x32x16_bf16 v[64:79], v[120:123], a[156:159], v[64:79]
ds_read_b128 v[112:115], v16 offset:49152
s_add_u32 m0, s90, 73728
s_add_u32 s91, s89, 36864
buffer_load_dwordx4 v8, s[40:43], s91 offen sc1 lds
v_mfma_f32_32x32x16_bf16 v[80:95], v[124:127], a[156:159], v[80:95]
ds_read_b128 v[116:119], v16 offset:50176
s_waitcnt lgkmcnt(4)
v_mfma_f32_32x32x16_bf16 v[32:47], v[96:99], a[0:3], 0
ds_read_b128 v[120:123], v16 offset:51200
v_mfma_f32_32x32x16_bf16 v[48:63], v[100:103], a[0:3], 0
ds_read_b128 v[124:127], v16 offset:52224
s_add_u32 m0, s90, 77824
s_add_u32 s91, s89, 40960
buffer_load_dwordx4 v8, s[40:43], s91 offen sc1 lds
s_waitcnt lgkmcnt(4)
v_mfma_f32_32x32x16_bf16 v[32:47], v[104:107], a[4:7], v[32:47]
ds_read_b128 v[96:99], v16 offset:53248
ds_read_b128 v[128:131], v18 offset:128
ds_read_b128 v[132:135], v18 offset:512
ds_read_b128 v[136:139], v18 offset:896
v_mfma_f32_32x32x16_bf16 v[48:63], v[108:111], a[4:7], v[48:63]
ds_read_b128 v[100:103], v16 offset:54272
ds_read_b128 v[140:143], v18 offset:1280
ds_read_b128 v[144:147], v18 offset:160
ds_read_b128 v[148:151], v18 offset:544
s_waitcnt lgkmcnt(10)
v_mfma_f32_32x32x16_bf16 v[32:47], v[112:115], a[8:11], v[32:47]
ds_read_b128 v[104:107], v16 offset:55296
s_add_u32 m0, s90, 81920
s_add_u32 s91, s89, 45056
buffer_load_dwordx4 v8, s[40:43], s91 offen sc1 lds
ds_read_b128 v[152:155], v18 offset:928
ds_read_b128 v[156:159], v18 offset:1312
s_waitcnt lgkmcnt(5)
v_fma_f32 v132, v11, v128, v132
v_fma_f32 v140, v11, v136, v140
v_mfma_f32_32x32x16_bf16 v[48:63], v[116:119], a[8:11], v[48:63]
ds_read_b128 v[108:111], v16 offset:56320
v_fma_f32 v133, v11, v129, v133
v_fma_f32 v141, v11, v137, v141
v_fma_f32 v134, v11, v130, v134
v_mfma_f32_32x32x16_bf16 v[32:47], v[120:123], a[12:15], v[32:47]
ds_read_b128 v[112:115], v16 offset:57344
v_fma_f32 v142, v11, v138, v142
v_fma_f32 v135, v11, v131, v135
v_fma_f32 v143, v11, v139, v143
v_mfma_f32_32x32x16_bf16 v[48:63], v[124:127], a[12:15], v[48:63]
ds_read_b128 v[116:119], v16 offset:58368
s_add_u32 m0, s90, 86016
s_add_u32 s91, s89, 49152
buffer_load_dwordx4 v8, s[40:43], s91 offen sc1 lds
v_fma_f32 v64, v10, v64, v132
v_fma_f32 v65, v10, v65, v133
v_fma_f32 v66, v10, v66, v134
v_fma_f32 v67, v10, v67, v135
v_mfma_f32_32x32x16_bf16 v[32:47], v[96:99], a[16:19], v[32:47]
ds_read_b128 v[120:123], v16 offset:59392
v_mul_f32 v160, v64, v64
v_mul_f32 v161, v65, v65
v_mul_f32 v162, v66, v66
v_mfma_f32_32x32x16_bf16 v[48:63], v[100:103], a[16:19], v[48:63]
ds_read_b128 v[124:127], v16 offset:60416
v_mul_f32 v163, v67, v67
v_fma_f32 v80, v10, v80, v140
v_fma_f32 v81, v10, v81, v141
v_fma_f32 v82, v10, v82, v142
s_waitcnt lgkmcnt(4)
v_mfma_f32_32x32x16_bf16 v[32:47], v[104:107], a[20:23], v[32:47]
ds_read_b128 v[96:99], v16 offset:61440
s_add_u32 m0, s90, 90112
s_add_u32 s91, s89, 53248
buffer_load_dwordx4 v8, s[40:43], s91 offen sc1 lds
v_fma_f32 v83, v10, v83, v143
v_fmamk_f32 v160, v160, 0xbdd2d3e8, v20
v_fmamk_f32 v161, v161, 0xbdd2d3e8, v20
v_mfma_f32_32x32x16_bf16 v[48:63], v[108:111], a[20:23], v[48:63]
ds_read_b128 v[100:103], v16 offset:62464
v_fmamk_f32 v162, v162, 0xbdd2d3e8, v20
v_fmamk_f32 v163, v163, 0xbdd2d3e8, v20
v_mul_f32 v160, v160, v64
s_waitcnt lgkmcnt(4)
v_mfma_f32_32x32x16_bf16 v[32:47], v[112:115], a[24:27], v[32:47]
ds_read_b128 v[104:107], v16 offset:63488
v_mul_f32 v161, v161, v65
v_mul_f32 v162, v162, v66
v_mul_f32 v163, v163, v67
v_exp_f32 v160, v160
v_mfma_f32_32x32x16_bf16 v[48:63], v[116:119], a[24:27], v[48:63]
ds_read_b128 v[108:111], v16 offset:64512
s_add_u32 m0, s90, 94208
s_add_u32 s91, s89, 57344
buffer_load_dwordx4 v8, s[40:43], s91 offen sc1 lds
v_exp_f32 v161, v161
s_waitcnt lgkmcnt(4)
v_mfma_f32_32x32x16_bf16 v[32:47], v[120:123], a[28:31], v[32:47]
ds_read_b128 v[112:115], v17 offset:0
v_exp_f32 v162, v162
v_exp_f32 v163, v163
s_waitcnt vmcnt(6)
s_add_u32 s72, s8, 7
v_mov_b32 v1, s72
s_mov_b64 exec, 1
buffer_store_dword v1, off, s[40:43], s10 sc1
s_mov_b64 exec, -1
v_mfma_f32_32x32x16_bf16 v[48:63], v[124:127], a[28:31], v[48:63]
ds_read_b128 v[116:119], v17 offset:1024
v_mul_f32 v64, v64, v80
v_mul_f32 v65, v65, v81
v_mul_f32 v66, v66, v82
s_waitcnt lgkmcnt(4)
v_mfma_f32_32x32x16_bf16 v[32:47], v[96:99], a[32:35], v[32:47]
ds_read_b128 v[120:123], v17 offset:2048
s_add_u32 m0, s90, 98304
s_add_u32 s91, s89, 61440
buffer_load_dwordx4 v8, s[40:43], s91 offen sc1 lds
v_mul_f32 v67, v67, v83
v_add_f32 v160, 1.0, v160
v_add_f32 v161, 1.0, v161
v_mfma_f32_32x32x16_bf16 v[48:63], v[100:103], a[32:35], v[48:63]
ds_read_b128 v[124:127], v17 offset:3072
v_add_f32 v162, 1.0, v162
v_add_f32 v163, 1.0, v163
v_rcp_f32 v160, v160
s_waitcnt lgkmcnt(4)
v_mfma_f32_32x32x16_bf16 v[32:47], v[104:107], a[36:39], v[32:47]
ds_read_b128 v[96:99], v17 offset:4096
v_rcp_f32 v161, v161
v_rcp_f32 v162, v162
v_mfma_f32_32x32x16_bf16 v[48:63], v[108:111], a[36:39], v[48:63]
ds_read_b128 v[100:103], v17 offset:5120
v_rcp_f32 v163, v163
v_mul_f32 v64, v64, v160
s_waitcnt lgkmcnt(4)
v_mfma_f32_32x32x16_bf16 v[32:47], v[112:115], a[40:43], v[32:47]
ds_read_b128 v[104:107], v17 offset:6144
v_mul_f32 v65, v65, v161
v_mul_f32 v66, v66, v162
v_mul_f32 v67, v67, v163
v_mfma_f32_32x32x16_bf16 v[48:63], v[116:119], a[40:43], v[48:63]
ds_read_b128 v[108:111], v17 offset:7168
v_cvt_pk_bf16_f32 v168, v64, v65
v_cvt_pk_bf16_f32 v169, v66, v67
ds_read_b128 v[128:131], v18 offset:192
s_waitcnt lgkmcnt(5)
v_mfma_f32_32x32x16_bf16 v[32:47], v[120:123], a[44:47], v[32:47]
ds_read_b128 v[112:115], v17 offset:8192
ds_read_b128 v[132:135], v18 offset:576
ds_read_b128 v[136:139], v18 offset:960
ds_read_b128 v[140:143], v18 offset:1344
v_fma_f32 v148, v11, v144, v148
v_mfma_f32_32x32x16_bf16 v[48:63], v[124:127], a[44:47], v[48:63]
ds_read_b128 v[116:119], v17 offset:9216
v_fma_f32 v156, v11, v152, v156
v_fma_f32 v149, v11, v145, v149
v_fma_f32 v157, v11, v153, v157
s_waitcnt lgkmcnt(8)
v_mfma_f32_32x32x16_bf16 v[32:47], v[96:99], a[48:51], v[32:47]
ds_read_b128 v[120:123], v17 offset:10240
v_fma_f32 v150, v11, v146, v150
v_fma_f32 v158, v11, v154, v158
v_fma_f32 v151, v11, v147, v151
v_fma_f32 v159, v11, v155, v159
v_mfma_f32_32x32x16_bf16 v[48:63], v[100:103], a[48:51], v[48:63]
ds_read_b128 v[124:127], v17 offset:11264
v_fma_f32 v68, v10, v68, v148
v_fma_f32 v69, v10, v69, v149
v_fma_f32 v70, v10, v70, v150
s_waitcnt lgkmcnt(8)
v_mfma_f32_32x32x16_bf16 v[32:47], v[104:107], a[52:55], v[32:47]
ds_read_b128 v[96:99], v17 offset:12288
v_fma_f32 v71, v10, v71, v151
v_mul_f32 v160, v68, v68
v_mul_f32 v161, v69, v69
v_mfma_f32_32x32x16_bf16 v[48:63], v[108:111], a[52:55], v[48:63]
ds_read_b128 v[100:103], v17 offset:13312
v_mul_f32 v162, v70, v70
v_mul_f32 v163, v71, v71
v_fma_f32 v84, v10, v84, v156
v_fma_f32 v85, v10, v85, v157
s_waitcnt lgkmcnt(4)
v_mfma_f32_32x32x16_bf16 v[32:47], v[112:115], a[56:59], v[32:47]
ds_read_b128 v[104:107], v17 offset:14336
v_fma_f32 v86, v10, v86, v158
v_fma_f32 v87, v10, v87, v159
v_fmamk_f32 v160, v160, 0xbdd2d3e8, v20
v_mfma_f32_32x32x16_bf16 v[48:63], v[116:119], a[56:59], v[48:63]
ds_read_b128 v[108:111], v17 offset:15360
v_fmamk_f32 v161, v161, 0xbdd2d3e8, v20
v_fmamk_f32 v162, v162, 0xbdd2d3e8, v20
v_fmamk_f32 v163, v163, 0xbdd2d3e8, v20
v_mul_f32 v160, v160, v68
s_waitcnt lgkmcnt(4)
v_mfma_f32_32x32x16_bf16 v[32:47], v[120:123], a[60:63], v[32:47]
ds_read_b128 v[112:115], v17 offset:16384
v_mul_f32 v161, v161, v69
v_mul_f32 v162, v162, v70
v_mul_f32 v163, v163, v71
v_mfma_f32_32x32x16_bf16 v[48:63], v[124:127], a[60:63], v[48:63]
ds_read_b128 v[116:119], v17 offset:17408
v_exp_f32 v160, v160
v_exp_f32 v161, v161
s_waitcnt lgkmcnt(4)
v_mfma_f32_32x32x16_bf16 v[32:47], v[96:99], a[64:67], v[32:47]
ds_read_b128 v[120:123], v17 offset:18432
v_exp_f32 v162, v162
v_exp_f32 v163, v163
v_mfma_f32_32x32x16_bf16 v[48:63], v[100:103], a[64:67], v[48:63]
ds_read_b128 v[124:127], v17 offset:19456
v_mul_f32 v68, v68, v84
v_mul_f32 v69, v69, v85
s_waitcnt lgkmcnt(4)
v_mfma_f32_32x32x16_bf16 v[32:47], v[104:107], a[68:71], v[32:47]
ds_read_b128 v[96:99], v17 offset:20480
v_mul_f32 v70, v70, v86
v_mul_f32 v71, v71, v87
v_add_f32 v160, 1.0, v160
v_add_f32 v161, 1.0, v161
v_mfma_f32_32x32x16_bf16 v[48:63], v[108:111], a[68:71], v[48:63]
ds_read_b128 v[100:103], v17 offset:21504
v_add_f32 v162, 1.0, v162
v_add_f32 v163, 1.0, v163
v_rcp_f32 v160, v160
s_waitcnt lgkmcnt(4)
v_mfma_f32_32x32x16_bf16 v[32:47], v[112:115], a[72:75], v[32:47]
ds_read_b128 v[104:107], v17 offset:22528
v_rcp_f32 v161, v161
v_mfma_f32_32x32x16_bf16 v[48:63], v[116:119], a[72:75], v[48:63]
ds_read_b128 v[108:111], v17 offset:23552
v_rcp_f32 v162, v162
v_rcp_f32 v163, v163
s_waitcnt lgkmcnt(4)
v_mfma_f32_32x32x16_bf16 v[32:47], v[120:123], a[76:79], v[32:47]
ds_read_b128 v[112:115], v8 offset:0
v_mul_f32 v68, v68, v160
v_mul_f32 v69, v69, v161
v_mul_f32 v70, v70, v162
v_mfma_f32_32x32x16_bf16 v[48:63], v[124:127], a[76:79], v[48:63]
ds_read_b128 v[116:119], v8 offset:1024
v_mul_f32 v71, v71, v163
v_cvt_pk_bf16_f32 v170, v68, v69
v_cvt_pk_bf16_f32 v171, v70, v71
s_nop 0
v_permlane32_swap_b32 v168, v170
s_barrier
s_waitcnt lgkmcnt(4)
v_mfma_f32_32x32x16_bf16 v[32:47], v[96:99], a[80:83], v[32:47]
ds_read_b128 v[120:123], v8 offset:2048
s_add_u32 m0, s90, 102400
s_add_u32 s91, s89, 65536
buffer_load_dwordx4 v8, s[40:43], s91 offen sc1 lds
v_permlane32_swap_b32 v169, v171
v_mfma_f32_32x32x16_bf16 v[48:63], v[100:103], a[80:83], v[48:63]
ds_read_b128 v[124:127], v8 offset:3072
buffer_store_dwordx4 v[168:171], v19, s[40:43], s86 offen offset:1024 sc1
ds_read_b128 v[144:147], v18 offset:224
ds_read_b128 v[148:151], v18 offset:608
s_waitcnt lgkmcnt(6)
v_mfma_f32_32x32x16_bf16 v[32:47], v[104:107], a[84:87], v[32:47]
ds_read_b128 v[96:99], v8 offset:4096
s_add_u32 m0, s90, 106496
s_add_u32 s91, s89, 69632
buffer_load_dwordx4 v8, s[40:43], s91 offen sc1 lds
ds_read_b128 v[152:155], v18 offset:992
ds_read_b128 v[156:159], v18 offset:1376
v_fma_f32 v132, v11, v128, v132
v_fma_f32 v140, v11, v136, v140
v_mfma_f32_32x32x16_bf16 v[48:63], v[108:111], a[84:87], v[48:63]
ds_read_b128 v[100:103], v8 offset:5120
v_fma_f32 v133, v11, v129, v133
v_fma_f32 v141, v11, v137, v141
v_fma_f32 v134, v11, v130, v134
s_waitcnt lgkmcnt(8)
v_mfma_f32_32x32x16_bf16 v[32:47], v[112:115], a[88:91], v[32:47]
ds_read_b128 v[104:107], v8 offset:6144
s_add_u32 m0, s90, 110592
s_add_u32 s91, s89, 73728
buffer_load_dwordx4 v8, s[40:43], s91 offen sc1 lds
v_fma_f32 v142, v11, v138, v142
v_fma_f32 v135, v11, v131, v135
v_fma_f32 v143, v11, v139, v143
v_mfma_f32_32x32x16_bf16 v[48:63], v[116:119], a[88:91], v[48:63]
ds_read_b128 v[108:111], v8 offset:7168
v_fma_f32 v72, v10, v72, v132
v_fma_f32 v73, v10, v73, v133
v_fma_f32 v74, v10, v74, v134
v_fma_f32 v75, v10, v75, v135
s_waitcnt lgkmcnt(8)
v_mfma_f32_32x32x16_bf16 v[32:47], v[120:123], a[92:95], v[32:47]
ds_read_b128 v[112:115], v8 offset:8192
s_add_u32 m0, s90, 114688
s_add_u32 s91, s89, 77824
buffer_load_dwordx4 v8, s[40:43], s91 offen sc1 lds
v_mul_f32 v160, v72, v72
v_mul_f32 v161, v73, v73
v_mul_f32 v162, v74, v74
v_mfma_f32_32x32x16_bf16 v[48:63], v[124:127], a[92:95], v[48:63]
ds_read_b128 v[116:119], v8 offset:9216
v_mul_f32 v163, v75, v75
v_fma_f32 v88, v10, v88, v140
v_fma_f32 v89, v10, v89, v141
v_fma_f32 v90, v10, v90, v142
s_waitcnt lgkmcnt(4)
v_mfma_f32_32x32x16_bf16 v[32:47], v[96:99], a[96:99], v[32:47]
ds_read_b128 v[120:123], v8 offset:10240
s_add_u32 m0, s90, 118784
s_add_u32 s91, s89, 81920
buffer_load_dwordx4 v8, s[40:43], s91 offen sc1 lds
v_fma_f32 v91, v10, v91, v143
v_fmamk_f32 v160, v160, 0xbdd2d3e8, v20
v_fmamk_f32 v161, v161, 0xbdd2d3e8, v20
v_mfma_f32_32x32x16_bf16 v[48:63], v[100:103], a[96:99], v[48:63]
ds_read_b128 v[124:127], v8 offset:11264
v_fmamk_f32 v162, v162, 0xbdd2d3e8, v20
v_fmamk_f32 v163, v163, 0xbdd2d3e8, v20
v_mul_f32 v160, v160, v72
s_waitcnt lgkmcnt(4)
v_mfma_f32_32x32x16_bf16 v[32:47], v[104:107], a[100:103], v[32:47]
ds_read_b128 v[96:99], v8 offset:12288
s_add_u32 m0, s90, 122880
s_add_u32 s91, s89, 86016
buffer_load_dwordx4 v8, s[40:43], s91 offen sc1 lds
v_mul_f32 v161, v161, v73
v_mul_f32 v162, v162, v74
v_mul_f32 v163, v163, v75
v_exp_f32 v160, v160
v_mfma_f32_32x32x16_bf16 v[48:63], v[108:111], a[100:103], v[48:63]
ds_read_b128 v[100:103], v8 offset:13312
v_exp_f32 v161, v161
s_waitcnt lgkmcnt(4)
v_mfma_f32_32x32x16_bf16 v[32:47], v[112:115], a[104:107], v[32:47]
ds_read_b128 v[104:107], v8 offset:14336
s_add_u32 m0, s90, 126976
s_add_u32 s91, s89, 90112
buffer_load_dwordx4 v8, s[40:43], s91 offen sc1 lds
v_exp_f32 v162, v162
v_exp_f32 v163, v163
buffer_load_dword v5, v31, s[40:43], 0 offen sc1
v_mfma_f32_32x32x16_bf16 v[48:63], v[116:119], a[104:107], v[48:63]
ds_read_b128 v[108:111], v8 offset:15360
v_mul_f32 v72, v72, v88
v_mul_f32 v73, v73, v89
v_mul_f32 v74, v74, v90
s_waitcnt lgkmcnt(4)
v_mfma_f32_32x32x16_bf16 v[32:47], v[120:123], a[108:111], v[32:47]
ds_read_b128 v[112:115], v8 offset:16384
s_add_u32 m0, s90, 131072
s_add_u32 s91, s89, 94208
buffer_load_dwordx4 v8, s[40:43], s91 offen sc1 lds
v_mul_f32 v75, v75, v91
v_add_f32 v160, 1.0, v160
v_add_f32 v161, 1.0, v161
v_mfma_f32_32x32x16_bf16 v[48:63], v[124:127], a[108:111], v[48:63]
ds_read_b128 v[116:119], v8 offset:17408
v_add_f32 v162, 1.0, v162
v_add_f32 v163, 1.0, v163
v_rcp_f32 v160, v160
s_waitcnt lgkmcnt(4)
v_mfma_f32_32x32x16_bf16 v[32:47], v[96:99], a[112:115], v[32:47]
ds_read_b128 v[120:123], v8 offset:18432
s_add_u32 m0, s90, 135168
s_add_u32 s91, s89, 98304
buffer_load_dwordx4 v8, s[40:43], s91 offen sc1 lds
v_rcp_f32 v161, v161
v_rcp_f32 v162, v162
v_mfma_f32_32x32x16_bf16 v[48:63], v[100:103], a[112:115], v[48:63]
ds_read_b128 v[124:127], v8 offset:19456
v_rcp_f32 v163, v163
v_mul_f32 v72, v72, v160
s_waitcnt lgkmcnt(4)
v_mfma_f32_32x32x16_bf16 v[32:47], v[104:107], a[116:119], v[32:47]
ds_read_b128 v[96:99], v8 offset:20480
s_add_u32 m0, s90, 139264
s_add_u32 s91, s89, 102400
buffer_load_dwordx4 v8, s[40:43], s91 offen sc1 lds
v_mul_f32 v73, v73, v161
v_mul_f32 v74, v74, v162
v_mul_f32 v75, v75, v163
v_mfma_f32_32x32x16_bf16 v[48:63], v[108:111], a[116:119], v[48:63]
ds_read_b128 v[100:103], v8 offset:21504
v_cvt_pk_bf16_f32 v172, v72, v73
v_cvt_pk_bf16_f32 v173, v74, v75
v_fma_f32 v148, v11, v144, v148
s_waitcnt lgkmcnt(4)
v_mfma_f32_32x32x16_bf16 v[32:47], v[112:115], a[120:123], v[32:47]
ds_read_b128 v[104:107], v8 offset:22528
s_add_u32 m0, s90, 143360
s_add_u32 s91, s89, 106496
buffer_load_dwordx4 v8, s[40:43], s91 offen sc1 lds
v_fma_f32 v156, v11, v152, v156
v_fma_f32 v149, v11, v145, v149
v_fma_f32 v157, v11, v153, v157
v_fma_f32 v150, v11, v146, v150
v_mfma_f32_32x32x16_bf16 v[48:63], v[116:119], a[120:123], v[48:63]
ds_read_b128 v[108:111], v8 offset:23552
v_fma_f32 v158, v11, v154, v158
v_fma_f32 v151, v11, v147, v151
v_fma_f32 v159, v11, v155, v159
s_waitcnt vmcnt(4)
s_add_u32 s72, s8, 7
v_subrev_u32 v5, s72, v5
v_cmp_lt_u32 vcc, 8, v5
s_nop 3
s_cbranch_vccnz L_slow_35
L_back_36:
s_waitcnt lgkmcnt(4)
v_mfma_f32_32x32x16_bf16 v[32:47], v[120:123], a[124:127], v[32:47]
ds_read_b128 v[112:115], v8 offset:24576
s_add_u32 m0, s90, 147456
s_add_u32 s91, s89, 110592
buffer_load_dwordx4 v8, s[40:43], s91 offen sc1 lds
v_fma_f32 v76, v10, v76, v148
v_fma_f32 v77, v10, v77, v149
v_fma_f32 v78, v10, v78, v150
v_fma_f32 v79, v10, v79, v151
v_mfma_f32_32x32x16_bf16 v[48:63], v[124:127], a[124:127], v[48:63]
ds_read_b128 v[116:119], v8 offset:25600
v_mul_f32 v160, v76, v76
v_mul_f32 v161, v77, v77
v_mul_f32 v162, v78, v78
s_waitcnt lgkmcnt(4)
v_mfma_f32_32x32x16_bf16 v[32:47], v[96:99], a[128:131], v[32:47]
ds_read_b128 v[120:123], v8 offset:26624
s_add_u32 s91, s82, 0
buffer_load_dwordx4 a[0:3], v8, s[40:43], s91 offen sc1
v_mul_f32 v163, v79, v79
v_fma_f32 v92, v10, v92, v156
v_fma_f32 v93, v10, v93, v157
v_mfma_f32_32x32x16_bf16 v[48:63], v[100:103], a[128:131], v[48:63]
ds_read_b128 v[124:127], v8 offset:27648
v_fma_f32 v94, v10, v94, v158
v_fma_f32 v95, v10, v95, v159
v_fmamk_f32 v160, v160, 0xbdd2d3e8, v20
v_fmamk_f32 v161, v161, 0xbdd2d3e8, v20
s_waitcnt lgkmcnt(4)
v_mfma_f32_32x32x16_bf16 v[32:47], v[104:107], a[132:135], v[32:47]
ds_read_b128 v[96:99], v8 offset:28672
s_add_u32 s91, s82, 3072
buffer_load_dwordx4 a[4:7], v8, s[40:43], s91 offen sc1
v_fmamk_f32 v162, v162, 0xbdd2d3e8, v20
v_fmamk_f32 v163, v163, 0xbdd2d3e8, v20
v_mul_f32 v160, v160, v76
v_mfma_f32_32x32x16_bf16 v[48:63], v[108:111], a[132:135], v[48:63]
ds_read_b128 v[100:103], v8 offset:29696
v_mul_f32 v161, v161, v77
v_mul_f32 v162, v162, v78
v_mul_f32 v163, v163, v79
v_exp_f32 v160, v160
s_waitcnt lgkmcnt(4)
v_mfma_f32_32x32x16_bf16 v[32:47], v[112:115], a[136:139], v[32:47]
ds_read_b128 v[104:107], v8 offset:30720
s_add_u32 s91, s82, 6144
buffer_load_dwordx4 a[8:11], v8, s[40:43], s91 offen sc1
v_exp_f32 v161, v161
v_mfma_f32_32x32x16_bf16 v[48:63], v[116:119], a[136:139], v[48:63]
ds_read_b128 v[108:111], v8 offset:31744
v_exp_f32 v162, v162
v_exp_f32 v163, v163
s_waitcnt lgkmcnt(4)
v_mfma_f32_32x32x16_bf16 v[32:47], v[120:123], a[140:143], v[32:47]
ds_read_b128 v[112:115], v8 offset:32768
s_add_u32 s91, s82, 9216
buffer_load_dwordx4 a[12:15], v8, s[40:43], s91 offen sc1
v_mul_f32 v76, v76, v92
v_mul_f32 v77, v77, v93
v_mul_f32 v78, v78, v94
v_mfma_f32_32x32x16_bf16 v[48:63], v[124:127], a[140:143], v[48:63]
ds_read_b128 v[116:119], v8 offset:33792
v_mul_f32 v79, v79, v95
v_add_f32 v160, 1.0, v160
v_add_f32 v161, 1.0, v161
s_waitcnt lgkmcnt(4)
v_mfma_f32_32x32x16_bf16 v[32:47], v[96:99], a[144:147], v[32:47]
ds_read_b128 v[120:123], v8 offset:34816
v_add_f32 v162, 1.0, v162
v_add_f32 v163, 1.0, v163
v_rcp_f32 v160, v160
v_mfma_f32_32x32x16_bf16 v[48:63], v[100:103], a[144:147], v[48:63]
ds_read_b128 v[124:127], v8 offset:35840
s_add_u32 s91, s82, 12288
buffer_load_dwordx4 a[16:19], v8, s[40:43], s91 offen sc1
v_rcp_f32 v161, v161
v_rcp_f32 v162, v162
s_waitcnt lgkmcnt(4)
v_mfma_f32_32x32x16_bf16 v[32:47], v[104:107], a[148:151], v[32:47]
v_rcp_f32 v163, v163
v_mfma_f32_32x32x16_bf16 v[48:63], v[108:111], a[148:151], v[48:63]
s_add_u32 s91, s82, 15360
buffer_load_dwordx4 a[20:23], v8, s[40:43], s91 offen sc1
v_mul_f32 v76, v76, v160
v_mul_f32 v77, v77, v161
v_mul_f32 v78, v78, v162
v_mul_f32 v79, v79, v163
s_waitcnt lgkmcnt(2)
v_mfma_f32_32x32x16_bf16 v[32:47], v[112:115], a[152:155], v[32:47]
v_cvt_pk_bf16_f32 v174, v76, v77
v_cvt_pk_bf16_f32 v175, v78, v79
s_nop 0
v_permlane32_swap_b32 v172, v174
v_mfma_f32_32x32x16_bf16 v[48:63], v[116:119], a[152:155], v[48:63]
v_permlane32_swap_b32 v173, v175
buffer_store_dwordx4 v[172:175], v19, s[40:43], s86 offen offset:1536 sc1
s_waitcnt lgkmcnt(0)
v_mfma_f32_32x32x16_bf16 v[32:47], v[120:123], a[156:159], v[32:47]
s_add_u32 s91, s82, 18432
buffer_load_dwordx4 a[24:27], v8, s[40:43], s91 offen sc1
v_mfma_f32_32x32x16_bf16 v[48:63], v[124:127], a[156:159], v[48:63]
s_barrier
s_waitcnt vmcnt(1)
s_add_u32 s72, s8, 8
v_mov_b32 v1, s72
s_mov_b64 exec, 1
buffer_store_dword v1, off, s[40:43], s10 sc1
s_mov_b64 exec, -1
ds_read_b128 v[128:131], v18 offset:256
ds_read_b128 v[132:135], v18 offset:640
ds_read_b128 v[136:139], v18 offset:1024
ds_read_b128 v[140:143], v18 offset:1408
ds_read_b128 v[144:147], v18 offset:288
ds_read_b128 v[148:151], v18 offset:672
ds_read_b128 v[152:155], v18 offset:1056
ds_read_b128 v[156:159], v18 offset:1440
s_waitcnt lgkmcnt(4)
v_pk_fma_f32 v[132:133], v[10:11], v[128:129], v[132:133] op_sel:[1,0,0]
v_pk_fma_f32 v[140:141], v[10:11], v[136:137], v[140:141] op_sel:[1,0,0]
v_pk_fma_f32 v[134:135], v[10:11], v[130:131], v[134:135] op_sel:[1,0,0]
v_pk_fma_f32 v[142:143], v[10:11], v[138:139], v[142:143] op_sel:[1,0,0]
v_pk_fma_f32 v[32:33], v[10:11], v[32:33], v[132:133] op_sel_hi:[0,1,1]
v_pk_fma_f32 v[34:35], v[10:11], v[34:35], v[134:135] op_sel_hi:[0,1,1]
v_pk_mul_f32 v[160:161], v[32:33], v[32:33]
v_pk_mul_f32 v[162:163], v[34:35], v[34:35]
v_pk_fma_f32 v[48:49], v[10:11], v[48:49], v[140:141] op_sel_hi:[0,1,1]
v_pk_fma_f32 v[50:51], v[10:11], v[50:51], v[142:143] op_sel_hi:[0,1,1]
v_pk_fma_f32 v[160:161], v[160:161], v[20:21], v[20:21] op_sel:[0,1,0] op_sel_hi:[1,1,0]
v_pk_fma_f32 v[162:163], v[162:163], v[20:21], v[20:21] op_sel:[0,1,0] op_sel_hi:[1,1,0]
v_pk_mul_f32 v[160:161], v[160:161], v[32:33]
v_pk_mul_f32 v[162:163], v[162:163], v[34:35]
v_exp_f32 v160, v160
v_exp_f32 v161, v161
v_exp_f32 v162, v162
v_exp_f32 v163, v163
v_pk_mul_f32 v[32:33], v[32:33], v[48:49]
v_pk_mul_f32 v[34:35], v[34:35], v[50:51]
v_pk_add_f32 v[160:161], v[160:161], v[22:23] op_sel_hi:[1,0]
v_pk_add_f32 v[162:163], v[162:163], v[22:23] op_sel_hi:[1,0]
v_rcp_f32 v160, v160
v_rcp_f32 v161, v161
v_rcp_f32 v162, v162
v_rcp_f32 v163, v163
v_pk_mul_f32 v[32:33], v[32:33], v[160:161]
v_pk_mul_f32 v[34:35], v[34:35], v[162:163]
v_cvt_pk_bf16_f32 v168, v32, v33
v_cvt_pk_bf16_f32 v169, v34, v35
s_add_u32 s91, s82, 21504
buffer_load_dwordx4 a[28:31], v8, s[40:43], s91 offen sc1
s_add_u32 s91, s82, 24576
buffer_load_dwordx4 a[32:35], v8, s[40:43], s91 offen sc1
s_add_u32 s91, s82, 27648
buffer_load_dwordx4 a[36:39], v8, s[40:43], s91 offen sc1
ds_read_b128 v[128:131], v18 offset:320
ds_read_b128 v[132:135], v18 offset:704
ds_read_b128 v[136:139], v18 offset:1088
ds_read_b128 v[140:143], v18 offset:1472
s_waitcnt lgkmcnt(4)
v_pk_fma_f32 v[148:149], v[10:11], v[144:145], v[148:149] op_sel:[1,0,0]
v_pk_fma_f32 v[156:157], v[10:11], v[152:153], v[156:157] op_sel:[1,0,0]
v_pk_fma_f32 v[150:151], v[10:11], v[146:147], v[150:151] op_sel:[1,0,0]
v_pk_fma_f32 v[158:159], v[10:11], v[154:155], v[158:159] op_sel:[1,0,0]
v_pk_fma_f32 v[36:37], v[10:11], v[36:37], v[148:149] op_sel_hi:[0,1,1]
v_pk_fma_f32 v[38:39], v[10:11], v[38:39], v[150:151] op_sel_hi:[0,1,1]
v_pk_mul_f32 v[160:161], v[36:37], v[36:37]
v_pk_mul_f32 v[162:163], v[38:39], v[38:39]
v_pk_fma_f32 v[52:53], v[10:11], v[52:53], v[156:157] op_sel_hi:[0,1,1]
v_pk_fma_f32 v[54:55], v[10:11], v[54:55], v[158:159] op_sel_hi:[0,1,1]
v_pk_fma_f32 v[160:161], v[160:161], v[20:21], v[20:21] op_sel:[0,1,0] op_sel_hi:[1,1,0]
v_pk_fma_f32 v[162:163], v[162:163], v[20:21], v[20:21] op_sel:[0,1,0] op_sel_hi:[1,1,0]
v_pk_mul_f32 v[160:161], v[160:161], v[36:37]
v_pk_mul_f32 v[162:163], v[162:163], v[38:39]
v_exp_f32 v160, v160
v_exp_f32 v161, v161
v_exp_f32 v162, v162
v_exp_f32 v163, v163
v_pk_mul_f32 v[36:37], v[36:37], v[52:53]
v_pk_mul_f32 v[38:39], v[38:39], v[54:55]
v_pk_add_f32 v[160:161], v[160:161], v[22:23] op_sel_hi:[1,0]
v_pk_add_f32 v[162:163], v[162:163], v[22:23] op_sel_hi:[1,0]
v_rcp_f32 v160, v160
v_rcp_f32 v161, v161
v_rcp_f32 v162, v162
v_rcp_f32 v163, v163
v_pk_mul_f32 v[36:37], v[36:37], v[160:161]
v_pk_mul_f32 v[38:39], v[38:39], v[162:163]
v_cvt_pk_bf16_f32 v170, v36, v37
v_cvt_pk_bf16_f32 v171, v38, v39
s_add_u32 s91, s82, 30720
buffer_load_dwordx4 a[40:43], v8, s[40:43], s91 offen sc1
s_add_u32 s91, s82, 33792
buffer_load_dwordx4 a[44:47], v8, s[40:43], s91 offen sc1
s_add_u32 s91, s82, 36864
buffer_load_dwordx4 a[48:51], v8, s[40:43], s91 offen sc1
v_permlane32_swap_b32 v168, v170
v_permlane32_swap_b32 v169, v171
buffer_store_dwordx4 v[168:171], v19, s[40:43], s86 offen offset:2048 sc1
ds_read_b128 v[144:147], v18 offset:352
ds_read_b128 v[148:151], v18 offset:736
ds_read_b128 v[152:155], v18 offset:1120
ds_read_b128 v[156:159], v18 offset:1504
s_waitcnt lgkmcnt(4)
v_pk_fma_f32 v[132:133], v[10:11], v[128:129], v[132:133] op_sel:[1,0,0]
v_pk_fma_f32 v[140:141], v[10:11], v[136:137], v[140:141] op_sel:[1,0,0]
v_pk_fma_f32 v[134:135], v[10:11], v[130:131], v[134:135] op_sel:[1,0,0]
v_pk_fma_f32 v[142:143], v[10:11], v[138:139], v[142:143] op_sel:[1,0,0]
v_pk_fma_f32 v[40:41], v[10:11], v[40:41], v[132:133] op_sel_hi:[0,1,1]
v_pk_fma_f32 v[42:43], v[10:11], v[42:43], v[134:135] op_sel_hi:[0,1,1]
v_pk_mul_f32 v[160:161], v[40:41], v[40:41]
v_pk_mul_f32 v[162:163], v[42:43], v[42:43]
v_pk_fma_f32 v[56:57], v[10:11], v[56:57], v[140:141] op_sel_hi:[0,1,1]
v_pk_fma_f32 v[58:59], v[10:11], v[58:59], v[142:143] op_sel_hi:[0,1,1]
v_pk_fma_f32 v[160:161], v[160:161], v[20:21], v[20:21] op_sel:[0,1,0] op_sel_hi:[1,1,0]
v_pk_fma_f32 v[162:163], v[162:163], v[20:21], v[20:21] op_sel:[0,1,0] op_sel_hi:[1,1,0]
v_pk_mul_f32 v[160:161], v[160:161], v[40:41]
v_pk_mul_f32 v[162:163], v[162:163], v[42:43]
v_exp_f32 v160, v160
v_exp_f32 v161, v161
v_exp_f32 v162, v162
v_exp_f32 v163, v163
v_pk_mul_f32 v[40:41], v[40:41], v[56:57]
v_pk_mul_f32 v[42:43], v[42:43], v[58:59]
v_pk_add_f32 v[160:161], v[160:161], v[22:23] op_sel_hi:[1,0]
v_pk_add_f32 v[162:163], v[162:163], v[22:23] op_sel_hi:[1,0]
v_rcp_f32 v160, v160
v_rcp_f32 v161, v161
v_rcp_f32 v162, v162
v_rcp_f32 v163, v163
v_pk_mul_f32 v[40:41], v[40:41], v[160:161]
v_pk_mul_f32 v[42:43], v[42:43], v[162:163]
v_cvt_pk_bf16_f32 v172, v40, v41
v_cvt_pk_bf16_f32 v173, v42, v43
s_add_u32 s91, s82, 39936
buffer_load_dwordx4 a[52:55], v8, s[40:43], s91 offen sc1
s_add_u32 s91, s82, 43008
buffer_load_dwordx4 a[56:59], v8, s[40:43], s91 offen sc1
s_add_u32 s91, s82, 46080
buffer_load_dwordx4 a[60:63], v8, s[40:43], s91 offen sc1
s_waitcnt lgkmcnt(0)
v_pk_fma_f32 v[148:149], v[10:11], v[144:145], v[148:149] op_sel:[1,0,0]
v_pk_fma_f32 v[156:157], v[10:11], v[152:153], v[156:157] op_sel:[1,0,0]
v_pk_fma_f32 v[150:151], v[10:11], v[146:147], v[150:151] op_sel:[1,0,0]
v_pk_fma_f32 v[158:159], v[10:11], v[154:155], v[158:159] op_sel:[1,0,0]
v_pk_fma_f32 v[44:45], v[10:11], v[44:45], v[148:149] op_sel_hi:[0,1,1]
v_pk_fma_f32 v[46:47], v[10:11], v[46:47], v[150:151] op_sel_hi:[0,1,1]
v_pk_mul_f32 v[160:161], v[44:45], v[44:45]
v_pk_mul_f32 v[162:163], v[46:47], v[46:47]
v_pk_fma_f32 v[60:61], v[10:11], v[60:61], v[156:157] op_sel_hi:[0,1,1]
v_pk_fma_f32 v[62:63], v[10:11], v[62:63], v[158:159] op_sel_hi:[0,1,1]
v_pk_fma_f32 v[160:161], v[160:161], v[20:21], v[20:21] op_sel:[0,1,0] op_sel_hi:[1,1,0]
v_pk_fma_f32 v[162:163], v[162:163], v[20:21], v[20:21] op_sel:[0,1,0] op_sel_hi:[1,1,0]
v_pk_mul_f32 v[160:161], v[160:161], v[44:45]
v_pk_mul_f32 v[162:163], v[162:163], v[46:47]
v_exp_f32 v160, v160
v_exp_f32 v161, v161
v_exp_f32 v162, v162
v_exp_f32 v163, v163
v_pk_mul_f32 v[44:45], v[44:45], v[60:61]
v_pk_mul_f32 v[46:47], v[46:47], v[62:63]
v_pk_add_f32 v[160:161], v[160:161], v[22:23] op_sel_hi:[1,0]
v_pk_add_f32 v[162:163], v[162:163], v[22:23] op_sel_hi:[1,0]
v_rcp_f32 v160, v160
v_rcp_f32 v161, v161
v_rcp_f32 v162, v162
v_rcp_f32 v163, v163
v_pk_mul_f32 v[44:45], v[44:45], v[160:161]
v_pk_mul_f32 v[46:47], v[46:47], v[162:163]
v_cvt_pk_bf16_f32 v174, v44, v45
v_cvt_pk_bf16_f32 v175, v46, v47
s_nop 0
v_permlane32_swap_b32 v172, v174
v_permlane32_swap_b32 v173, v175
buffer_store_dwordx4 v[172:175], v19, s[40:43], s86 offen offset:2560 sc1
buffer_load_dword v5, v31, s[40:43], 0 offen sc1
L_p4:
ds_read_b128 v[64:67], v8 offset:36864
ds_read_b128 v[68:71], v8 offset:37888
ds_read_b128 v[72:75], v8 offset:38912
ds_read_b128 v[76:79], v8 offset:39936
ds_read_b128 v[80:83], v8 offset:40960
ds_read_b128 v[84:87], v8 offset:41984
ds_read_b128 v[88:91], v8 offset:43008
ds_read_b128 v[92:95], v8 offset:44032
ds_read_b128 v[96:99], v8 offset:45056
v_lshrrev_b32 v3, 4, v0
v_lshlrev_b32 v4, 4, v3
v_add_u32 v4, 160384, v4
ds_read_b128 v[112:115], v4 offset:0
ds_read_b128 v[116:119], v4 offset:64
ds_read_b128 v[120:123], v4 offset:128
ds_read_b128 v[124:127], v4 offset:192
ds_read_b128 v[128:131], v4 offset:256
s_mov_b32 s11, 0xffff0000
v_accvgpr_read_b32 v1, a240
v_lshlrev_b32 v136, 16, v1
v_and_b32 v137, s11, v1
v_accvgpr_read_b32 v1, a241
v_lshlrev_b32 v138, 16, v1
v_and_b32 v139, s11, v1
v_accvgpr_read_b32 v1, a242
v_lshlrev_b32 v140, 16, v1
v_and_b32 v141, s11, v1
v_accvgpr_read_b32 v1, a243
v_lshlrev_b32 v142, 16, v1
v_and_b32 v143, s11, v1
v_accvgpr_read_b32 v1, a244
v_lshlrev_b32 v144, 16, v1
v_and_b32 v145, s11, v1
v_accvgpr_read_b32 v1, a245
v_lshlrev_b32 v146, 16, v1
v_and_b32 v147, s11, v1
v_accvgpr_read_b32 v1, a246
v_lshlrev_b32 v148, 16, v1
v_and_b32 v149, s11, v1
v_accvgpr_read_b32 v1, a247
v_lshlrev_b32 v150, 16, v1
v_and_b32 v151, s11, v1
v_accvgpr_read_b32 v1, a248
v_lshlrev_b32 v152, 16, v1
v_and_b32 v153, s11, v1
v_accvgpr_read_b32 v1, a249
v_lshlrev_b32 v154, 16, v1
v_and_b32 v155, s11, v1
s_mov_b32 s44, s34
s_mov_b32 s45, s35
s_mov_b32 s46, 2621440
s_mov_b32 s47, 0x20000
v_and_b32 v2, 15, v0
v_and_b32 v7, 1, v3
v_lshlrev_b32 v7, 1, v7
v_lshrrev_b32 v6, 1, v3
v_add_u32 v7, v7, v6
v_lshlrev_b32 v7, 4, v7
v_mul_u32_u24 v6, 1280, v2
v_add_u32 v7, v7, v6
s_and_b32 s80, s5, 7
s_lshl_b32 s81, s87, 4
s_mul_i32 s81, s81, 1280
s_mul_i32 s12, s80, 160
s_add_u32 s81, s81, s12
s_waitcnt lgkmcnt(13)
v_mfma_f32_16x16x32_bf16 v[32:35], v[64:67], a[0:3], 0
ds_read_b128 v[100:103], v8 offset:46080
s_waitcnt lgkmcnt(13)
v_mfma_f32_16x16x32_bf16 v[36:39], v[68:71], a[0:3], 0
ds_read_b128 v[64:67], v8 offset:47104
s_add_u32 m0, s90, 151552
s_add_u32 s91, s89, 114688
buffer_load_dwordx4 v8, s[40:43], s91 offen sc1 lds
s_waitcnt lgkmcnt(13)
v_mfma_f32_16x16x32_bf16 v[40:43], v[72:75], a[0:3], 0
ds_read_b128 v[68:71], v8 offset:48128
s_waitcnt lgkmcnt(13)
v_mfma_f32_16x16x32_bf16 v[44:47], v[76:79], a[0:3], 0
ds_read_b128 v[72:75], v8 offset:49152
s_waitcnt lgkmcnt(13)
v_mfma_f32_16x16x32_bf16 v[48:51], v[80:83], a[0:3], 0
ds_read_b128 v[76:79], v8 offset:50176
s_waitcnt lgkmcnt(13)
v_mfma_f32_16x16x32_bf16 v[32:35], v[84:87], a[4:7], v[32:35]
ds_read_b128 v[80:83], v8 offset:51200
s_waitcnt lgkmcnt(13)
v_mfma_f32_16x16x32_bf16 v[36:39], v[88:91], a[4:7], v[36:39]
ds_read_b128 v[84:87], v8 offset:52224
s_add_u32 m0, s90, 0
s_add_u32 s91, s89, 118784
buffer_load_dwordx4 v8, s[40:43], s91 offen sc1 lds
s_waitcnt lgkmcnt(13)
v_mfma_f32_16x16x32_bf16 v[40:43], v[92:95], a[4:7], v[40:43]
ds_read_b128 v[88:91], v8 offset:53248
s_waitcnt lgkmcnt(13)
v_mfma_f32_16x16x32_bf16 v[44:47], v[96:99], a[4:7], v[44:47]
ds_read_b128 v[92:95], v8 offset:54272
s_waitcnt lgkmcnt(8)
v_mfma_f32_16x16x32_bf16 v[48:51], v[100:103], a[4:7], v[48:51]
ds_read_b128 v[96:99], v8 offset:55296
s_waitcnt lgkmcnt(8)
v_mfma_f32_16x16x32_bf16 v[32:35], v[64:67], a[8:11], v[32:35]
ds_read_b128 v[100:103], v8 offset:56320
s_waitcnt lgkmcnt(8)
v_mfma_f32_16x16x32_bf16 v[36:39], v[68:71], a[8:11], v[36:39]
ds_read_b128 v[64:67], v8 offset:57344
s_add_u32 m0, s90, 4096
s_add_u32 s91, s89, 122880
buffer_load_dwordx4 v8, s[40:43], s91 offen sc1 lds
s_waitcnt lgkmcnt(8)
v_mfma_f32_16x16x32_bf16 v[40:43], v[72:75], a[8:11], v[40:43]
ds_read_b128 v[68:71], v8 offset:58368
s_waitcnt lgkmcnt(8)
v_mfma_f32_16x16x32_bf16 v[44:47], v[76:79], a[8:11], v[44:47]
ds_read_b128 v[72:75], v8 offset:59392
s_waitcnt lgkmcnt(8)
v_mfma_f32_16x16x32_bf16 v[48:51], v[80:83], a[8:11], v[48:51]
ds_read_b128 v[76:79], v8 offset:60416
s_waitcnt vmcnt(3)
s_add_u32 s72, s8, 8
v_subrev_u32 v5, s72, v5
v_cmp_lt_u32 vcc, 7, v5
s_nop 3
s_cbranch_vccnz L_slow_37
L_back_38:
s_waitcnt lgkmcnt(8)
v_mfma_f32_16x16x32_bf16 v[32:35], v[84:87], a[12:15], v[32:35]
ds_read_b128 v[80:83], v8 offset:61440
s_waitcnt lgkmcnt(8)
v_mfma_f32_16x16x32_bf16 v[36:39], v[88:91], a[12:15], v[36:39]
ds_read_b128 v[84:87], v8 offset:62464
s_add_u32 s91, s82, 1024
buffer_load_dwordx4 a[64:67], v8, s[40:43], s91 offen sc1
s_waitcnt lgkmcnt(8)
v_mfma_f32_16x16x32_bf16 v[40:43], v[92:95], a[12:15], v[40:43]
ds_read_b128 v[88:91], v8 offset:63488
s_waitcnt lgkmcnt(8)
v_mfma_f32_16x16x32_bf16 v[44:47], v[96:99], a[12:15], v[44:47]
ds_read_b128 v[92:95], v8 offset:64512
s_add_u32 s91, s82, 4096
buffer_load_dwordx4 a[68:71], v8, s[40:43], s91 offen sc1
s_waitcnt lgkmcnt(8)
v_mfma_f32_16x16x32_bf16 v[48:51], v[100:103], a[12:15], v[48:51]
ds_read_b128 v[96:99], v16 offset:0
s_waitcnt lgkmcnt(8)
v_mfma_f32_16x16x32_bf16 v[32:35], v[64:67], a[16:19], v[32:35]
ds_read_b128 v[100:103], v16 offset:1024
s_waitcnt lgkmcnt(8)
v_mfma_f32_16x16x32_bf16 v[36:39], v[68:71], a[16:19], v[36:39]
ds_read_b128 v[64:67], v16 offset:2048
s_add_u32 m0, s90, 8192
s_add_u32 s91, s89, 126976
buffer_load_dwordx4 v8, s[40:43], s91 offen sc1 lds
s_waitcnt lgkmcnt(8)
v_mfma_f32_16x16x32_bf16 v[40:43], v[72:75], a[16:19], v[40:43]
ds_read_b128 v[68:71], v16 offset:3072
s_waitcnt lgkmcnt(8)
v_mfma_f32_16x16x32_bf16 v[44:47], v[76:79], a[16:19], v[44:47]
ds_read_b128 v[72:75], v16 offset:4096
s_add_u32 s91, s82, 7168
buffer_load_dwordx4 a[72:75], v8, s[40:43], s91 offen sc1
s_waitcnt lgkmcnt(8)
v_mfma_f32_16x16x32_bf16 v[48:51], v[80:83], a[16:19], v[48:51]
ds_read_b128 v[76:79], v16 offset:5120
s_waitcnt lgkmcnt(8)
v_mfma_f32_16x16x32_bf16 v[32:35], v[84:87], a[20:23], v[32:35]
ds_read_b128 v[80:83], v16 offset:6144
s_waitcnt lgkmcnt(8)
v_mfma_f32_16x16x32_bf16 v[36:39], v[88:91], a[20:23], v[36:39]
ds_read_b128 v[84:87], v16 offset:7168
s_add_u32 s91, s82, 10240
buffer_load_dwordx4 a[76:79], v8, s[40:43], s91 offen sc1
s_waitcnt lgkmcnt(8)
v_mfma_f32_16x16x32_bf16 v[40:43], v[92:95], a[20:23], v[40:43]
ds_read_b128 v[88:91], v16 offset:8192
s_waitcnt lgkmcnt(8)
v_mfma_f32_16x16x32_bf16 v[44:47], v[96:99], a[20:23], v[44:47]
ds_read_b128 v[92:95], v16 offset:9216
s_add_u32 m0, s90, 12288
s_add_u32 s91, s89, 131072
buffer_load_dwordx4 v8, s[40:43], s91 offen sc1 lds
s_waitcnt lgkmcnt(8)
v_mfma_f32_16x16x32_bf16 v[48:51], v[100:103], a[20:23], v[48:51]
ds_read_b128 v[96:99], v16 offset:10240
s_waitcnt lgkmcnt(8)
v_mfma_f32_16x16x32_bf16 v[32:35], v[64:67], a[24:27], v[32:35]
ds_read_b128 v[100:103], v16 offset:11264
s_waitcnt lgkmcnt(8)
v_mfma_f32_16x16x32_bf16 v[36:39], v[68:71], a[24:27], v[36:39]
ds_read_b128 v[64:67], v16 offset:12288
s_add_u32 s91, s82, 13312
buffer_load_dwordx4 a[80:83], v8, s[40:43], s91 offen sc1
s_waitcnt lgkmcnt(8)
v_mfma_f32_16x16x32_bf16 v[40:43], v[72:75], a[24:27], v[40:43]
ds_read_b128 v[68:71], v16 offset:13312
s_waitcnt lgkmcnt(8)
v_mfma_f32_16x16x32_bf16 v[44:47], v[76:79], a[24:27], v[44:47]
ds_read_b128 v[72:75], v16 offset:14336
s_add_u32 s91, s82, 16384
buffer_load_dwordx4 a[84:87], v8, s[40:43], s91 offen sc1
s_waitcnt lgkmcnt(8)
v_mfma_f32_16x16x32_bf16 v[48:51], v[80:83], a[24:27], v[48:51]
ds_read_b128 v[76:79], v16 offset:15360
s_waitcnt lgkmcnt(8)
v_mfma_f32_16x16x32_bf16 v[32:35], v[84:87], a[28:31], v[32:35]
ds_read_b128 v[80:83], v16 offset:16384
s_waitcnt lgkmcnt(8)
v_mfma_f32_16x16x32_bf16 v[36:39], v[88:91], a[28:31], v[36:39]
ds_read_b128 v[84:87], v16 offset:17408
s_add_u32 m0, s90, 16384
s_add_u32 s91, s89, 135168
buffer_load_dwordx4 v8, s[40:43], s91 offen sc1 lds
s_waitcnt lgkmcnt(8)
v_mfma_f32_16x16x32_bf16 v[40:43], v[92:95], a[28:31], v[40:43]
ds_read_b128 v[88:91], v16 offset:18432
s_waitcnt lgkmcnt(8)
v_mfma_f32_16x16x32_bf16 v[44:47], v[96:99], a[28:31], v[44:47]
ds_read_b128 v[92:95], v16 offset:19456
s_add_u32 s91, s82, 19456
buffer_load_dwordx4 a[88:91], v8, s[40:43], s91 offen sc1
s_waitcnt lgkmcnt(8)
v_mfma_f32_16x16x32_bf16 v[48:51], v[100:103], a[28:31], v[48:51]
ds_read_b128 v[96:99], v16 offset:20480
s_barrier
s_waitcnt lgkmcnt(8)
v_mfma_f32_16x16x32_bf16 v[32:35], v[64:67], a[32:35], v[32:35]
ds_read_b128 v[100:103], v16 offset:21504
s_waitcnt lgkmcnt(8)
v_mfma_f32_16x16x32_bf16 v[36:39], v[68:71], a[32:35], v[36:39]
ds_read_b128 v[64:67], v16 offset:22528
s_add_u32 s91, s82, 22528
buffer_load_dwordx4 a[92:95], v8, s[40:43], s91 offen sc1
s_waitcnt lgkmcnt(8)
v_mfma_f32_16x16x32_bf16 v[40:43], v[72:75], a[32:35], v[40:43]
ds_read_b128 v[68:71], v16 offset:23552
s_waitcnt lgkmcnt(8)
v_mfma_f32_16x16x32_bf16 v[44:47], v[76:79], a[32:35], v[44:47]
ds_read_b128 v[72:75], v16 offset:24576
s_add_u32 m0, s90, 20480
s_add_u32 s91, s89, 139264
buffer_load_dwordx4 v8, s[40:43], s91 offen sc1 lds
s_waitcnt lgkmcnt(8)
v_mfma_f32_16x16x32_bf16 v[48:51], v[80:83], a[32:35], v[48:51]
ds_read_b128 v[76:79], v16 offset:25600
s_add_u32 s72, s8, 9
v_mov_b32 v1, s72
s_mov_b64 exec, 1
buffer_store_dword v1, off, s[40:43], s10 sc1
s_mov_b64 exec, -1
s_waitcnt lgkmcnt(8)
v_mfma_f32_16x16x32_bf16 v[32:35], v[84:87], a[36:39], v[32:35]
ds_read_b128 v[80:83], v16 offset:26624
s_waitcnt lgkmcnt(8)
v_mfma_f32_16x16x32_bf16 v[36:39], v[88:91], a[36:39], v[36:39]
ds_read_b128 v[84:87], v16 offset:27648
s_add_u32 s91, s82, 25600
buffer_load_dwordx4 a[96:99], v8, s[40:43], s91 offen sc1
s_waitcnt lgkmcnt(8)
v_mfma_f32_16x16x32_bf16 v[40:43], v[92:95], a[36:39], v[40:43]
ds_read_b128 v[88:91], v16 offset:28672
s_waitcnt lgkmcnt(8)
v_mfma_f32_16x16x32_bf16 v[44:47], v[96:99], a[36:39], v[44:47]
ds_read_b128 v[92:95], v16 offset:29696
s_add_u32 s91, s82, 28672
buffer_load_dwordx4 a[100:103], v8, s[40:43], s91 offen sc1
s_waitcnt lgkmcnt(8)
v_mfma_f32_16x16x32_bf16 v[48:51], v[100:103], a[36:39], v[48:51]
ds_read_b128 v[96:99], v16 offset:30720
s_waitcnt lgkmcnt(8)
v_mfma_f32_16x16x32_bf16 v[32:35], v[64:67], a[40:43], v[32:35]
ds_read_b128 v[100:103], v16 offset:31744
s_waitcnt lgkmcnt(8)
v_mfma_f32_16x16x32_bf16 v[36:39], v[68:71], a[40:43], v[36:39]
ds_read_b128 v[64:67], v16 offset:32768
s_add_u32 m0, s90, 24576
s_add_u32 s91, s89, 143360
buffer_load_dwordx4 v8, s[40:43], s91 offen sc1 lds
s_waitcnt lgkmcnt(8)
v_mfma_f32_16x16x32_bf16 v[40:43], v[72:75], a[40:43], v[40:43]
ds_read_b128 v[68:71], v16 offset:33792
s_waitcnt lgkmcnt(8)
v_mfma_f32_16x16x32_bf16 v[44:47], v[76:79], a[40:43], v[44:47]
ds_read_b128 v[72:75], v16 offset:34816
s_add_u32 s91, s82, 31744
buffer_load_dwordx4 a[104:107], v8, s[40:43], s91 offen sc1
s_waitcnt lgkmcnt(8)
v_mfma_f32_16x16x32_bf16 v[48:51], v[80:83], a[40:43], v[48:51]
ds_read_b128 v[76:79], v16 offset:35840
s_waitcnt lgkmcnt(8)
v_mfma_f32_16x16x32_bf16 v[32:35], v[84:87], a[44:47], v[32:35]
ds_read_b128 v[80:83], v16 offset:36864
s_waitcnt lgkmcnt(8)
v_mfma_f32_16x16x32_bf16 v[36:39], v[88:91], a[44:47], v[36:39]
ds_read_b128 v[84:87], v16 offset:37888
s_add_u32 s91, s82, 34816
buffer_load_dwordx4 a[108:111], v8, s[40:43], s91 offen sc1
s_waitcnt lgkmcnt(8)
v_mfma_f32_16x16x32_bf16 v[40:43], v[92:95], a[44:47], v[40:43]
ds_read_b128 v[88:91], v16 offset:38912
s_waitcnt lgkmcnt(8)
v_mfma_f32_16x16x32_bf16 v[44:47], v[96:99], a[44:47], v[44:47]
ds_read_b128 v[92:95], v16 offset:39936
s_add_u32 m0, s90, 28672
s_add_u32 s91, s89, 147456
buffer_load_dwordx4 v8, s[40:43], s91 offen sc1 lds
s_waitcnt lgkmcnt(8)
v_mfma_f32_16x16x32_bf16 v[48:51], v[100:103], a[44:47], v[48:51]
ds_read_b128 v[96:99], v16 offset:40960
s_waitcnt lgkmcnt(8)
v_mfma_f32_16x16x32_bf16 v[32:35], v[64:67], a[48:51], v[32:35]
ds_read_b128 v[100:103], v16 offset:41984
s_waitcnt lgkmcnt(8)
v_mfma_f32_16x16x32_bf16 v[36:39], v[68:71], a[48:51], v[36:39]
ds_read_b128 v[64:67], v16 offset:43008
s_add_u32 s91, s82, 37888
buffer_load_dwordx4 a[112:115], v8, s[40:43], s91 offen sc1
s_waitcnt lgkmcnt(8)
v_mfma_f32_16x16x32_bf16 v[40:43], v[72:75], a[48:51], v[40:43]
ds_read_b128 v[68:71], v16 offset:44032
s_waitcnt lgkmcnt(8)
v_mfma_f32_16x16x32_bf16 v[44:47], v[76:79], a[48:51], v[44:47]
ds_read_b128 v[72:75], v16 offset:45056
s_add_u32 s91, s82, 40960
buffer_load_dwordx4 a[116:119], v8, s[40:43], s91 offen sc1
s_waitcnt lgkmcnt(8)
v_mfma_f32_16x16x32_bf16 v[48:51], v[80:83], a[48:51], v[48:51]
ds_read_b128 v[76:79], v16 offset:46080
s_waitcnt lgkmcnt(8)
v_mfma_f32_16x16x32_bf16 v[32:35], v[84:87], a[52:55], v[32:35]
ds_read_b128 v[80:83], v16 offset:47104
s_waitcnt lgkmcnt(8)
v_mfma_f32_16x16x32_bf16 v[36:39], v[88:91], a[52:55], v[36:39]
ds_read_b128 v[84:87], v16 offset:48128
s_add_u32 m0, s90, 32768
s_add_u32 s91, s89, 151552
buffer_load_dwordx4 v8, s[40:43], s91 offen sc1 lds
s_waitcnt lgkmcnt(8)
v_mfma_f32_16x16x32_bf16 v[40:43], v[92:95], a[52:55], v[40:43]
ds_read_b128 v[88:91], v16 offset:49152
s_waitcnt lgkmcnt(8)
v_mfma_f32_16x16x32_bf16 v[44:47], v[96:99], a[52:55], v[44:47]
ds_read_b128 v[92:95], v16 offset:50176
s_add_u32 s91, s82, 44032
buffer_load_dwordx4 a[120:123], v8, s[40:43], s91 offen sc1
s_waitcnt lgkmcnt(8)
v_mfma_f32_16x16x32_bf16 v[48:51], v[100:103], a[52:55], v[48:51]
ds_read_b128 v[96:99], v16 offset:51200
s_waitcnt lgkmcnt(8)
v_mfma_f32_16x16x32_bf16 v[32:35], v[64:67], a[56:59], v[32:35]
ds_read_b128 v[100:103], v16 offset:52224
s_waitcnt lgkmcnt(8)
v_mfma_f32_16x16x32_bf16 v[36:39], v[68:71], a[56:59], v[36:39]
ds_read_b128 v[64:67], v16 offset:53248
s_add_u32 s91, s82, 47104
buffer_load_dwordx4 a[124:127], v8, s[40:43], s91 offen sc1
s_waitcnt lgkmcnt(8)
v_mfma_f32_16x16x32_bf16 v[40:43], v[72:75], a[56:59], v[40:43]
ds_read_b128 v[68:71], v16 offset:54272
s_waitcnt lgkmcnt(8)
v_mfma_f32_16x16x32_bf16 v[44:47], v[76:79], a[56:59], v[44:47]
ds_read_b128 v[72:75], v16 offset:55296
s_add_u32 m0, s90, 36864
s_add_u32 s91, s89, 155648
buffer_load_dwordx4 v8, s[40:43], s91 offen sc1 lds
s_waitcnt lgkmcnt(8)
v_mfma_f32_16x16x32_bf16 v[48:51], v[80:83], a[56:59], v[48:51]
ds_read_b128 v[76:79], v16 offset:56320
s_waitcnt lgkmcnt(8)
v_mfma_f32_16x16x32_bf16 v[32:35], v[84:87], a[60:63], v[32:35]
ds_read_b128 v[80:83], v16 offset:57344
s_waitcnt lgkmcnt(8)
v_mfma_f32_16x16x32_bf16 v[36:39], v[88:91], a[60:63], v[36:39]
ds_read_b128 v[84:87], v16 offset:58368
s_add_u32 m0, s90, 40960
s_add_u32 s91, s89, 159744
buffer_load_dwordx4 v8, s[40:43], s91 offen sc1 lds
s_waitcnt lgkmcnt(8)
v_mfma_f32_16x16x32_bf16 v[40:43], v[92:95], a[60:63], v[40:43]
ds_read_b128 v[88:91], v16 offset:59392
s_waitcnt lgkmcnt(8)
v_mfma_f32_16x16x32_bf16 v[44:47], v[96:99], a[60:63], v[44:47]
ds_read_b128 v[92:95], v16 offset:60416
s_add_u32 m0, s90, 45056
s_add_u32 s91, s89, 163840
buffer_load_dwordx4 v8, s[40:43], s91 offen sc1 lds
s_waitcnt lgkmcnt(8)
v_mfma_f32_16x16x32_bf16 v[48:51], v[100:103], a[60:63], v[48:51]
ds_read_b128 v[96:99], v16 offset:61440
s_waitcnt vmcnt(25)
s_waitcnt lgkmcnt(8)
v_mfma_f32_16x16x32_bf16 v[32:35], v[64:67], a[64:67], v[32:35]
ds_read_b128 v[100:103], v16 offset:62464
s_waitcnt lgkmcnt(8)
v_mfma_f32_16x16x32_bf16 v[36:39], v[68:71], a[64:67], v[36:39]
ds_read_b128 v[64:67], v16 offset:63488
s_add_u32 m0, s90, 49152
s_add_u32 s91, s89, 167936
buffer_load_dwordx4 v8, s[40:43], s91 offen sc1 lds
s_waitcnt lgkmcnt(8)
v_mfma_f32_16x16x32_bf16 v[40:43], v[72:75], a[64:67], v[40:43]
ds_read_b128 v[68:71], v16 offset:64512
s_waitcnt lgkmcnt(8)
v_mfma_f32_16x16x32_bf16 v[44:47], v[76:79], a[64:67], v[44:47]
ds_read_b128 v[72:75], v17 offset:0
s_add_u32 m0, s90, 53248
s_add_u32 s91, s89, 172032
buffer_load_dwordx4 v8, s[40:43], s91 offen sc1 lds
s_waitcnt lgkmcnt(8)
v_mfma_f32_16x16x32_bf16 v[48:51], v[80:83], a[64:67], v[48:51]
ds_read_b128 v[76:79], v17 offset:1024
s_waitcnt vmcnt(26)
s_waitcnt lgkmcnt(8)
v_mfma_f32_16x16x32_bf16 v[32:35], v[84:87], a[68:71], v[32:35]
ds_read_b128 v[80:83], v17 offset:2048
s_waitcnt lgkmcnt(8)
v_mfma_f32_16x16x32_bf16 v[36:39], v[88:91], a[68:71], v[36:39]
ds_read_b128 v[84:87], v17 offset:3072
s_add_u32 m0, s90, 57344
s_add_u32 s91, s89, 176128
buffer_load_dwordx4 v8, s[40:43], s91 offen sc1 lds
s_waitcnt lgkmcnt(8)
v_mfma_f32_16x16x32_bf16 v[40:43], v[92:95], a[68:71], v[40:43]
ds_read_b128 v[88:91], v17 offset:4096
s_waitcnt lgkmcnt(8)
v_mfma_f32_16x16x32_bf16 v[44:47], v[96:99], a[68:71], v[44:47]
ds_read_b128 v[92:95], v17 offset:5120
s_add_u32 m0, s90, 61440
s_add_u32 s91, s89, 180224
buffer_load_dwordx4 v8, s[40:43], s91 offen sc1 lds
s_waitcnt lgkmcnt(8)
v_mfma_f32_16x16x32_bf16 v[48:51], v[100:103], a[68:71], v[48:51]
ds_read_b128 v[96:99], v17 offset:6144
s_waitcnt vmcnt(9)
s_barrier
s_waitcnt lgkmcnt(8)
v_mfma_f32_16x16x32_bf16 v[32:35], v[64:67], a[72:75], v[32:35]
ds_read_b128 v[100:103], v17 offset:7168
s_waitcnt lgkmcnt(8)
v_mfma_f32_16x16x32_bf16 v[36:39], v[68:71], a[72:75], v[36:39]
ds_read_b128 v[64:67], v17 offset:8192
s_add_u32 m0, s90, 65536
s_add_u32 s91, s89, 184320
buffer_load_dwordx4 v8, s[40:43], s91 offen sc1 lds
s_waitcnt lgkmcnt(8)
v_mfma_f32_16x16x32_bf16 v[40:43], v[72:75], a[72:75], v[40:43]
ds_read_b128 v[68:71], v17 offset:9216
s_waitcnt lgkmcnt(8)
v_mfma_f32_16x16x32_bf16 v[44:47], v[76:79], a[72:75], v[44:47]
ds_read_b128 v[72:75], v17 offset:10240
s_add_u32 m0, s90, 69632
s_add_u32 s91, s89, 188416
buffer_load_dwordx4 v8, s[40:43], s91 offen sc1 lds
s_waitcnt lgkmcnt(8)
v_mfma_f32_16x16x32_bf16 v[48:51], v[80:83], a[72:75], v[48:51]
ds_read_b128 v[76:79], v17 offset:11264
s_waitcnt lgkmcnt(8)
v_mfma_f32_16x16x32_bf16 v[32:35], v[84:87], a[76:79], v[32:35]
ds_read_b128 v[80:83], v17 offset:12288
s_waitcnt lgkmcnt(8)
v_mfma_f32_16x16x32_bf16 v[36:39], v[88:91], a[76:79], v[36:39]
ds_read_b128 v[84:87], v17 offset:13312
s_add_u32 m0, s90, 73728
s_add_u32 s91, s89, 192512
buffer_load_dwordx4 v8, s[40:43], s91 offen sc1 lds
s_waitcnt lgkmcnt(8)
v_mfma_f32_16x16x32_bf16 v[40:43], v[92:95], a[76:79], v[40:43]
ds_read_b128 v[88:91], v17 offset:14336
s_waitcnt lgkmcnt(8)
v_mfma_f32_16x16x32_bf16 v[44:47], v[96:99], a[76:79], v[44:47]
ds_read_b128 v[92:95], v17 offset:15360
s_add_u32 m0, s90, 77824
s_add_u32 s91, s89, 196608
buffer_load_dwordx4 v8, s[40:43], s91 offen sc1 lds
s_waitcnt lgkmcnt(8)
v_mfma_f32_16x16x32_bf16 v[48:51], v[100:103], a[76:79], v[48:51]
ds_read_b128 v[96:99], v17 offset:16384
buffer_load_dword v5, v31, s[40:43], 0 offen sc1
s_waitcnt lgkmcnt(8)
v_mfma_f32_16x16x32_bf16 v[32:35], v[64:67], a[80:83], v[32:35]
ds_read_b128 v[100:103], v17 offset:17408
s_waitcnt lgkmcnt(8)
v_mfma_f32_16x16x32_bf16 v[36:39], v[68:71], a[80:83], v[36:39]
ds_read_b128 v[64:67], v17 offset:18432
s_add_u32 m0, s90, 81920
s_add_u32 s91, s89, 200704
buffer_load_dwordx4 v8, s[40:43], s91 offen sc1 lds
s_waitcnt lgkmcnt(8)
v_mfma_f32_16x16x32_bf16 v[40:43], v[72:75], a[80:83], v[40:43]
ds_read_b128 v[68:71], v17 offset:19456
s_waitcnt lgkmcnt(8)
v_mfma_f32_16x16x32_bf16 v[44:47], v[76:79], a[80:83], v[44:47]
ds_read_b128 v[72:75], v17 offset:20480
s_add_u32 m0, s90, 86016
s_add_u32 s91, s89, 204800
buffer_load_dwordx4 v8, s[40:43], s91 offen sc1 lds
s_waitcnt lgkmcnt(8)
v_mfma_f32_16x16x32_bf16 v[48:51], v[80:83], a[80:83], v[48:51]
ds_read_b128 v[76:79], v17 offset:21504
s_waitcnt lgkmcnt(8)
v_mfma_f32_16x16x32_bf16 v[32:35], v[84:87], a[84:87], v[32:35]
ds_read_b128 v[80:83], v17 offset:22528
s_waitcnt lgkmcnt(8)
v_mfma_f32_16x16x32_bf16 v[36:39], v[88:91], a[84:87], v[36:39]
ds_read_b128 v[84:87], v17 offset:23552
s_add_u32 m0, s90, 90112
s_add_u32 s91, s89, 208896
buffer_load_dwordx4 v8, s[40:43], s91 offen sc1 lds
s_waitcnt lgkmcnt(8)
v_mfma_f32_16x16x32_bf16 v[40:43], v[92:95], a[84:87], v[40:43]
ds_read_b128 v[88:91], v8 offset:0
s_waitcnt lgkmcnt(8)
v_mfma_f32_16x16x32_bf16 v[44:47], v[96:99], a[84:87], v[44:47]
ds_read_b128 v[92:95], v8 offset:1024
s_add_u32 m0, s90, 94208
s_add_u32 s91, s89, 212992
buffer_load_dwordx4 v8, s[40:43], s91 offen sc1 lds
s_waitcnt lgkmcnt(8)
v_mfma_f32_16x16x32_bf16 v[48:51], v[100:103], a[84:87], v[48:51]
ds_read_b128 v[96:99], v8 offset:2048
s_waitcnt lgkmcnt(8)
v_mfma_f32_16x16x32_bf16 v[32:35], v[64:67], a[88:91], v[32:35]
ds_read_b128 v[100:103], v8 offset:3072
s_waitcnt lgkmcnt(8)
v_mfma_f32_16x16x32_bf16 v[36:39], v[68:71], a[88:91], v[36:39]
ds_read_b128 v[64:67], v8 offset:4096
s_add_u32 m0, s90, 98304
s_add_u32 s91, s89, 217088
buffer_load_dwordx4 v8, s[40:43], s91 offen sc1 lds
s_waitcnt lgkmcnt(8)
v_mfma_f32_16x16x32_bf16 v[40:43], v[72:75], a[88:91], v[40:43]
ds_read_b128 v[68:71], v8 offset:5120
s_waitcnt lgkmcnt(8)
v_mfma_f32_16x16x32_bf16 v[44:47], v[76:79], a[88:91], v[44:47]
ds_read_b128 v[72:75], v8 offset:6144
s_add_u32 m0, s90, 102400
s_add_u32 s91, s89, 221184
buffer_load_dwordx4 v8, s[40:43], s91 offen sc1 lds
s_waitcnt lgkmcnt(8)
v_mfma_f32_16x16x32_bf16 v[48:51], v[80:83], a[88:91], v[48:51]
ds_read_b128 v[76:79], v8 offset:7168
s_waitcnt lgkmcnt(8)
v_mfma_f32_16x16x32_bf16 v[32:35], v[84:87], a[92:95], v[32:35]
ds_read_b128 v[80:83], v8 offset:8192
s_waitcnt lgkmcnt(8)
v_mfma_f32_16x16x32_bf16 v[36:39], v[88:91], a[92:95], v[36:39]
ds_read_b128 v[84:87], v8 offset:9216
s_add_u32 m0, s90, 106496
s_add_u32 s91, s89, 225280
buffer_load_dwordx4 v8, s[40:43], s91 offen sc1 lds
s_waitcnt lgkmcnt(8)
v_mfma_f32_16x16x32_bf16 v[40:43], v[92:95], a[92:95], v[40:43]
ds_read_b128 v[88:91], v8 offset:10240
s_waitcnt lgkmcnt(8)
v_mfma_f32_16x16x32_bf16 v[44:47], v[96:99], a[92:95], v[44:47]
ds_read_b128 v[92:95], v8 offset:11264
s_add_u32 m0, s90, 110592
s_add_u32 s91, s89, 229376
buffer_load_dwordx4 v8, s[40:43], s91 offen sc1 lds
s_waitcnt lgkmcnt(8)
v_mfma_f32_16x16x32_bf16 v[48:51], v[100:103], a[92:95], v[48:51]
ds_read_b128 v[96:99], v8 offset:12288
s_waitcnt vmcnt(8)
s_add_u32 s72, s8, 9
v_subrev_u32 v5, s72, v5
v_cmp_lt_u32 vcc, 6, v5
s_nop 3
s_cbranch_vccnz L_slow_39
L_back_40:
s_waitcnt lgkmcnt(8)
v_mfma_f32_16x16x32_bf16 v[32:35], v[64:67], a[96:99], v[32:35]
ds_read_b128 v[100:103], v8 offset:13312
s_waitcnt lgkmcnt(8)
v_mfma_f32_16x16x32_bf16 v[36:39], v[68:71], a[96:99], v[36:39]
ds_read_b128 v[64:67], v8 offset:14336
s_add_u32 m0, s90, 114688
s_add_u32 s91, s89, 233472
buffer_load_dwordx4 v8, s[40:43], s91 offen sc1 lds
s_waitcnt lgkmcnt(8)
v_mfma_f32_16x16x32_bf16 v[40:43], v[72:75], a[96:99], v[40:43]
ds_read_b128 v[68:71], v8 offset:15360
s_waitcnt lgkmcnt(8)
v_mfma_f32_16x16x32_bf16 v[44:47], v[76:79], a[96:99], v[44:47]
ds_read_b128 v[72:75], v8 offset:16384
s_add_u32 m0, s90, 118784
s_add_u32 s91, s89, 237568
buffer_load_dwordx4 v8, s[40:43], s91 offen sc1 lds
s_waitcnt lgkmcnt(8)
v_mfma_f32_16x16x32_bf16 v[48:51], v[80:83], a[96:99], v[48:51]
ds_read_b128 v[76:79], v8 offset:17408
s_waitcnt lgkmcnt(8)
v_mfma_f32_16x16x32_bf16 v[32:35], v[84:87], a[100:103], v[32:35]
ds_read_b128 v[80:83], v8 offset:18432
s_waitcnt lgkmcnt(8)
v_mfma_f32_16x16x32_bf16 v[36:39], v[88:91], a[100:103], v[36:39]
ds_read_b128 v[84:87], v8 offset:19456
s_add_u32 m0, s90, 122880
s_add_u32 s91, s89, 241664
buffer_load_dwordx4 v8, s[40:43], s91 offen sc1 lds
s_waitcnt lgkmcnt(8)
v_mfma_f32_16x16x32_bf16 v[40:43], v[92:95], a[100:103], v[40:43]
ds_read_b128 v[88:91], v8 offset:20480
s_waitcnt lgkmcnt(8)
v_mfma_f32_16x16x32_bf16 v[44:47], v[96:99], a[100:103], v[44:47]
ds_read_b128 v[92:95], v8 offset:21504
s_add_u32 s91, s82, 2048
buffer_load_dwordx4 a[128:131], v8, s[40:43], s91 offen sc1
s_waitcnt lgkmcnt(8)
v_mfma_f32_16x16x32_bf16 v[48:51], v[100:103], a[100:103], v[48:51]
ds_read_b128 v[96:99], v8 offset:22528
s_waitcnt lgkmcnt(8)
v_mfma_f32_16x16x32_bf16 v[32:35], v[64:67], a[104:107], v[32:35]
ds_read_b128 v[100:103], v8 offset:23552
s_waitcnt lgkmcnt(8)
v_mfma_f32_16x16x32_bf16 v[36:39], v[68:71], a[104:107], v[36:39]
ds_read_b128 v[64:67], v8 offset:24576
s_add_u32 s91, s82, 5120
buffer_load_dwordx4 a[132:135], v8, s[40:43], s91 offen sc1
s_waitcnt lgkmcnt(8)
v_mfma_f32_16x16x32_bf16 v[40:43], v[72:75], a[104:107], v[40:43]
ds_read_b128 v[68:71], v8 offset:25600
s_waitcnt lgkmcnt(8)
v_mfma_f32_16x16x32_bf16 v[44:47], v[76:79], a[104:107], v[44:47]
ds_read_b128 v[72:75], v8 offset:26624
s_add_u32 s91, s82, 8192
buffer_load_dwordx4 a[136:139], v8, s[40:43], s91 offen sc1
s_waitcnt lgkmcnt(8)
v_mfma_f32_16x16x32_bf16 v[48:51], v[80:83], a[104:107], v[48:51]
ds_read_b128 v[76:79], v8 offset:27648
s_waitcnt lgkmcnt(8)
v_mfma_f32_16x16x32_bf16 v[32:35], v[84:87], a[108:111], v[32:35]
ds_read_b128 v[80:83], v8 offset:28672
s_waitcnt lgkmcnt(8)
v_mfma_f32_16x16x32_bf16 v[36:39], v[88:91], a[108:111], v[36:39]
ds_read_b128 v[84:87], v8 offset:29696
s_add_u32 s91, s82, 11264
buffer_load_dwordx4 a[140:143], v8, s[40:43], s91 offen sc1
s_waitcnt lgkmcnt(8)
v_mfma_f32_16x16x32_bf16 v[40:43], v[92:95], a[108:111], v[40:43]
ds_read_b128 v[88:91], v8 offset:30720
s_waitcnt lgkmcnt(8)
v_mfma_f32_16x16x32_bf16 v[44:47], v[96:99], a[108:111], v[44:47]
ds_read_b128 v[92:95], v8 offset:31744
s_add_u32 s91, s82, 14336
buffer_load_dwordx4 a[144:147], v8, s[40:43], s91 offen sc1
s_waitcnt lgkmcnt(8)
v_mfma_f32_16x16x32_bf16 v[48:51], v[100:103], a[108:111], v[48:51]
ds_read_b128 v[96:99], v8 offset:32768
s_waitcnt lgkmcnt(8)
v_mfma_f32_16x16x32_bf16 v[32:35], v[64:67], a[112:115], v[32:35]
ds_read_b128 v[100:103], v8 offset:33792
s_waitcnt lgkmcnt(8)
v_mfma_f32_16x16x32_bf16 v[36:39], v[68:71], a[112:115], v[36:39]
ds_read_b128 v[64:67], v8 offset:34816
s_add_u32 s91, s82, 17408
buffer_load_dwordx4 a[148:151], v8, s[40:43], s91 offen sc1
s_waitcnt lgkmcnt(8)
v_mfma_f32_16x16x32_bf16 v[40:43], v[72:75], a[112:115], v[40:43]
ds_read_b128 v[68:71], v8 offset:35840
s_barrier
s_waitcnt lgkmcnt(8)
v_mfma_f32_16x16x32_bf16 v[44:47], v[76:79], a[112:115], v[44:47]
ds_read_b128 v[72:75], v8 offset:36864
s_add_u32 s91, s82, 20480
buffer_load_dwordx4 a[152:155], v8, s[40:43], s91 offen sc1
s_waitcnt lgkmcnt(8)
v_mfma_f32_16x16x32_bf16 v[48:51], v[80:83], a[112:115], v[48:51]
ds_read_b128 v[76:79], v8 offset:37888
s_waitcnt lgkmcnt(8)
v_mfma_f32_16x16x32_bf16 v[32:35], v[84:87], a[116:119], v[32:35]
ds_read_b128 v[80:83], v8 offset:38912
s_waitcnt lgkmcnt(8)
v_mfma_f32_16x16x32_bf16 v[36:39], v[88:91], a[116:119], v[36:39]
ds_read_b128 v[84:87], v8 offset:39936
s_add_u32 s91, s82, 23552
buffer_load_dwordx4 a[156:159], v8, s[40:43], s91 offen sc1
s_waitcnt lgkmcnt(8)
v_mfma_f32_16x16x32_bf16 v[40:43], v[92:95], a[116:119], v[40:43]
ds_read_b128 v[88:91], v8 offset:40960
s_waitcnt lgkmcnt(8)
v_mfma_f32_16x16x32_bf16 v[44:47], v[96:99], a[116:119], v[44:47]
ds_read_b128 v[92:95], v8 offset:41984
s_add_u32 s91, s82, 26624
buffer_load_dwordx4 a[160:163], v8, s[40:43], s91 offen sc1
s_waitcnt lgkmcnt(8)
v_mfma_f32_16x16x32_bf16 v[48:51], v[100:103], a[116:119], v[48:51]
ds_read_b128 v[96:99], v8 offset:43008
s_waitcnt lgkmcnt(8)
v_mfma_f32_16x16x32_bf16 v[32:35], v[64:67], a[120:123], v[32:35]
ds_read_b128 v[100:103], v8 offset:44032
s_waitcnt lgkmcnt(8)
v_mfma_f32_16x16x32_bf16 v[36:39], v[68:71], a[120:123], v[36:39]
ds_read_b128 v[64:67], v8 offset:45056
s_add_u32 s91, s82, 29696
buffer_load_dwordx4 a[164:167], v8, s[40:43], s91 offen sc1
s_waitcnt lgkmcnt(8)
v_mfma_f32_16x16x32_bf16 v[40:43], v[72:75], a[120:123], v[40:43]
ds_read_b128 v[68:71], v8 offset:46080
s_waitcnt lgkmcnt(8)
v_mfma_f32_16x16x32_bf16 v[44:47], v[76:79], a[120:123], v[44:47]
ds_read_b128 v[72:75], v8 offset:47104
s_add_u32 s91, s82, 32768
buffer_load_dwordx4 a[168:171], v8, s[40:43], s91 offen sc1
s_waitcnt lgkmcnt(8)
v_mfma_f32_16x16x32_bf16 v[48:51], v[80:83], a[120:123], v[48:51]
ds_read_b128 v[76:79], v8 offset:48128
s_waitcnt lgkmcnt(8)
v_mfma_f32_16x16x32_bf16 v[32:35], v[84:87], a[124:127], v[32:35]
ds_read_b128 v[80:83], v8 offset:49152
s_waitcnt lgkmcnt(8)
v_mfma_f32_16x16x32_bf16 v[36:39], v[88:91], a[124:127], v[36:39]
ds_read_b128 v[84:87], v8 offset:50176
s_add_u32 s91, s82, 35840
buffer_load_dwordx4 a[172:175], v8, s[40:43], s91 offen sc1
s_waitcnt lgkmcnt(8)
v_mfma_f32_16x16x32_bf16 v[40:43], v[92:95], a[124:127], v[40:43]
ds_read_b128 v[88:91], v8 offset:51200
s_waitcnt lgkmcnt(8)
v_mfma_f32_16x16x32_bf16 v[44:47], v[96:99], a[124:127], v[44:47]
ds_read_b128 v[92:95], v8 offset:52224
s_add_u32 s91, s82, 38912
buffer_load_dwordx4 a[176:179], v8, s[40:43], s91 offen sc1
s_waitcnt lgkmcnt(8)
v_mfma_f32_16x16x32_bf16 v[48:51], v[100:103], a[124:127], v[48:51]
ds_read_b128 v[96:99], v8 offset:53248
s_waitcnt vmcnt(12)
s_waitcnt lgkmcnt(8)
v_mfma_f32_16x16x32_bf16 v[32:35], v[64:67], a[128:131], v[32:35]
ds_read_b128 v[100:103], v8 offset:54272
s_waitcnt lgkmcnt(8)
v_mfma_f32_16x16x32_bf16 v[36:39], v[68:71], a[128:131], v[36:39]
ds_read_b128 v[64:67], v8 offset:55296
s_add_u32 s91, s82, 41984
buffer_load_dwordx4 a[180:183], v8, s[40:43], s91 offen sc1
s_waitcnt lgkmcnt(8)
v_mfma_f32_16x16x32_bf16 v[40:43], v[72:75], a[128:131], v[40:43]
ds_read_b128 v[68:71], v8 offset:56320
s_waitcnt lgkmcnt(8)
v_mfma_f32_16x16x32_bf16 v[44:47], v[76:79], a[128:131], v[44:47]
ds_read_b128 v[72:75], v8 offset:57344
s_add_u32 s91, s82, 45056
buffer_load_dwordx4 a[184:187], v8, s[40:43], s91 offen sc1
s_waitcnt lgkmcnt(8)
v_mfma_f32_16x16x32_bf16 v[48:51], v[80:83], a[128:131], v[48:51]
ds_read_b128 v[76:79], v8 offset:58368
s_waitcnt vmcnt(13)
s_waitcnt lgkmcnt(8)
v_mfma_f32_16x16x32_bf16 v[32:35], v[84:87], a[132:135], v[32:35]
ds_read_b128 v[80:83], v8 offset:59392
s_waitcnt lgkmcnt(8)
v_mfma_f32_16x16x32_bf16 v[36:39], v[88:91], a[132:135], v[36:39]
ds_read_b128 v[84:87], v8 offset:60416
s_add_u32 s91, s82, 48128
buffer_load_dwordx4 a[188:191], v8, s[40:43], s91 offen sc1
s_waitcnt lgkmcnt(8)
v_mfma_f32_16x16x32_bf16 v[40:43], v[92:95], a[132:135], v[40:43]
ds_read_b128 v[88:91], v8 offset:61440
s_waitcnt lgkmcnt(8)
v_mfma_f32_16x16x32_bf16 v[44:47], v[96:99], a[132:135], v[44:47]
ds_read_b128 v[92:95], v8 offset:62464
s_waitcnt lgkmcnt(8)
v_mfma_f32_16x16x32_bf16 v[48:51], v[100:103], a[132:135], v[48:51]
ds_read_b128 v[96:99], v8 offset:63488
s_waitcnt vmcnt(13)
s_waitcnt lgkmcnt(8)
v_mfma_f32_16x16x32_bf16 v[32:35], v[64:67], a[136:139], v[32:35]
ds_read_b128 v[100:103], v8 offset:64512
s_waitcnt lgkmcnt(8)
v_mfma_f32_16x16x32_bf16 v[36:39], v[68:71], a[136:139], v[36:39]
ds_read_b128 v[64:67], v16 offset:0
s_waitcnt lgkmcnt(8)
v_mfma_f32_16x16x32_bf16 v[40:43], v[72:75], a[136:139], v[40:43]
ds_read_b128 v[68:71], v16 offset:1024
s_waitcnt lgkmcnt(8)
v_mfma_f32_16x16x32_bf16 v[44:47], v[76:79], a[136:139], v[44:47]
ds_read_b128 v[72:75], v16 offset:2048
s_waitcnt lgkmcnt(8)
v_mfma_f32_16x16x32_bf16 v[48:51], v[80:83], a[136:139], v[48:51]
ds_read_b128 v[76:79], v16 offset:3072
s_waitcnt vmcnt(12)
s_waitcnt lgkmcnt(8)
v_mfma_f32_16x16x32_bf16 v[32:35], v[84:87], a[140:143], v[32:35]
ds_read_b128 v[80:83], v16 offset:4096
s_waitcnt lgkmcnt(8)
v_mfma_f32_16x16x32_bf16 v[36:39], v[88:91], a[140:143], v[36:39]
ds_read_b128 v[84:87], v16 offset:5120
s_waitcnt lgkmcnt(8)
v_mfma_f32_16x16x32_bf16 v[40:43], v[92:95], a[140:143], v[40:43]
ds_read_b128 v[88:91], v16 offset:6144
s_waitcnt lgkmcnt(8)
v_mfma_f32_16x16x32_bf16 v[44:47], v[96:99], a[140:143], v[44:47]
ds_read_b128 v[92:95], v16 offset:7168
s_waitcnt lgkmcnt(8)
v_mfma_f32_16x16x32_bf16 v[48:51], v[100:103], a[140:143], v[48:51]
ds_read_b128 v[96:99], v16 offset:8192
s_waitcnt vmcnt(11)
s_waitcnt lgkmcnt(8)
v_mfma_f32_16x16x32_bf16 v[32:35], v[64:67], a[144:147], v[32:35]
ds_read_b128 v[100:103], v16 offset:9216
s_waitcnt lgkmcnt(8)
v_mfma_f32_16x16x32_bf16 v[36:39], v[68:71], a[144:147], v[36:39]
ds_read_b128 v[64:67], v16 offset:10240
s_waitcnt lgkmcnt(8)
v_mfma_f32_16x16x32_bf16 v[40:43], v[72:75], a[144:147], v[40:43]
ds_read_b128 v[68:71], v16 offset:11264
s_barrier
s_waitcnt lgkmcnt(8)
v_mfma_f32_16x16x32_bf16 v[44:47], v[76:79], a[144:147], v[44:47]
ds_read_b128 v[72:75], v16 offset:12288
s_waitcnt lgkmcnt(8)
v_mfma_f32_16x16x32_bf16 v[48:51], v[80:83], a[144:147], v[48:51]
ds_read_b128 v[76:79], v16 offset:13312
s_waitcnt vmcnt(10)
s_waitcnt lgkmcnt(8)
v_mfma_f32_16x16x32_bf16 v[32:35], v[84:87], a[148:151], v[32:35]
ds_read_b128 v[80:83], v16 offset:14336
s_waitcnt lgkmcnt(8)
v_mfma_f32_16x16x32_bf16 v[36:39], v[88:91], a[148:151], v[36:39]
ds_read_b128 v[84:87], v16 offset:15360
s_waitcnt lgkmcnt(8)
v_mfma_f32_16x16x32_bf16 v[40:43], v[92:95], a[148:151], v[40:43]
ds_read_b128 v[88:91], v16 offset:16384
s_waitcnt lgkmcnt(8)
v_mfma_f32_16x16x32_bf16 v[44:47], v[96:99], a[148:151], v[44:47]
ds_read_b128 v[92:95], v16 offset:17408
s_waitcnt lgkmcnt(8)
v_mfma_f32_16x16x32_bf16 v[48:51], v[100:103], a[148:151], v[48:51]
ds_read_b128 v[96:99], v16 offset:18432
s_waitcnt vmcnt(9)
s_waitcnt lgkmcnt(8)
v_mfma_f32_16x16x32_bf16 v[32:35], v[64:67], a[152:155], v[32:35]
ds_read_b128 v[100:103], v16 offset:19456
s_waitcnt lgkmcnt(8)
v_mfma_f32_16x16x32_bf16 v[36:39], v[68:71], a[152:155], v[36:39]
ds_read_b128 v[64:67], v16 offset:20480
s_waitcnt lgkmcnt(8)
v_mfma_f32_16x16x32_bf16 v[40:43], v[72:75], a[152:155], v[40:43]
ds_read_b128 v[68:71], v16 offset:21504
s_waitcnt lgkmcnt(8)
v_mfma_f32_16x16x32_bf16 v[44:47], v[76:79], a[152:155], v[44:47]
ds_read_b128 v[72:75], v16 offset:22528
s_waitcnt lgkmcnt(8)
v_mfma_f32_16x16x32_bf16 v[48:51], v[80:83], a[152:155], v[48:51]
ds_read_b128 v[76:79], v16 offset:23552
s_waitcnt vmcnt(8)
s_waitcnt lgkmcnt(8)
v_mfma_f32_16x16x32_bf16 v[32:35], v[84:87], a[156:159], v[32:35]
ds_read_b128 v[80:83], v16 offset:24576
s_waitcnt lgkmcnt(8)
v_mfma_f32_16x16x32_bf16 v[36:39], v[88:91], a[156:159], v[36:39]
ds_read_b128 v[84:87], v16 offset:25600
s_waitcnt lgkmcnt(8)
v_mfma_f32_16x16x32_bf16 v[40:43], v[92:95], a[156:159], v[40:43]
ds_read_b128 v[88:91], v16 offset:26624
s_waitcnt lgkmcnt(8)
v_mfma_f32_16x16x32_bf16 v[44:47], v[96:99], a[156:159], v[44:47]
ds_read_b128 v[92:95], v16 offset:27648
s_waitcnt lgkmcnt(8)
v_mfma_f32_16x16x32_bf16 v[48:51], v[100:103], a[156:159], v[48:51]
ds_read_b128 v[96:99], v16 offset:28672
s_waitcnt vmcnt(7)
s_waitcnt lgkmcnt(8)
v_mfma_f32_16x16x32_bf16 v[32:35], v[64:67], a[160:163], v[32:35]
ds_read_b128 v[100:103], v16 offset:29696
s_waitcnt lgkmcnt(8)
v_mfma_f32_16x16x32_bf16 v[36:39], v[68:71], a[160:163], v[36:39]
ds_read_b128 v[64:67], v16 offset:30720
s_waitcnt lgkmcnt(8)
v_mfma_f32_16x16x32_bf16 v[40:43], v[72:75], a[160:163], v[40:43]
ds_read_b128 v[68:71], v16 offset:31744
s_waitcnt lgkmcnt(8)
v_mfma_f32_16x16x32_bf16 v[44:47], v[76:79], a[160:163], v[44:47]
ds_read_b128 v[72:75], v16 offset:32768
s_waitcnt lgkmcnt(8)
v_mfma_f32_16x16x32_bf16 v[48:51], v[80:83], a[160:163], v[48:51]
ds_read_b128 v[76:79], v16 offset:33792
s_waitcnt vmcnt(6)
s_waitcnt lgkmcnt(8)
v_mfma_f32_16x16x32_bf16 v[32:35], v[84:87], a[164:167], v[32:35]
ds_read_b128 v[80:83], v16 offset:34816
s_waitcnt lgkmcnt(8)
v_mfma_f32_16x16x32_bf16 v[36:39], v[88:91], a[164:167], v[36:39]
ds_read_b128 v[84:87], v16 offset:35840
s_waitcnt lgkmcnt(8)
v_mfma_f32_16x16x32_bf16 v[40:43], v[92:95], a[164:167], v[40:43]
ds_read_b128 v[88:91], v16 offset:36864
s_waitcnt lgkmcnt(8)
v_mfma_f32_16x16x32_bf16 v[44:47], v[96:99], a[164:167], v[44:47]
ds_read_b128 v[92:95], v16 offset:37888
s_waitcnt lgkmcnt(8)
v_mfma_f32_16x16x32_bf16 v[48:51], v[100:103], a[164:167], v[48:51]
ds_read_b128 v[96:99], v16 offset:38912
s_waitcnt vmcnt(5)
s_waitcnt lgkmcnt(8)
v_mfma_f32_16x16x32_bf16 v[32:35], v[64:67], a[168:171], v[32:35]
ds_read_b128 v[100:103], v16 offset:39936
s_waitcnt lgkmcnt(8)
v_mfma_f32_16x16x32_bf16 v[36:39], v[68:71], a[168:171], v[36:39]
ds_read_b128 v[64:67], v16 offset:40960
s_waitcnt lgkmcnt(8)
v_mfma_f32_16x16x32_bf16 v[40:43], v[72:75], a[168:171], v[40:43]
ds_read_b128 v[68:71], v16 offset:41984
s_waitcnt lgkmcnt(8)
v_mfma_f32_16x16x32_bf16 v[44:47], v[76:79], a[168:171], v[44:47]
ds_read_b128 v[72:75], v16 offset:43008
s_waitcnt lgkmcnt(8)
v_mfma_f32_16x16x32_bf16 v[48:51], v[80:83], a[168:171], v[48:51]
ds_read_b128 v[76:79], v16 offset:44032
s_waitcnt vmcnt(4)
s_waitcnt lgkmcnt(8)
v_mfma_f32_16x16x32_bf16 v[32:35], v[84:87], a[172:175], v[32:35]
ds_read_b128 v[80:83], v16 offset:45056
s_waitcnt lgkmcnt(8)
v_mfma_f32_16x16x32_bf16 v[36:39], v[88:91], a[172:175], v[36:39]
ds_read_b128 v[84:87], v16 offset:46080
s_waitcnt lgkmcnt(8)
v_mfma_f32_16x16x32_bf16 v[40:43], v[92:95], a[172:175], v[40:43]
ds_read_b128 v[88:91], v16 offset:47104
s_waitcnt lgkmcnt(8)
v_mfma_f32_16x16x32_bf16 v[44:47], v[96:99], a[172:175], v[44:47]
ds_read_b128 v[92:95], v16 offset:48128
s_waitcnt lgkmcnt(8)
v_mfma_f32_16x16x32_bf16 v[48:51], v[100:103], a[172:175], v[48:51]
ds_read_b128 v[96:99], v16 offset:49152
s_waitcnt vmcnt(3)
s_waitcnt lgkmcnt(8)
v_mfma_f32_16x16x32_bf16 v[32:35], v[64:67], a[176:179], v[32:35]
ds_read_b128 v[100:103], v16 offset:50176
s_waitcnt lgkmcnt(8)
v_mfma_f32_16x16x32_bf16 v[36:39], v[68:71], a[176:179], v[36:39]
ds_read_b128 v[64:67], v16 offset:51200
s_waitcnt lgkmcnt(8)
v_mfma_f32_16x16x32_bf16 v[40:43], v[72:75], a[176:179], v[40:43]
ds_read_b128 v[68:71], v16 offset:52224
s_waitcnt lgkmcnt(8)
v_mfma_f32_16x16x32_bf16 v[44:47], v[76:79], a[176:179], v[44:47]
ds_read_b128 v[72:75], v16 offset:53248
s_waitcnt lgkmcnt(8)
v_mfma_f32_16x16x32_bf16 v[48:51], v[80:83], a[176:179], v[48:51]
ds_read_b128 v[76:79], v16 offset:54272
s_waitcnt vmcnt(2)
s_waitcnt lgkmcnt(8)
v_mfma_f32_16x16x32_bf16 v[32:35], v[84:87], a[180:183], v[32:35]
ds_read_b128 v[80:83], v16 offset:55296
s_waitcnt lgkmcnt(8)
v_mfma_f32_16x16x32_bf16 v[36:39], v[88:91], a[180:183], v[36:39]
ds_read_b128 v[84:87], v16 offset:56320
s_waitcnt lgkmcnt(8)
v_mfma_f32_16x16x32_bf16 v[40:43], v[92:95], a[180:183], v[40:43]
ds_read_b128 v[88:91], v16 offset:57344
s_waitcnt lgkmcnt(8)
v_mfma_f32_16x16x32_bf16 v[44:47], v[96:99], a[180:183], v[44:47]
ds_read_b128 v[92:95], v16 offset:58368
s_waitcnt lgkmcnt(8)
v_mfma_f32_16x16x32_bf16 v[48:51], v[100:103], a[180:183], v[48:51]
ds_read_b128 v[96:99], v16 offset:59392
s_waitcnt vmcnt(1)
s_waitcnt lgkmcnt(8)
v_mfma_f32_16x16x32_bf16 v[32:35], v[64:67], a[184:187], v[32:35]
ds_read_b128 v[100:103], v16 offset:60416
s_waitcnt lgkmcnt(8)
v_mfma_f32_16x16x32_bf16 v[36:39], v[68:71], a[184:187], v[36:39]
s_waitcnt lgkmcnt(7)
v_mfma_f32_16x16x32_bf16 v[40:43], v[72:75], a[184:187], v[40:43]
s_waitcnt lgkmcnt(6)
v_mfma_f32_16x16x32_bf16 v[44:47], v[76:79], a[184:187], v[44:47]
s_waitcnt lgkmcnt(5)
v_mfma_f32_16x16x32_bf16 v[48:51], v[80:83], a[184:187], v[48:51]
s_waitcnt vmcnt(0)
s_waitcnt lgkmcnt(4)
v_mfma_f32_16x16x32_bf16 v[32:35], v[84:87], a[188:191], v[32:35]
s_waitcnt lgkmcnt(3)
v_mfma_f32_16x16x32_bf16 v[36:39], v[88:91], a[188:191], v[36:39]
s_waitcnt lgkmcnt(2)
v_mfma_f32_16x16x32_bf16 v[40:43], v[92:95], a[188:191], v[40:43]
s_waitcnt lgkmcnt(1)
v_mfma_f32_16x16x32_bf16 v[44:47], v[96:99], a[188:191], v[44:47]
s_waitcnt lgkmcnt(0)
v_mfma_f32_16x16x32_bf16 v[48:51], v[100:103], a[188:191], v[48:51]
v_pk_fma_f32 v[136:137], v[112:113], v[32:33], v[136:137]
v_pk_fma_f32 v[138:139], v[114:115], v[34:35], v[138:139]
v_pk_fma_f32 v[140:141], v[116:117], v[36:37], v[140:141]
v_pk_fma_f32 v[142:143], v[118:119], v[38:39], v[142:143]
v_pk_fma_f32 v[144:145], v[120:121], v[40:41], v[144:145]
v_pk_fma_f32 v[146:147], v[122:123], v[42:43], v[146:147]
v_pk_fma_f32 v[148:149], v[124:125], v[44:45], v[148:149]
v_pk_fma_f32 v[150:151], v[126:127], v[46:47], v[150:151]
v_pk_fma_f32 v[152:153], v[128:129], v[48:49], v[152:153]
v_pk_fma_f32 v[154:155], v[130:131], v[50:51], v[154:155]
v_cvt_pk_bf16_f32 v160, v136, v137
v_cvt_pk_bf16_f32 v161, v138, v139
v_cvt_pk_bf16_f32 v162, v140, v141
v_cvt_pk_bf16_f32 v163, v142, v143
v_cvt_pk_bf16_f32 v164, v144, v145
v_cvt_pk_bf16_f32 v165, v146, v147
v_cvt_pk_bf16_f32 v166, v148, v149
v_cvt_pk_bf16_f32 v167, v150, v151
v_cvt_pk_bf16_f32 v168, v152, v153
v_cvt_pk_bf16_f32 v169, v154, v155
v_mov_b32 v170, v168
v_mov_b32 v171, v169
v_permlane16_swap_b32 v160, v162
v_permlane16_swap_b32 v161, v163
v_permlane16_swap_b32 v164, v166
v_permlane16_swap_b32 v165, v167
v_permlane16_swap_b32 v168, v170
v_permlane16_swap_b32 v169, v171
buffer_store_dwordx4 v[160:163], v7, s[44:47], s81 offen
buffer_store_dwordx4 v[164:167], v7, s[44:47], s81 offen offset:64
s_mov_b32 exec_lo, 0xffff
s_mov_b32 exec_hi, 0xffff
buffer_store_dwordx4 v[168:171], v7, s[44:47], s81 offen offset:128
s_mov_b64 exec, -1
s_waitcnt vmcnt(0) lgkmcnt(0)
L_exit:
s_endpgm
L_slow_13:
s_mov_b32 s73, 200000
L_spin_41:
buffer_load_dword v19, v244, s[40:43], 0 offen sc1
s_waitcnt vmcnt(0)
v_subrev_u32 v19, s72, v19
v_cmp_lt_u32 vcc, 13, v19
s_sub_u32 s73, s73, 1
s_cmp_eq_u32 s73, 0
s_cbranch_scc1 L_back_14
s_nop 0
s_cbranch_vccnz L_spin_41
s_branch L_back_14
L_slow_23:
s_mov_b32 s73, 200000
L_spin_42:
buffer_load_dword v21, v23, s[40:43], 0 offen sc1
s_waitcnt vmcnt(0)
v_subrev_u32 v21, s72, v21
v_cmp_lt_u32 vcc, 11, v21
s_sub_u32 s73, s73, 1
s_cmp_eq_u32 s73, 0
s_cbranch_scc1 L_back_24
s_nop 0
s_cbranch_vccnz L_spin_42
s_branch L_back_24
L_slow_27:
s_mov_b32 s73, 200000
L_spin_43:
buffer_load_dword v23, v24, s[40:43], 0 offen sc1
s_waitcnt vmcnt(0)
v_subrev_u32 v23, s72, v23
v_cmp_lt_u32 vcc, 10, v23
s_sub_u32 s73, s73, 1
s_cmp_eq_u32 s73, 0
s_cbranch_scc1 L_back_28
s_nop 0
s_cbranch_vccnz L_spin_43
s_branch L_back_28
L_slow_29:
s_mov_b32 s73, 200000
L_spin_44:
buffer_load_dword v5, v29, s[40:43], 0 offen sc1
s_waitcnt vmcnt(0)
v_subrev_u32 v5, s72, v5
v_cmp_lt_u32 vcc, 11, v5
s_sub_u32 s73, s73, 1
s_cmp_eq_u32 s73, 0
s_cbranch_scc1 L_back_30
s_nop 0
s_cbranch_vccnz L_spin_44
s_branch L_back_30
L_slow_31:
s_mov_b32 s73, 200000
L_spin_45:
buffer_load_dword v6, v30, s[40:43], 0 offen sc1
s_waitcnt vmcnt(0)
v_subrev_u32 v6, s72, v6
v_cmp_lt_u32 vcc, 11, v6
s_sub_u32 s73, s73, 1
s_cmp_eq_u32 s73, 0
s_cbranch_scc1 L_back_32
s_nop 0
s_cbranch_vccnz L_spin_45
s_branch L_back_32
L_slow_33:
s_mov_b32 s73, 200000
L_spin_46:
buffer_load_dword v177, v176, s[40:43], 0 offen sc1
s_waitcnt vmcnt(0)
v_subrev_u32 v177, s72, v177
v_cmp_lt_u32 vcc, 10, v177
s_sub_u32 s73, s73, 1
s_cmp_eq_u32 s73, 0
s_cbranch_scc1 L_back_34
s_nop 0
s_cbranch_vccnz L_spin_46
s_branch L_back_34
L_slow_35:
s_mov_b32 s73, 200000
L_spin_47:
buffer_load_dword v5, v31, s[40:43], 0 offen sc1
s_waitcnt vmcnt(0)
v_subrev_u32 v5, s72, v5
v_cmp_lt_u32 vcc, 8, v5
s_sub_u32 s73, s73, 1
s_cmp_eq_u32 s73, 0
s_cbranch_scc1 L_back_36
s_nop 0
s_cbranch_vccnz L_spin_47
s_branch L_back_36
L_slow_37:
s_mov_b32 s73, 200000
L_spin_48:
buffer_load_dword v5, v31, s[40:43], 0 offen sc1
s_waitcnt vmcnt(0)
v_subrev_u32 v5, s72, v5
v_cmp_lt_u32 vcc, 7, v5
s_sub_u32 s73, s73, 1
s_cmp_eq_u32 s73, 0
s_cbranch_scc1 L_back_38
s_nop 0
s_cbranch_vccnz L_spin_48
s_branch L_back_38
L_slow_39:
s_mov_b32 s73, 200000
L_spin_49:
buffer_load_dword v5, v31, s[40:43], 0 offen sc1
s_waitcnt vmcnt(0)
v_subrev_u32 v5, s72, v5
v_cmp_lt_u32 vcc, 6, v5
s_sub_u32 s73, s73, 1
s_cmp_eq_u32 s73, 0
s_cbranch_scc1 L_back_40
s_nop 0
s_cbranch_vccnz L_spin_49
s_branch L_back_40
L_code_end:
.section .rodata,"a"
.p2align 6
.amdhsa_kernel adaLN_cond__sliding_local_dilated__geglu_ffn__prompt_kernel
  .amdhsa_next_free_vgpr 512
  .amdhsa_next_free_sgpr 102
  .amdhsa_accum_offset 256
  .amdhsa_group_segment_fixed_size 0
  .amdhsa_kernarg_size 96
  .amdhsa_user_sgpr_count 2
  .amdhsa_user_sgpr_kernarg_segment_ptr 1
  .amdhsa_system_sgpr_workgroup_id_x 1
  .amdhsa_float_denorm_mode_32 3
.end_amdhsa_kernel
```
